```python
import torch

def _softmax(x, axis=-1):
    return torch.softmax(x, dim=axis)
def _gelu(x):
    return torch.nn.functional.gelu(x, approximate="tanh")
def _silu(x):
    return torch.nn.functional.silu(x)
def _sigmoid(x):
    return torch.sigmoid(x)
def _layernorm(x, axis=-1, eps=1e-5):
    m = x.mean(dim=axis, keepdim=True)
    v = x.var(dim=axis, keepdim=True, unbiased=False)
    return (x - m) / torch.sqrt(v + eps)
def _scatter_add(tgt, idx, src, axis=0):
    return tgt.clone().index_add_(axis, idx, src)
def _segment_sum(src, seg, n):
    out = torch.zeros((n,) + src.shape[1:], dtype=src.dtype)
    return out.index_add_(0, seg, src)
def _pad(x, pw):
    flat = tuple(v for pair in reversed(pw) for v in pair)
    return torch.nn.functional.pad(x, flat)

kernel_name = 'standalone__gqa_block_cached__near_ridge'

def setup_inputs():

    _w = (lambda a: (lambda t: t.to(torch.bfloat16) if t.is_floating_point() else t)(torch.as_tensor(a)))
    B, Sq, D = 8, 192, 640
    Hq, Hkv, Sk, Dh = 32, 32, 512, 192
    assert Hq % Hkv == 0, (Hq, Hkv)
    return {
        "x": _w((lambda *s: torch.randn(*s, dtype=torch.bfloat16) * 0.8)(B, Sq, D)),
        "k_cache": _w((lambda *s: torch.randn(*s, dtype=torch.bfloat16) * 0.8)(B, Hkv, Sk, Dh)),
        "v_cache": _w((lambda *s: torch.randn(*s, dtype=torch.bfloat16) * 0.05)(B, Hkv, Sk, Dh)),
        "wq": _w((lambda *s: torch.randn(*s, dtype=torch.bfloat16) * 0.8)(D, Hq * Dh) * (D ** -0.5)),
        "wo": _w((lambda *s: torch.randn(*s, dtype=torch.bfloat16) * 0.05)(Hq * Dh, D) * ((Hq * Dh) ** -0.5)),
    }

def reference(x, k_cache, v_cache, wq, wo):
    B, Sq, D = x.shape
    Hq, Dh = 32, 192
    Hkv = k_cache.shape[1]
    rep = Hq // Hkv
    q = (lambda x, *d: x.permute(*d))((x @ wq).reshape(B, Sq, Hq, Dh), 0, 2, 1, 3)
    k = (lambda x, n, axis: torch.repeat_interleave(x, n, dim=axis))(k_cache, rep, axis=1)
    v = (lambda x, n, axis: torch.repeat_interleave(x, n, dim=axis))(v_cache, rep, axis=1)
    scores = torch.einsum("bhqd,bhkd->bhqk", q, k) * (Dh ** -0.5)
    p = _softmax(scores, axis=-1)
    o = torch.einsum("bhqk,bhkd->bhqd", p, v)
    return (lambda x, *d: x.permute(*d))(o, 0, 2, 1, 3).reshape(B, Sq, Hq * Dh) @ wo
```

```asm
; @launch grid=(256,1,1) block=(256,1,1) lds=163840
.amdgcn_target "amdgcn-amd-amdhsa--gfx950"
.text
.globl standalone__gqa_block_cached__near_ridge_kernel
.p2align 8
.type standalone__gqa_block_cached__near_ridge_kernel,@function
standalone__gqa_block_cached__near_ridge_kernel:
  s_cmp_ge_u32 s2, 256
  s_cbranch_scc1 L_end_k
  s_mov_b32 s99, 0
  v_lshrrev_b32 v1, 6, v0
  v_and_b32 v0, 63, v0
  v_readfirstlane_b32 s36, v1
L_restart:
  s_load_dwordx16 s[72:87], s[0:1], 0
  v_lshlrev_b32 v19, 4, v0
  s_and_b32 s40, s2, 7
  s_lshr_b32 s48, s2, 3
  s_and_b32 s41, s48, 3
  s_lshr_b32 s38, s48, 2
  s_lshl_b32 s39, s40, 2
  s_add_u32 s39, s39, s41
  s_mul_i32 s37, s36, 0xc00
  s_mul_i32 s42, s36, 0x1800
  v_mov_b32 v28, 0xff7fffff
  v_mov_b32 v29, 0xff7fffff
  v_mov_b32 v30, 0xff7fffff
  s_getpc_b64 s[50:51]
L_pc:
  s_lshr_b32 s48, s2, 3
  s_lshl_b32 s48, s48, 2
  s_add_u32 s48, s48, s36
  s_mul_i32 s48, s48, 5
  v_add_u32 v20, s48, v0
  v_lshlrev_b32 v20, 7, v20
  v_min_u32 v20, L_end_k-L_pc, v20
  v_mov_b32 v23, s51
  v_add_co_u32 v22, vcc, s50, v20
  s_nop 1
  v_addc_co_u32 v23, vcc, 0, v23, vcc
  s_mov_b64 exec, 31
  global_load_dword v240, v[22:23], off
  s_mov_b64 exec, -1
  v_lshrrev_b32 v20, 3, v0
  s_lshl_b32 s48, s36, 3
  v_add_u32 v21, s48, v20
  v_and_b32 v22, 7, v0
  v_and_b32 v23, 6, v21
  v_xor_b32 v23, v23, v22
  v_lshlrev_b32 v24, 4, v23
  v_bfe_u32 v25, v21, 2, 2
  v_lshlrev_b32 v25, 3, v25
  v_lshrrev_b32 v26, 4, v21
  v_lshl_add_u32 v25, v26, 2, v25
  v_and_b32 v26, 3, v21
  v_add_u32 v25, v25, v26
  v_mul_u32_u24 v25, 0x3000, v25
  v_add_u32 v12, v25, v24
  v_lshrrev_b32 v25, 1, v20
  v_add_u32 v25, 6, v25
  v_and_b32 v25, 7, v25
  v_xor_b32 v25, v25, v22
  s_mul_i32 s49, s36, 48
  v_add_u32 v26, s49, v20
  v_mul_u32_u24 v26, 0x500, v26
  v_lshl_add_u32 v17, v25, 4, v26
  v_xor_b32 v18, 64, v17
  v_add_u32 v18, 0x2800, v18
  s_add_u32 s48, s38, s41
  s_mul_hi_u32 s49, s48, 0x40000000
  s_mul_i32 s49, s49, 4
  s_sub_u32 s48, s48, s49
  s_mov_b32 s49, 0
  s_cmp_eq_u32 s48, 1
  s_cselect_b32 s49, 3, s49
  s_cmp_eq_u32 s48, 2
  s_cselect_b32 s49, 5, s49
  s_cmp_eq_u32 s48, 3
  s_cselect_b32 s49, 8, s49
  s_lshl_b32 s57, s49, 7
  s_mul_i32 s56, s49, 0xc0000
  s_mul_i32 s50, s38, 0x3c000
  s_mul_i32 s51, s39, 0x180
  s_waitcnt lgkmcnt(0)
  s_add_u32 s4, s72, s50
  s_addc_u32 s5, s73, 0
  s_mov_b32 s6, 0x3c000
  s_mov_b32 s7, 0x20000
  s_add_u32 s8, s78, s51
  s_addc_u32 s9, s79, 0
  s_mov_b32 s10, 0x77d180
  s_mov_b32 s11, 0x20000
  s_add_u32 s45, s57, 0
  s_add_u32 m0, s42, 0
  s_nop 0
  buffer_load_dwordx4 v17, s[4:7], s45 offen lds
  s_add_u32 m0, s42, 0x400
  s_nop 0
  buffer_load_dwordx4 v18, s[4:7], s45 offen lds
  s_add_u32 s44, s57, 0x5000
  s_add_u32 m0, s42, 0x800
  s_nop 0
  buffer_load_dwordx4 v17, s[4:7], s44 offen lds
  s_add_u32 m0, s42, 0xc00
  s_nop 0
  buffer_load_dwordx4 v18, s[4:7], s44 offen lds
  s_add_u32 s45, s57, 0xa000
  s_add_u32 m0, s42, 0x1000
  s_nop 0
  buffer_load_dwordx4 v17, s[4:7], s45 offen lds
  s_add_u32 s57, s57, 0x80
  s_cmp_eq_u32 s57, 0x500
  s_cselect_b32 s57, 0, s57
  s_add_u32 m0, s42, 0x1400
  s_nop 0
  buffer_load_dwordx4 v18, s[4:7], s45 offen lds
  s_mov_b32 s44, s56
  s_add_u32 m0, s37, 0x12000
  s_nop 0
  buffer_load_dwordx4 v12, s[8:11], s44 offen lds
  s_add_u32 s56, s56, 0x60000
  s_cmp_eq_u32 s56, 0x780000
  s_cselect_b32 s56, 0, s56
  s_add_u32 m0, s37, 0x12380
  s_nop 0
  buffer_load_dwordx4 v12, s[8:11], s44 offen offset:128 lds
  s_add_u32 m0, s37, 0x12700
  s_nop 0
  buffer_load_dwordx4 v12, s[8:11], s44 offen offset:256 lds
  s_add_u32 s45, s57, 0
  s_add_u32 m0, s42, 0x6000
  s_nop 0
  buffer_load_dwordx4 v17, s[4:7], s45 offen lds
  s_add_u32 m0, s42, 0x6400
  s_nop 0
  buffer_load_dwordx4 v18, s[4:7], s45 offen lds
  s_add_u32 s44, s57, 0x5000
  s_add_u32 m0, s42, 0x6800
  s_nop 0
  buffer_load_dwordx4 v17, s[4:7], s44 offen lds
  s_mov_b32 s58, 0
  s_mov_b32 s59, s58
  s_lshl_b32 s48, s38, 5
  s_add_u32 s48, s48, s39
  s_mul_i32 s49, s48, 0x30000
  s_add_u32 s12, s74, s49
  s_addc_u32 s13, s75, 0
  s_mov_b32 s14, 0x30000
  s_mov_b32 s15, 0x20000
  s_add_u32 s16, s76, s49
  s_addc_u32 s17, s77, 0
  s_mov_b32 s18, 0x30000
  s_mov_b32 s19, 0x20000
  s_lshl_b32 s48, s38, 5
  s_lshl_b32 s49, s40, 2
  s_add_u32 s48, s48, s49
  s_mul_i32 s49, s48, 0x12000
  s_add_u32 s24, s86, s49
  s_addc_u32 s25, s87, 0
  s_mov_b32 s26, 0x48000
  s_mov_b32 s27, 0x20000
  s_mul_i32 s48, s40, 0xf0000
  s_mul_i32 s49, s41, 0x140
  s_add_u32 s48, s48, s49
  s_add_u32 s20, s80, s48
  s_addc_u32 s21, s81, 0
  s_mov_b32 s22, 0xefc40
  s_mov_b32 s23, 0x20000
  s_add_u32 s48, s41, 0
  s_and_b32 s48, s48, 3
  s_mul_i32 s64, s48, 0x12000
  s_mul_i32 s68, s48, 0x3c000
  s_add_u32 s48, s41, 1
  s_and_b32 s48, s48, 3
  s_mul_i32 s65, s48, 0x12000
  s_mul_i32 s69, s48, 0x3c000
  s_add_u32 s48, s41, 2
  s_and_b32 s48, s48, 3
  s_mul_i32 s66, s48, 0x12000
  s_mul_i32 s70, s48, 0x3c000
  s_add_u32 s48, s41, 3
  s_and_b32 s48, s48, 3
  s_mul_i32 s67, s48, 0x12000
  s_mul_i32 s71, s48, 0x3c000
  s_lshl_b32 s48, s38, 2
  s_add_u32 s48, s48, s41
  s_lshl_b32 s48, s48, 2
  s_add_u32 s48, s48, s36
  s_mul_i32 s49, s48, 0x1e000
  s_add_u32 s49, s49, 0x2000000
  s_add_u32 s28, s86, s49
  s_addc_u32 s29, s87, 0
  s_mov_b32 s30, 0x1e000
  s_mov_b32 s31, 0x20000
  s_lshl_b32 s48, s48, 10
  s_add_u32 s48, s48, 0x40000
  s_lshl_b32 s49, s40, 7
  s_add_u32 s3, s48, s49
  v_and_b32 v20, 7, v0
  v_lshlrev_b32 v20, 7, v20
  v_add_u32 v45, s48, v20
  s_lshl_b32 s48, s38, 3
  s_add_u32 s48, s48, s40
  s_lshl_b32 s48, s48, 2
  s_add_u32 s48, s48, s36
  s_lshl_b32 s48, s48, 9
  s_lshl_b32 s49, s41, 7
  s_add_u32 s43, s48, s49
  v_and_b32 v20, 3, v0
  v_lshlrev_b32 v20, 7, v20
  v_add_u32 v44, s48, v20
  s_mov_b32 s48, 0x4000000
  s_add_u32 s60, s86, s48
  s_addc_u32 s61, s87, 0
  s_mov_b32 s62, 0x100000
  s_mov_b32 s63, 0x20000
  s_mul_i32 s48, s38, 0x3c000
  s_mul_i32 s49, s41, 0x140
  s_add_u32 s48, s48, s49
  s_add_u32 s32, s82, s48
  s_addc_u32 s33, s83, 0
  s_mov_b32 s34, 0x3bc40
  s_mov_b32 s35, 0x20000
  v_lshrrev_b32 v20, 3, v0
  s_lshl_b32 s48, s36, 3
  v_add_u32 v21, s48, v20
  v_and_b32 v22, 7, v0
  v_and_b32 v23, 6, v21
  v_xor_b32 v23, v23, v22
  v_lshlrev_b32 v24, 4, v23
  v_mul_u32_u24 v25, 0x180, v21
  v_add_u32 v14, v25, v24
  v_bfe_u32 v26, v21, 1, 3
  v_add_u32 v26, 6, v26
  v_and_b32 v26, 7, v26
  v_xor_b32 v26, v26, v22
  v_lshl_add_u32 v13, v26, 4, v25
  v_mul_u32_u24 v25, 0x500, v21
  v_add_u32 v15, v25, v24
  v_lshrrev_b32 v26, 2, v23
  v_lshlrev_b32 v26, 30, v26
  v_add_u32 v16, v15, v26
  v_lshrrev_b32 v20, 2, v0
  v_lshrrev_b32 v21, 3, v20
  v_mul_u32_u24 v21, 0xc00, v21
  v_and_b32 v22, 7, v20
  v_lshl_add_u32 v21, v22, 7, v21
  v_and_b32 v22, 3, v0
  v_lshl_add_u32 v21, v22, 3, v21
  v_bfe_u32 v22, v20, 1, 2
  v_xor_b32 v23, 0, v22
  v_lshl_add_u32 v4, v23, 5, v21
  v_xor_b32 v23, 1, v22
  v_lshl_add_u32 v5, v23, 5, v21
  v_xor_b32 v23, 2, v22
  v_lshl_add_u32 v6, v23, 5, v21
  v_xor_b32 v23, 3, v22
  v_lshl_add_u32 v7, v23, 5, v21
  v_and_b32 v20, 15, v0
  v_lshrrev_b32 v21, 1, v20
  v_add_u32 v21, 6, v21
  v_and_b32 v21, 7, v21
  v_lshrrev_b32 v22, 4, v0
  v_and_b32 v23, 7, v20
  v_lshlrev_b32 v23, 7, v23
  v_lshrrev_b32 v24, 3, v20
  v_lshl_add_u32 v25, v24, 10, v23
  v_add_u32 v25, s42, v25
  v_xor_b32 v26, v22, v21
  v_lshl_add_u32 v10, v26, 4, v25
  v_xor_b32 v11, 64, v10
  v_mul_u32_u24 v25, 0xc00, v24
  v_add_u32 v25, v25, v23
  v_and_b32 v26, 1, v22
  v_lshrrev_b32 v27, 1, v22
  v_lshl_add_u32 v26, v26, 1, v27
  v_xor_b32 v26, v26, v21
  v_lshl_add_u32 v8, v26, 4, v25
  v_xor_b32 v9, 64, v8
  s_add_u32 m0, s42, 0x6c00
  s_nop 0
  buffer_load_dwordx4 v18, s[4:7], s44 offen lds
  s_add_u32 s45, s57, 0xa000
  s_add_u32 m0, s42, 0x7000
  s_nop 0
  buffer_load_dwordx4 v17, s[4:7], s45 offen lds
  s_add_u32 s57, s57, 0x80
  s_cmp_eq_u32 s57, 0x500
  s_cselect_b32 s57, 0, s57
  s_add_u32 m0, s42, 0x7400
  s_nop 0
  buffer_load_dwordx4 v18, s[4:7], s45 offen lds
  s_mov_b32 s44, s56
  s_add_u32 m0, s37, 0x15000
  s_nop 0
  buffer_load_dwordx4 v12, s[8:11], s44 offen lds
  s_add_u32 s56, s56, 0x60000
  s_cmp_eq_u32 s56, 0x780000
  s_cselect_b32 s56, 0, s56
  s_add_u32 m0, s37, 0x15380
  s_nop 0
  buffer_load_dwordx4 v12, s[8:11], s44 offen offset:128 lds
  s_add_u32 m0, s37, 0x15700
  s_nop 0
  buffer_load_dwordx4 v12, s[8:11], s44 offen offset:256 lds
  s_mov_b32 s45, s56
  s_add_u32 m0, s37, 0x18000
  s_nop 0
  buffer_load_dwordx4 v12, s[8:11], s45 offen lds
  s_add_u32 s56, s56, 0x60000
  s_cmp_eq_u32 s56, 0x780000
  s_cselect_b32 s56, 0, s56
  s_add_u32 m0, s37, 0x18380
  s_nop 0
  buffer_load_dwordx4 v12, s[8:11], s45 offen offset:128 lds
  s_add_u32 m0, s37, 0x18700
  s_nop 0
  buffer_load_dwordx4 v12, s[8:11], s45 offen offset:256 lds
  s_mov_b64 exec, 0
  s_cmp_eq_u32 s36, 0
  s_cbranch_scc1 L_hop0
  s_cmp_eq_u32 s36, 1
  s_cbranch_scc1 L_hop1
  s_cmp_eq_u32 s36, 2
  s_cbranch_scc1 L_hop2
  s_branch L_hop3
L_maxpass:
  s_waitcnt vmcnt(0) lgkmcnt(0)
  s_nop 15
  v_and_b32 v136, 15, v0
  v_mul_u32_u24 v136, 0x180, v136
  v_lshrrev_b32 v140, 4, v0
  v_and_b32 v141, 1, v140
  v_lshrrev_b32 v140, 1, v140
  v_lshl_add_u32 v140, v141, 1, v140
  v_lshl_add_u32 v136, v140, 4, v136
  s_mov_b32 s53, 0
L_maxpass_loop:
  buffer_load_dwordx4 v[96:99], v136, s[12:15], s53 offen offset:0
  buffer_load_dwordx4 v[100:103], v136, s[12:15], s53 offen offset:64
  buffer_load_dwordx4 v[104:107], v136, s[12:15], s53 offen offset:128
  buffer_load_dwordx4 v[108:111], v136, s[12:15], s53 offen offset:192
  buffer_load_dwordx4 v[112:115], v136, s[12:15], s53 offen offset:256
  buffer_load_dwordx4 v[116:119], v136, s[12:15], s53 offen offset:320
  s_waitcnt vmcnt(0)
  v_mfma_f32_16x16x32_bf16 v[120:123], v[96:99], a[48:51], 0
  v_mfma_f32_16x16x32_bf16 v[120:123], v[100:103], a[60:63], v[120:123]
  v_mfma_f32_16x16x32_bf16 v[120:123], v[104:107], a[72:75], v[120:123]
  v_mfma_f32_16x16x32_bf16 v[120:123], v[108:111], a[84:87], v[120:123]
  v_mfma_f32_16x16x32_bf16 v[120:123], v[112:115], a[96:99], v[120:123]
  v_mfma_f32_16x16x32_bf16 v[120:123], v[116:119], a[108:111], v[120:123]
  v_mfma_f32_16x16x32_bf16 v[124:127], v[96:99], a[52:55], 0
  v_mfma_f32_16x16x32_bf16 v[124:127], v[100:103], a[64:67], v[124:127]
  v_mfma_f32_16x16x32_bf16 v[124:127], v[104:107], a[76:79], v[124:127]
  v_mfma_f32_16x16x32_bf16 v[124:127], v[108:111], a[88:91], v[124:127]
  v_mfma_f32_16x16x32_bf16 v[124:127], v[112:115], a[100:103], v[124:127]
  v_mfma_f32_16x16x32_bf16 v[124:127], v[116:119], a[112:115], v[124:127]
  v_mfma_f32_16x16x32_bf16 v[128:131], v[96:99], a[56:59], 0
  v_mfma_f32_16x16x32_bf16 v[128:131], v[100:103], a[68:71], v[128:131]
  v_mfma_f32_16x16x32_bf16 v[128:131], v[104:107], a[80:83], v[128:131]
  v_mfma_f32_16x16x32_bf16 v[128:131], v[108:111], a[92:95], v[128:131]
  v_mfma_f32_16x16x32_bf16 v[128:131], v[112:115], a[104:107], v[128:131]
  v_mfma_f32_16x16x32_bf16 v[128:131], v[116:119], a[116:119], v[128:131]
  s_nop 15
  v_max3_f32 v28, v28, v120, v121
  v_max3_f32 v28, v28, v122, v123
  v_max3_f32 v29, v29, v124, v125
  v_max3_f32 v29, v29, v126, v127
  v_max3_f32 v30, v30, v128, v129
  v_max3_f32 v30, v30, v130, v131
  s_add_u32 s53, s53, 0x1800
  s_cmp_lt_u32 s53, 196608
  s_cbranch_scc1 L_maxpass_loop
  v_mov_b32 v140, v28
  s_nop 1
  v_permlane32_swap_b32 v28, v140
  v_max_f32 v28, v28, v140
  v_mov_b32 v140, v28
  s_nop 1
  v_permlane16_swap_b32 v28, v140
  v_max_f32 v28, v28, v140
  v_mov_b32 v140, v29
  s_nop 1
  v_permlane32_swap_b32 v29, v140
  v_max_f32 v29, v29, v140
  v_mov_b32 v140, v29
  s_nop 1
  v_permlane16_swap_b32 v29, v140
  v_max_f32 v29, v29, v140
  v_mov_b32 v140, v30
  s_nop 1
  v_permlane32_swap_b32 v30, v140
  v_max_f32 v30, v30, v140
  v_mov_b32 v140, v30
  s_nop 1
  v_permlane16_swap_b32 v30, v140
  v_max_f32 v30, v30, v140
  s_nop 3
  s_branch L_maxpass_back
L_redo:
  s_cmp_lg_u32 s99, 0
  s_cbranch_scc1 L_redo_back
  s_waitcnt vmcnt(0) lgkmcnt(0)
  s_nop 15
  s_barrier
  s_mov_b32 s99, 1
  s_branch L_restart
L_poll1_0:
  s_mov_b32 s54, 0
L_poll1_0_loop:
  buffer_load_dword v31, v44, s[60:63], 0 offen sc1
  s_add_u32 s54, s54, 1
  s_cmp_gt_u32 s54, 0x200000
  s_waitcnt vmcnt(0)
  s_cbranch_scc1 L_poll1_0_back
  v_sub_u32 v31, v31, v46
  v_cmp_gt_u32 vcc, 1, v31
  s_nop 0
  s_cbranch_vccnz L_poll1_0_loop
  s_branch L_poll1_0_back
L_poll1_1:
  s_mov_b32 s54, 0
L_poll1_1_loop:
  buffer_load_dword v31, v44, s[60:63], 0 offen sc1
  s_add_u32 s54, s54, 1
  s_cmp_gt_u32 s54, 0x200000
  s_waitcnt vmcnt(0)
  s_cbranch_scc1 L_poll1_1_back
  v_sub_u32 v31, v31, v46
  v_cmp_gt_u32 vcc, 2, v31
  s_nop 0
  s_cbranch_vccnz L_poll1_1_loop
  s_branch L_poll1_1_back
L_poll1_2:
  s_mov_b32 s54, 0
L_poll1_2_loop:
  buffer_load_dword v31, v44, s[60:63], 0 offen sc1
  s_add_u32 s54, s54, 1
  s_cmp_gt_u32 s54, 0x200000
  s_waitcnt vmcnt(0)
  s_cbranch_scc1 L_poll1_2_back
  v_sub_u32 v31, v31, v46
  v_cmp_gt_u32 vcc, 3, v31
  s_nop 0
  s_cbranch_vccnz L_poll1_2_loop
  s_branch L_poll1_2_back
L_poll2a:
  s_mov_b32 s54, 0
L_poll2a_loop:
  buffer_load_dword v31, v45, s[60:63], 0 offen sc1
  s_add_u32 s54, s54, 1
  s_cmp_gt_u32 s54, 0x200000
  s_waitcnt vmcnt(0)
  s_cbranch_scc1 L_poll2a_back
  v_sub_u32 v31, v31, v47
  v_cmp_gt_u32 vcc, 1, v31
  s_nop 0
  s_cbranch_vccnz L_poll2a_loop
  s_branch L_poll2a_back
L_poll2b:
  s_mov_b32 s54, 0
L_poll2b_loop:
  buffer_load_dword v31, v45, s[60:63], 0 offen sc1
  s_add_u32 s54, s54, 1
  s_cmp_gt_u32 s54, 0x200000
  s_waitcnt vmcnt(0)
  s_cbranch_scc1 L_poll2b_back
  v_sub_u32 v31, v31, v47
  v_cmp_gt_u32 vcc, 2, v31
  s_nop 0
  s_cbranch_vccnz L_poll2b_loop
  s_branch L_poll2b_back
.p2align 12
L_hop_ret:
  s_mov_b64 exec, -1
  s_waitcnt vmcnt(12)
  s_barrier
  ds_read_b128 a[112:115], v10 offset:0
  ds_read_b128 a[116:119], v10 offset:2048
  ds_read_b128 a[120:123], v10 offset:4096
  ds_read_b128 a[124:127], v11 offset:0
  ds_read_b128 a[128:131], v11 offset:2048
  ds_read_b128 a[132:135], v11 offset:4096
  v_add_u32 v4, 0x12000, v4
  v_add_u32 v5, 0x12000, v5
  v_add_u32 v6, 0x12000, v6
  v_add_u32 v7, 0x12000, v7
  ds_read_b64_tr_b16 a[0:1], v4 offset:0
  ds_read_b64_tr_b16 a[2:3], v4 offset:6144
  ds_read_b64_tr_b16 a[4:5], v5 offset:0
  ds_read_b64_tr_b16 a[6:7], v5 offset:6144
  ds_read_b64_tr_b16 a[8:9], v6 offset:0
  ds_read_b64_tr_b16 a[10:11], v6 offset:6144
  s_waitcnt lgkmcnt(4)
  v_mfma_f32_16x16x32_bf16 v[96:99], a[0:3], a[112:115], 0
  s_nop 0
  ds_read_b64_tr_b16 a[12:13], v7 offset:0
  ds_read_b64_tr_b16 a[14:15], v7 offset:6144
  v_mfma_f32_16x16x32_bf16 v[100:103], a[0:3], a[116:119], 0
  s_add_u32 s44, s57, 0
  s_add_u32 m0, s42, 0xc000
  ds_read_b64_tr_b16 a[16:17], v4 offset:1024
  v_mfma_f32_16x16x32_bf16 v[104:107], a[0:3], a[120:123], 0
  s_waitcnt lgkmcnt(5)
  ds_read_b64_tr_b16 a[18:19], v4 offset:7168
  ds_read_b64_tr_b16 a[20:21], v5 offset:1024
  v_mfma_f32_16x16x32_bf16 v[116:119], a[4:7], a[120:123], 0
  buffer_load_dwordx4 v17, s[4:7], s44 offen lds
  v_mfma_f32_16x16x32_bf16 v[112:115], a[4:7], a[116:119], 0
  s_add_u32 m0, s42, 0xc400
  ds_read_b64_tr_b16 a[22:23], v5 offset:7168
  v_mfma_f32_16x16x32_bf16 v[108:111], a[4:7], a[112:115], 0
  s_waitcnt lgkmcnt(6)
  ds_read_b64_tr_b16 a[24:25], v6 offset:1024
  ds_read_b64_tr_b16 a[26:27], v6 offset:7168
  v_mfma_f32_16x16x32_bf16 v[120:123], a[8:11], a[112:115], 0
  buffer_load_dwordx4 v18, s[4:7], s44 offen lds
  v_mfma_f32_16x16x32_bf16 v[124:127], a[8:11], a[116:119], 0
  s_add_u32 s45, s57, 0x5000
  s_add_u32 m0, s42, 0xc800
  v_mfma_f32_16x16x32_bf16 v[128:131], a[8:11], a[120:123], 0
  s_waitcnt lgkmcnt(6)
  ds_read_b64_tr_b16 a[28:29], v7 offset:1024
  ds_read_b64_tr_b16 a[30:31], v7 offset:7168
  v_mfma_f32_16x16x32_bf16 v[140:143], a[12:15], a[120:123], 0
  buffer_load_dwordx4 v17, s[4:7], s45 offen lds
  v_mfma_f32_16x16x32_bf16 v[136:139], a[12:15], a[116:119], 0
  s_add_u32 m0, s42, 0xcc00
  v_mfma_f32_16x16x32_bf16 v[132:135], a[12:15], a[112:115], 0
  s_waitcnt lgkmcnt(6)
  ds_read_b64_tr_b16 a[32:33], v4 offset:2048
  ds_read_b64_tr_b16 a[34:35], v4 offset:8192
  v_mfma_f32_16x16x32_bf16 v[144:147], a[16:19], a[112:115], 0
  buffer_load_dwordx4 v18, s[4:7], s45 offen lds
  v_mfma_f32_16x16x32_bf16 v[148:151], a[16:19], a[116:119], 0
  s_add_u32 s44, s57, 0xa000
  s_add_u32 m0, s42, 0xd000
  v_mfma_f32_16x16x32_bf16 v[152:155], a[16:19], a[120:123], 0
  s_waitcnt lgkmcnt(6)
  ds_read_b64_tr_b16 a[36:37], v5 offset:2048
  ds_read_b64_tr_b16 a[38:39], v5 offset:8192
  v_mfma_f32_16x16x32_bf16 v[164:167], a[20:23], a[120:123], 0
  buffer_load_dwordx4 v17, s[4:7], s44 offen lds
  v_mfma_f32_16x16x32_bf16 v[160:163], a[20:23], a[116:119], 0
  s_add_u32 s57, s57, 0x80
  s_cmp_eq_u32 s57, 0x500
  s_cselect_b32 s57, 0, s57
  v_mfma_f32_16x16x32_bf16 v[156:159], a[20:23], a[112:115], 0
  s_waitcnt lgkmcnt(6)
  s_add_u32 m0, s42, 0xd400
  ds_read_b64_tr_b16 a[40:41], v6 offset:2048
  v_mfma_f32_16x16x32_bf16 v[168:171], a[24:27], a[112:115], 0
  buffer_load_dwordx4 v18, s[4:7], s44 offen lds
  v_mfma_f32_16x16x32_bf16 v[172:175], a[24:27], a[116:119], 0
  s_mov_b32 s45, s56
  s_add_u32 m0, s37, 0x1b000
  ds_read_b64_tr_b16 a[42:43], v6 offset:8192
  v_mfma_f32_16x16x32_bf16 v[176:179], a[24:27], a[120:123], 0
  s_waitcnt lgkmcnt(6)
  ds_read_b64_tr_b16 a[44:45], v7 offset:2048
  ds_read_b64_tr_b16 a[46:47], v7 offset:8192
  v_mfma_f32_16x16x32_bf16 v[188:191], a[28:31], a[120:123], 0
  buffer_load_dwordx4 v12, s[8:11], s45 offen lds
  v_mfma_f32_16x16x32_bf16 v[184:187], a[28:31], a[116:119], 0
  s_waitcnt vmcnt(10)
  s_barrier
  v_mfma_f32_16x16x32_bf16 v[180:183], a[28:31], a[112:115], 0
  s_waitcnt lgkmcnt(6)
  ds_read_b64_tr_b16 a[0:1], v4 offset:12288
  ds_read_b64_tr_b16 a[2:3], v4 offset:18432
  v_mfma_f32_16x16x32_bf16 v[192:195], a[32:35], a[112:115], 0
  s_add_u32 s56, s56, 0x60000
  s_cmp_eq_u32 s56, 0x780000
  s_cselect_b32 s56, 0, s56
  v_mfma_f32_16x16x32_bf16 v[196:199], a[32:35], a[116:119], 0
  s_add_u32 m0, s37, 0x1b380
  v_mfma_f32_16x16x32_bf16 v[200:203], a[32:35], a[120:123], 0
  s_waitcnt lgkmcnt(6)
  ds_read_b64_tr_b16 a[4:5], v5 offset:12288
  ds_read_b64_tr_b16 a[6:7], v5 offset:18432
  v_mfma_f32_16x16x32_bf16 v[212:215], a[36:39], a[120:123], 0
  buffer_load_dwordx4 v12, s[8:11], s45 offen offset:128 lds
  v_mfma_f32_16x16x32_bf16 v[208:211], a[36:39], a[116:119], 0
  s_add_u32 m0, s37, 0x1b700
  v_mfma_f32_16x16x32_bf16 v[204:207], a[36:39], a[112:115], 0
  s_waitcnt lgkmcnt(6)
  ds_read_b64_tr_b16 a[8:9], v6 offset:12288
  ds_read_b64_tr_b16 a[10:11], v6 offset:18432
  v_mfma_f32_16x16x32_bf16 v[216:219], a[40:43], a[112:115], 0
  buffer_load_dwordx4 v12, s[8:11], s45 offen offset:256 lds
  v_mfma_f32_16x16x32_bf16 v[220:223], a[40:43], a[116:119], 0
  v_mfma_f32_16x16x32_bf16 v[224:227], a[40:43], a[120:123], 0
  s_waitcnt lgkmcnt(6)
  ds_read_b64_tr_b16 a[12:13], v7 offset:12288
  ds_read_b64_tr_b16 a[14:15], v7 offset:18432
  v_mfma_f32_16x16x32_bf16 v[236:239], a[44:47], a[120:123], 0
  v_mfma_f32_16x16x32_bf16 v[232:235], a[44:47], a[116:119], 0
  v_mfma_f32_16x16x32_bf16 v[228:231], a[44:47], a[112:115], 0
  s_waitcnt lgkmcnt(6)
  ds_read_b64_tr_b16 a[16:17], v4 offset:13312
  ds_read_b64_tr_b16 a[18:19], v4 offset:19456
  v_mfma_f32_16x16x32_bf16 v[96:99], a[0:3], a[124:127], v[96:99]
  s_nop 0
  ds_read_b128 a[136:139], v10 offset:24576
  ds_read_b128 a[140:143], v10 offset:26624
  v_mfma_f32_16x16x32_bf16 v[100:103], a[0:3], a[128:131], v[100:103]
  s_nop 0
  ds_read_b128 a[144:147], v10 offset:28672
  ds_read_b128 a[148:151], v11 offset:24576
  v_mfma_f32_16x16x32_bf16 v[104:107], a[0:3], a[132:135], v[104:107]
  s_waitcnt lgkmcnt(10)
  ds_read_b64_tr_b16 a[20:21], v5 offset:13312
  ds_read_b64_tr_b16 a[22:23], v5 offset:19456
  v_mfma_f32_16x16x32_bf16 v[116:119], a[4:7], a[132:135], v[116:119]
  s_nop 0
  ds_read_b128 a[152:155], v11 offset:26624
  ds_read_b128 a[156:159], v11 offset:28672
  v_mfma_f32_16x16x32_bf16 v[112:115], a[4:7], a[128:131], v[112:115]
  v_mfma_f32_16x16x32_bf16 v[108:111], a[4:7], a[124:127], v[108:111]
  s_waitcnt lgkmcnt(12)
  ds_read_b64_tr_b16 a[24:25], v6 offset:13312
  ds_read_b64_tr_b16 a[26:27], v6 offset:19456
  v_mfma_f32_16x16x32_bf16 v[120:123], a[8:11], a[124:127], v[120:123]
  v_mfma_f32_16x16x32_bf16 v[124:127], a[8:11], a[128:131], v[124:127]
  v_mfma_f32_16x16x32_bf16 v[128:131], a[8:11], a[132:135], v[128:131]
  s_waitcnt lgkmcnt(12)
  ds_read_b64_tr_b16 a[28:29], v7 offset:13312
  ds_read_b64_tr_b16 a[30:31], v7 offset:19456
  v_mfma_f32_16x16x32_bf16 v[140:143], a[12:15], a[132:135], v[140:143]
  v_mfma_f32_16x16x32_bf16 v[136:139], a[12:15], a[128:131], v[136:139]
  v_mfma_f32_16x16x32_bf16 v[132:135], a[12:15], a[124:127], v[132:135]
  s_waitcnt lgkmcnt(12)
  ds_read_b64_tr_b16 a[32:33], v4 offset:14336
  ds_read_b64_tr_b16 a[34:35], v4 offset:20480
  v_mfma_f32_16x16x32_bf16 v[144:147], a[16:19], a[124:127], v[144:147]
  v_mfma_f32_16x16x32_bf16 v[148:151], a[16:19], a[128:131], v[148:151]
  s_mov_b32 s44, s56
  s_add_u32 m0, s37, 0x1e000
  v_mfma_f32_16x16x32_bf16 v[152:155], a[16:19], a[132:135], v[152:155]
  s_waitcnt lgkmcnt(8)
  ds_read_b64_tr_b16 a[36:37], v5 offset:14336
  ds_read_b64_tr_b16 a[38:39], v5 offset:20480
  v_mfma_f32_16x16x32_bf16 v[164:167], a[20:23], a[132:135], v[164:167]
  buffer_load_dwordx4 v12, s[8:11], s44 offen lds
  v_mfma_f32_16x16x32_bf16 v[160:163], a[20:23], a[128:131], v[160:163]
  s_add_u32 s56, s56, 0x60000
  s_cmp_eq_u32 s56, 0x780000
  s_cselect_b32 s56, 0, s56
  v_mfma_f32_16x16x32_bf16 v[156:159], a[20:23], a[124:127], v[156:159]
  s_waitcnt lgkmcnt(6)
  s_add_u32 m0, s37, 0x1e380
  ds_read_b64_tr_b16 a[40:41], v6 offset:14336
  v_mfma_f32_16x16x32_bf16 v[168:171], a[24:27], a[124:127], v[168:171]
  buffer_load_dwordx4 v12, s[8:11], s44 offen offset:128 lds
  v_mfma_f32_16x16x32_bf16 v[172:175], a[24:27], a[128:131], v[172:175]
  s_add_u32 m0, s37, 0x1e700
  ds_read_b64_tr_b16 a[42:43], v6 offset:20480
  v_mfma_f32_16x16x32_bf16 v[176:179], a[24:27], a[132:135], v[176:179]
  s_waitcnt lgkmcnt(6)
  ds_read_b64_tr_b16 a[44:45], v7 offset:14336
  ds_read_b64_tr_b16 a[46:47], v7 offset:20480
  v_mfma_f32_16x16x32_bf16 v[188:191], a[28:31], a[132:135], v[188:191]
  buffer_load_dwordx4 v12, s[8:11], s44 offen offset:256 lds
  v_mfma_f32_16x16x32_bf16 v[184:187], a[28:31], a[128:131], v[184:187]
  s_waitcnt vmcnt(12)
  s_barrier
  v_mfma_f32_16x16x32_bf16 v[180:183], a[28:31], a[124:127], v[180:183]
  s_waitcnt lgkmcnt(6)
  ds_read_b64_tr_b16 a[0:1], v4 offset:24576
  ds_read_b64_tr_b16 a[2:3], v4 offset:30720
  v_mfma_f32_16x16x32_bf16 v[192:195], a[32:35], a[124:127], v[192:195]
  v_mfma_f32_16x16x32_bf16 v[196:199], a[32:35], a[128:131], v[196:199]
  v_mfma_f32_16x16x32_bf16 v[200:203], a[32:35], a[132:135], v[200:203]
  s_waitcnt lgkmcnt(6)
  ds_read_b64_tr_b16 a[4:5], v5 offset:24576
  ds_read_b64_tr_b16 a[6:7], v5 offset:30720
  v_mfma_f32_16x16x32_bf16 v[212:215], a[36:39], a[132:135], v[212:215]
  v_mfma_f32_16x16x32_bf16 v[208:211], a[36:39], a[128:131], v[208:211]
  v_mfma_f32_16x16x32_bf16 v[204:207], a[36:39], a[124:127], v[204:207]
  s_waitcnt lgkmcnt(6)
  ds_read_b64_tr_b16 a[8:9], v6 offset:24576
  ds_read_b64_tr_b16 a[10:11], v6 offset:30720
  v_mfma_f32_16x16x32_bf16 v[216:219], a[40:43], a[124:127], v[216:219]
  v_mfma_f32_16x16x32_bf16 v[220:223], a[40:43], a[128:131], v[220:223]
  v_mfma_f32_16x16x32_bf16 v[224:227], a[40:43], a[132:135], v[224:227]
  s_waitcnt lgkmcnt(6)
  ds_read_b64_tr_b16 a[12:13], v7 offset:24576
  ds_read_b64_tr_b16 a[14:15], v7 offset:30720
  v_mfma_f32_16x16x32_bf16 v[236:239], a[44:47], a[132:135], v[236:239]
  v_mfma_f32_16x16x32_bf16 v[232:235], a[44:47], a[128:131], v[232:235]
  v_mfma_f32_16x16x32_bf16 v[228:231], a[44:47], a[124:127], v[228:231]
  s_waitcnt lgkmcnt(6)
  ds_read_b64_tr_b16 a[16:17], v4 offset:25600
  ds_read_b64_tr_b16 a[18:19], v4 offset:31744
  v_mfma_f32_16x16x32_bf16 v[96:99], a[0:3], a[136:139], v[96:99]
  v_mfma_f32_16x16x32_bf16 v[100:103], a[0:3], a[140:143], v[100:103]
  s_add_u32 s45, s57, 0
  s_add_u32 m0, s42, 0
  v_mfma_f32_16x16x32_bf16 v[104:107], a[0:3], a[144:147], v[104:107]
  s_waitcnt lgkmcnt(6)
  ds_read_b64_tr_b16 a[20:21], v5 offset:25600
  ds_read_b64_tr_b16 a[22:23], v5 offset:31744
  v_mfma_f32_16x16x32_bf16 v[116:119], a[4:7], a[144:147], v[116:119]
  buffer_load_dwordx4 v17, s[4:7], s45 offen lds
  v_mfma_f32_16x16x32_bf16 v[112:115], a[4:7], a[140:143], v[112:115]
  s_add_u32 m0, s42, 0x400
  v_mfma_f32_16x16x32_bf16 v[108:111], a[4:7], a[136:139], v[108:111]
  s_waitcnt lgkmcnt(6)
  ds_read_b64_tr_b16 a[24:25], v6 offset:25600
  ds_read_b64_tr_b16 a[26:27], v6 offset:31744
  v_mfma_f32_16x16x32_bf16 v[120:123], a[8:11], a[136:139], v[120:123]
  buffer_load_dwordx4 v18, s[4:7], s45 offen lds
  v_mfma_f32_16x16x32_bf16 v[124:127], a[8:11], a[140:143], v[124:127]
  s_add_u32 s44, s57, 0x5000
  s_add_u32 m0, s42, 0x800
  v_mfma_f32_16x16x32_bf16 v[128:131], a[8:11], a[144:147], v[128:131]
  s_waitcnt lgkmcnt(6)
  ds_read_b64_tr_b16 a[28:29], v7 offset:25600
  ds_read_b64_tr_b16 a[30:31], v7 offset:31744
  v_mfma_f32_16x16x32_bf16 v[140:143], a[12:15], a[144:147], v[140:143]
  buffer_load_dwordx4 v17, s[4:7], s44 offen lds
  v_mfma_f32_16x16x32_bf16 v[136:139], a[12:15], a[140:143], v[136:139]
  s_add_u32 m0, s42, 0xc00
  v_mfma_f32_16x16x32_bf16 v[132:135], a[12:15], a[136:139], v[132:135]
  s_waitcnt lgkmcnt(6)
  ds_read_b64_tr_b16 a[32:33], v4 offset:26624
  ds_read_b64_tr_b16 a[34:35], v4 offset:32768
  v_mfma_f32_16x16x32_bf16 v[144:147], a[16:19], a[136:139], v[144:147]
  buffer_load_dwordx4 v18, s[4:7], s44 offen lds
  v_mfma_f32_16x16x32_bf16 v[148:151], a[16:19], a[140:143], v[148:151]
  s_add_u32 s45, s57, 0xa000
  s_add_u32 m0, s42, 0x1000
  v_mfma_f32_16x16x32_bf16 v[152:155], a[16:19], a[144:147], v[152:155]
  s_waitcnt lgkmcnt(6)
  ds_read_b64_tr_b16 a[36:37], v5 offset:26624
  ds_read_b64_tr_b16 a[38:39], v5 offset:32768
  v_mfma_f32_16x16x32_bf16 v[164:167], a[20:23], a[144:147], v[164:167]
  buffer_load_dwordx4 v17, s[4:7], s45 offen lds
  v_mfma_f32_16x16x32_bf16 v[160:163], a[20:23], a[140:143], v[160:163]
  s_add_u32 s57, s57, 0x80
  s_cmp_eq_u32 s57, 0x500
  s_cselect_b32 s57, 0, s57
  v_mfma_f32_16x16x32_bf16 v[156:159], a[20:23], a[136:139], v[156:159]
  s_waitcnt lgkmcnt(6)
  s_add_u32 m0, s42, 0x1400
  ds_read_b64_tr_b16 a[40:41], v6 offset:26624
  v_mfma_f32_16x16x32_bf16 v[168:171], a[24:27], a[136:139], v[168:171]
  buffer_load_dwordx4 v18, s[4:7], s45 offen lds
  v_mfma_f32_16x16x32_bf16 v[172:175], a[24:27], a[140:143], v[172:175]
  s_mov_b32 s44, s56
  s_add_u32 m0, s37, 0x21000
  ds_read_b64_tr_b16 a[42:43], v6 offset:32768
  v_mfma_f32_16x16x32_bf16 v[176:179], a[24:27], a[144:147], v[176:179]
  s_waitcnt lgkmcnt(6)
  ds_read_b64_tr_b16 a[44:45], v7 offset:26624
  ds_read_b64_tr_b16 a[46:47], v7 offset:32768
  v_mfma_f32_16x16x32_bf16 v[188:191], a[28:31], a[144:147], v[188:191]
  buffer_load_dwordx4 v12, s[8:11], s44 offen lds
  v_mfma_f32_16x16x32_bf16 v[184:187], a[28:31], a[140:143], v[184:187]
  s_waitcnt vmcnt(10)
  s_barrier
  v_mfma_f32_16x16x32_bf16 v[180:183], a[28:31], a[136:139], v[180:183]
  s_waitcnt lgkmcnt(6)
  ds_read_b64_tr_b16 a[0:1], v4 offset:36864
  ds_read_b64_tr_b16 a[2:3], v4 offset:43008
  v_mfma_f32_16x16x32_bf16 v[192:195], a[32:35], a[136:139], v[192:195]
  s_add_u32 s56, s56, 0x60000
  s_cmp_eq_u32 s56, 0x780000
  s_cselect_b32 s56, 0, s56
  v_mfma_f32_16x16x32_bf16 v[196:199], a[32:35], a[140:143], v[196:199]
  s_add_u32 m0, s37, 0x21380
  v_mfma_f32_16x16x32_bf16 v[200:203], a[32:35], a[144:147], v[200:203]
  s_waitcnt lgkmcnt(6)
  ds_read_b64_tr_b16 a[4:5], v5 offset:36864
  ds_read_b64_tr_b16 a[6:7], v5 offset:43008
  v_mfma_f32_16x16x32_bf16 v[212:215], a[36:39], a[144:147], v[212:215]
  buffer_load_dwordx4 v12, s[8:11], s44 offen offset:128 lds
  v_mfma_f32_16x16x32_bf16 v[208:211], a[36:39], a[140:143], v[208:211]
  s_add_u32 m0, s37, 0x21700
  v_mfma_f32_16x16x32_bf16 v[204:207], a[36:39], a[136:139], v[204:207]
  s_waitcnt lgkmcnt(6)
  ds_read_b64_tr_b16 a[8:9], v6 offset:36864
  ds_read_b64_tr_b16 a[10:11], v6 offset:43008
  v_mfma_f32_16x16x32_bf16 v[216:219], a[40:43], a[136:139], v[216:219]
  buffer_load_dwordx4 v12, s[8:11], s44 offen offset:256 lds
  v_mfma_f32_16x16x32_bf16 v[220:223], a[40:43], a[140:143], v[220:223]
  v_mfma_f32_16x16x32_bf16 v[224:227], a[40:43], a[144:147], v[224:227]
  s_waitcnt lgkmcnt(6)
  ds_read_b64_tr_b16 a[12:13], v7 offset:36864
  ds_read_b64_tr_b16 a[14:15], v7 offset:43008
  v_mfma_f32_16x16x32_bf16 v[236:239], a[44:47], a[144:147], v[236:239]
  v_mfma_f32_16x16x32_bf16 v[232:235], a[44:47], a[140:143], v[232:235]
  v_mfma_f32_16x16x32_bf16 v[228:231], a[44:47], a[136:139], v[228:231]
  s_waitcnt lgkmcnt(6)
  ds_read_b64_tr_b16 a[16:17], v4 offset:37888
  ds_read_b64_tr_b16 a[18:19], v4 offset:44032
  v_mfma_f32_16x16x32_bf16 v[96:99], a[0:3], a[148:151], v[96:99]
  s_nop 0
  ds_read_b128 a[160:163], v10 offset:49152
  ds_read_b128 a[164:167], v10 offset:51200
  v_mfma_f32_16x16x32_bf16 v[100:103], a[0:3], a[152:155], v[100:103]
  s_nop 0
  ds_read_b128 a[168:171], v10 offset:53248
  ds_read_b128 a[172:175], v11 offset:49152
  v_mfma_f32_16x16x32_bf16 v[104:107], a[0:3], a[156:159], v[104:107]
  s_waitcnt lgkmcnt(10)
  ds_read_b64_tr_b16 a[20:21], v5 offset:37888
  ds_read_b64_tr_b16 a[22:23], v5 offset:44032
  v_mfma_f32_16x16x32_bf16 v[116:119], a[4:7], a[156:159], v[116:119]
  s_nop 0
  ds_read_b128 a[176:179], v11 offset:51200
  ds_read_b128 a[180:183], v11 offset:53248
  v_mfma_f32_16x16x32_bf16 v[112:115], a[4:7], a[152:155], v[112:115]
  v_mfma_f32_16x16x32_bf16 v[108:111], a[4:7], a[148:151], v[108:111]
  s_waitcnt lgkmcnt(12)
  ds_read_b64_tr_b16 a[24:25], v6 offset:37888
  ds_read_b64_tr_b16 a[26:27], v6 offset:44032
  v_mfma_f32_16x16x32_bf16 v[120:123], a[8:11], a[148:151], v[120:123]
  v_mfma_f32_16x16x32_bf16 v[124:127], a[8:11], a[152:155], v[124:127]
  v_mfma_f32_16x16x32_bf16 v[128:131], a[8:11], a[156:159], v[128:131]
  s_waitcnt lgkmcnt(12)
  ds_read_b64_tr_b16 a[28:29], v7 offset:37888
  ds_read_b64_tr_b16 a[30:31], v7 offset:44032
  v_mfma_f32_16x16x32_bf16 v[140:143], a[12:15], a[156:159], v[140:143]
  v_mfma_f32_16x16x32_bf16 v[136:139], a[12:15], a[152:155], v[136:139]
  v_mfma_f32_16x16x32_bf16 v[132:135], a[12:15], a[148:151], v[132:135]
  s_waitcnt lgkmcnt(12)
  ds_read_b64_tr_b16 a[32:33], v4 offset:38912
  ds_read_b64_tr_b16 a[34:35], v4 offset:45056
  v_mfma_f32_16x16x32_bf16 v[144:147], a[16:19], a[148:151], v[144:147]
  v_mfma_f32_16x16x32_bf16 v[148:151], a[16:19], a[152:155], v[148:151]
  s_add_u32 s45, s57, 0
  s_add_u32 m0, s42, 0x6000
  v_mfma_f32_16x16x32_bf16 v[152:155], a[16:19], a[156:159], v[152:155]
  s_waitcnt lgkmcnt(8)
  ds_read_b64_tr_b16 a[36:37], v5 offset:38912
  ds_read_b64_tr_b16 a[38:39], v5 offset:45056
  v_mfma_f32_16x16x32_bf16 v[164:167], a[20:23], a[156:159], v[164:167]
  buffer_load_dwordx4 v17, s[4:7], s45 offen lds
  v_mfma_f32_16x16x32_bf16 v[160:163], a[20:23], a[152:155], v[160:163]
  s_add_u32 m0, s42, 0x6400
  v_mfma_f32_16x16x32_bf16 v[156:159], a[20:23], a[148:151], v[156:159]
  s_waitcnt lgkmcnt(6)
  ds_read_b64_tr_b16 a[40:41], v6 offset:38912
  ds_read_b64_tr_b16 a[42:43], v6 offset:45056
  v_mfma_f32_16x16x32_bf16 v[168:171], a[24:27], a[148:151], v[168:171]
  buffer_load_dwordx4 v18, s[4:7], s45 offen lds
  v_mfma_f32_16x16x32_bf16 v[172:175], a[24:27], a[152:155], v[172:175]
  s_add_u32 s44, s57, 0x5000
  s_add_u32 m0, s42, 0x6800
  v_mfma_f32_16x16x32_bf16 v[176:179], a[24:27], a[156:159], v[176:179]
  s_waitcnt lgkmcnt(6)
  ds_read_b64_tr_b16 a[44:45], v7 offset:38912
  ds_read_b64_tr_b16 a[46:47], v7 offset:45056
  v_mfma_f32_16x16x32_bf16 v[188:191], a[28:31], a[156:159], v[188:191]
  buffer_load_dwordx4 v17, s[4:7], s44 offen lds
  v_mfma_f32_16x16x32_bf16 v[184:187], a[28:31], a[152:155], v[184:187]
  s_waitcnt vmcnt(12)
  s_barrier
  v_mfma_f32_16x16x32_bf16 v[180:183], a[28:31], a[148:151], v[180:183]
  s_waitcnt lgkmcnt(6)
  s_add_u32 m0, s42, 0x6c00
  ds_read_b64_tr_b16 a[0:1], v4 offset:49152
  v_mfma_f32_16x16x32_bf16 v[192:195], a[32:35], a[148:151], v[192:195]
  buffer_load_dwordx4 v18, s[4:7], s44 offen lds
  v_mfma_f32_16x16x32_bf16 v[196:199], a[32:35], a[152:155], v[196:199]
  ds_read_b64_tr_b16 a[2:3], v4 offset:55296
  v_mfma_f32_16x16x32_bf16 v[200:203], a[32:35], a[156:159], v[200:203]
  s_waitcnt lgkmcnt(6)
  s_add_u32 s45, s57, 0xa000
  s_add_u32 m0, s42, 0x7000
  v_mfma_f32_16x16x32_bf16 v[212:215], a[36:39], a[156:159], v[212:215]
  buffer_load_dwordx4 v17, s[4:7], s45 offen lds
  v_mfma_f32_16x16x32_bf16 v[208:211], a[36:39], a[152:155], v[208:211]
  s_nop 0
  ds_read_b64_tr_b16 a[4:5], v5 offset:49152
  ds_read_b64_tr_b16 a[6:7], v5 offset:55296
  v_mfma_f32_16x16x32_bf16 v[204:207], a[36:39], a[148:151], v[204:207]
  s_waitcnt lgkmcnt(6)
  ds_read_b64_tr_b16 a[8:9], v6 offset:49152
  ds_read_b64_tr_b16 a[10:11], v6 offset:55296
  v_mfma_f32_16x16x32_bf16 v[216:219], a[40:43], a[148:151], v[216:219]
  s_add_u32 s57, s57, 0x80
  s_cmp_eq_u32 s57, 0x500
  s_cselect_b32 s57, 0, s57
  v_mfma_f32_16x16x32_bf16 v[220:223], a[40:43], a[152:155], v[220:223]
  s_add_u32 m0, s42, 0x7400
  v_mfma_f32_16x16x32_bf16 v[224:227], a[40:43], a[156:159], v[224:227]
  s_waitcnt lgkmcnt(6)
  ds_read_b64_tr_b16 a[12:13], v7 offset:49152
  ds_read_b64_tr_b16 a[14:15], v7 offset:55296
  v_mfma_f32_16x16x32_bf16 v[236:239], a[44:47], a[156:159], v[236:239]
  buffer_load_dwordx4 v18, s[4:7], s45 offen lds
  v_mfma_f32_16x16x32_bf16 v[232:235], a[44:47], a[152:155], v[232:235]
  s_mov_b32 s44, s56
  s_add_u32 m0, s37, 0x24000
  v_mfma_f32_16x16x32_bf16 v[228:231], a[44:47], a[148:151], v[228:231]
  s_waitcnt lgkmcnt(6)
  ds_read_b64_tr_b16 a[16:17], v4 offset:50176
  ds_read_b64_tr_b16 a[18:19], v4 offset:56320
  v_mfma_f32_16x16x32_bf16 v[96:99], a[0:3], a[160:163], v[96:99]
  buffer_load_dwordx4 v12, s[8:11], s44 offen lds
  v_mfma_f32_16x16x32_bf16 v[100:103], a[0:3], a[164:167], v[100:103]
  s_add_u32 s56, s56, 0x60000
  s_cmp_eq_u32 s56, 0x780000
  s_cselect_b32 s56, 0, s56
  v_mfma_f32_16x16x32_bf16 v[104:107], a[0:3], a[168:171], v[104:107]
  s_waitcnt lgkmcnt(6)
  s_add_u32 m0, s37, 0x24380
  ds_read_b64_tr_b16 a[20:21], v5 offset:50176
  v_mfma_f32_16x16x32_bf16 v[116:119], a[4:7], a[168:171], v[116:119]
  buffer_load_dwordx4 v12, s[8:11], s44 offen offset:128 lds
  v_mfma_f32_16x16x32_bf16 v[112:115], a[4:7], a[164:167], v[112:115]
  s_add_u32 m0, s37, 0x24700
  ds_read_b64_tr_b16 a[22:23], v5 offset:56320
  v_mfma_f32_16x16x32_bf16 v[108:111], a[4:7], a[160:163], v[108:111]
  s_waitcnt lgkmcnt(6)
  ds_read_b64_tr_b16 a[24:25], v6 offset:50176
  ds_read_b64_tr_b16 a[26:27], v6 offset:56320
  v_mfma_f32_16x16x32_bf16 v[120:123], a[8:11], a[160:163], v[120:123]
  buffer_load_dwordx4 v12, s[8:11], s44 offen offset:256 lds
  v_mfma_f32_16x16x32_bf16 v[124:127], a[8:11], a[164:167], v[124:127]
  v_mfma_f32_16x16x32_bf16 v[128:131], a[8:11], a[168:171], v[128:131]
  s_waitcnt lgkmcnt(6)
  s_add_u32 s45, s57, 0
  s_add_u32 m0, s42, 0xc000
  v_mfma_f32_16x16x32_bf16 v[140:143], a[12:15], a[168:171], v[140:143]
  buffer_load_dwordx4 v17, s[4:7], s45 offen lds
  v_mfma_f32_16x16x32_bf16 v[136:139], a[12:15], a[164:167], v[136:139]
  s_nop 0
  ds_read_b64_tr_b16 a[28:29], v7 offset:50176
  ds_read_b64_tr_b16 a[30:31], v7 offset:56320
  v_mfma_f32_16x16x32_bf16 v[132:135], a[12:15], a[160:163], v[132:135]
  s_waitcnt lgkmcnt(6)
  s_add_u32 m0, s42, 0xc400
  ds_read_b64_tr_b16 a[32:33], v4 offset:51200
  v_mfma_f32_16x16x32_bf16 v[144:147], a[16:19], a[160:163], v[144:147]
  buffer_load_dwordx4 v18, s[4:7], s45 offen lds
  v_mfma_f32_16x16x32_bf16 v[148:151], a[16:19], a[164:167], v[148:151]
  ds_read_b64_tr_b16 a[34:35], v4 offset:57344
  v_mfma_f32_16x16x32_bf16 v[152:155], a[16:19], a[168:171], v[152:155]
  s_waitcnt lgkmcnt(6)
  ds_read_b64_tr_b16 a[36:37], v5 offset:51200
  ds_read_b64_tr_b16 a[38:39], v5 offset:57344
  v_mfma_f32_16x16x32_bf16 v[164:167], a[20:23], a[168:171], v[164:167]
  s_add_u32 s44, s57, 0x5000
  s_add_u32 m0, s42, 0xc800
  v_mfma_f32_16x16x32_bf16 v[160:163], a[20:23], a[164:167], v[160:163]
  buffer_load_dwordx4 v17, s[4:7], s44 offen lds
  v_mfma_f32_16x16x32_bf16 v[156:159], a[20:23], a[160:163], v[156:159]
  s_waitcnt lgkmcnt(6)
  ds_read_b64_tr_b16 a[40:41], v6 offset:51200
  ds_read_b64_tr_b16 a[42:43], v6 offset:57344
  v_mfma_f32_16x16x32_bf16 v[168:171], a[24:27], a[160:163], v[168:171]
  v_mfma_f32_16x16x32_bf16 v[172:175], a[24:27], a[164:167], v[172:175]
  v_mfma_f32_16x16x32_bf16 v[176:179], a[24:27], a[168:171], v[176:179]
  s_waitcnt lgkmcnt(6)
  ds_read_b64_tr_b16 a[44:45], v7 offset:51200
  ds_read_b64_tr_b16 a[46:47], v7 offset:57344
  v_mfma_f32_16x16x32_bf16 v[188:191], a[28:31], a[168:171], v[188:191]
  v_add_u32 v4, 0xf000, v4
  v_add_u32 v5, 0xf000, v5
  v_mfma_f32_16x16x32_bf16 v[184:187], a[28:31], a[164:167], v[184:187]
  s_waitcnt vmcnt(12)
  s_barrier
  v_add_u32 v6, 0xf000, v6
  v_mfma_f32_16x16x32_bf16 v[180:183], a[28:31], a[160:163], v[180:183]
  s_waitcnt lgkmcnt(6)
  s_add_u32 m0, s42, 0xcc00
  v_add_u32 v7, 0xf000, v7
  v_mfma_f32_16x16x32_bf16 v[192:195], a[32:35], a[160:163], v[192:195]
  buffer_load_dwordx4 v18, s[4:7], s44 offen lds
  v_mfma_f32_16x16x32_bf16 v[196:199], a[32:35], a[164:167], v[196:199]
  s_nop 0
  ds_read_b64_tr_b16 a[0:1], v4 offset:0
  ds_read_b64_tr_b16 a[2:3], v4 offset:6144
  v_mfma_f32_16x16x32_bf16 v[200:203], a[32:35], a[168:171], v[200:203]
  s_waitcnt lgkmcnt(6)
  s_add_u32 s45, s57, 0xa000
  s_add_u32 m0, s42, 0xd000
  v_mfma_f32_16x16x32_bf16 v[212:215], a[36:39], a[168:171], v[212:215]
  buffer_load_dwordx4 v17, s[4:7], s45 offen lds
  v_mfma_f32_16x16x32_bf16 v[208:211], a[36:39], a[164:167], v[208:211]
  s_nop 0
  ds_read_b64_tr_b16 a[4:5], v5 offset:0
  ds_read_b64_tr_b16 a[6:7], v5 offset:6144
  v_mfma_f32_16x16x32_bf16 v[204:207], a[36:39], a[160:163], v[204:207]
  s_waitcnt lgkmcnt(6)
  ds_read_b64_tr_b16 a[8:9], v6 offset:0
  ds_read_b64_tr_b16 a[10:11], v6 offset:6144
  v_mfma_f32_16x16x32_bf16 v[216:219], a[40:43], a[160:163], v[216:219]
  s_add_u32 s57, s57, 0x80
  s_cmp_eq_u32 s57, 0x500
  s_cselect_b32 s57, 0, s57
  v_mfma_f32_16x16x32_bf16 v[220:223], a[40:43], a[164:167], v[220:223]
  s_add_u32 m0, s42, 0xd400
  v_mfma_f32_16x16x32_bf16 v[224:227], a[40:43], a[168:171], v[224:227]
  s_waitcnt lgkmcnt(6)
  ds_read_b64_tr_b16 a[12:13], v7 offset:0
  ds_read_b64_tr_b16 a[14:15], v7 offset:6144
  v_mfma_f32_16x16x32_bf16 v[236:239], a[44:47], a[168:171], v[236:239]
  buffer_load_dwordx4 v18, s[4:7], s45 offen lds
  v_mfma_f32_16x16x32_bf16 v[232:235], a[44:47], a[164:167], v[232:235]
  s_mov_b32 s44, s56
  s_add_u32 m0, s37, 0x12000
  v_mfma_f32_16x16x32_bf16 v[228:231], a[44:47], a[160:163], v[228:231]
  s_waitcnt lgkmcnt(6)
  ds_read_b64_tr_b16 a[16:17], v4 offset:1024
  ds_read_b64_tr_b16 a[18:19], v4 offset:7168
  v_mfma_f32_16x16x32_bf16 v[96:99], a[0:3], a[172:175], v[96:99]
  buffer_load_dwordx4 v12, s[8:11], s44 offen lds
  v_mfma_f32_16x16x32_bf16 v[100:103], a[0:3], a[176:179], v[100:103]
  s_add_u32 s56, s56, 0x60000
  s_cmp_eq_u32 s56, 0x780000
  s_cselect_b32 s56, 0, s56
  v_mfma_f32_16x16x32_bf16 v[104:107], a[0:3], a[180:183], v[104:107]
  s_waitcnt lgkmcnt(6)
  s_add_u32 m0, s37, 0x12380
  ds_read_b64_tr_b16 a[20:21], v5 offset:1024
  v_mfma_f32_16x16x32_bf16 v[116:119], a[4:7], a[180:183], v[116:119]
  buffer_load_dwordx4 v12, s[8:11], s44 offen offset:128 lds
  v_mfma_f32_16x16x32_bf16 v[112:115], a[4:7], a[176:179], v[112:115]
  s_add_u32 m0, s37, 0x12700
  ds_read_b64_tr_b16 a[22:23], v5 offset:7168
  ds_read_b128 a[184:187], v10 offset:0
  v_mfma_f32_16x16x32_bf16 v[108:111], a[4:7], a[172:175], v[108:111]
  s_waitcnt lgkmcnt(7)
  ds_read_b64_tr_b16 a[24:25], v6 offset:1024
  ds_read_b64_tr_b16 a[26:27], v6 offset:7168
  v_mfma_f32_16x16x32_bf16 v[120:123], a[8:11], a[172:175], v[120:123]
  buffer_load_dwordx4 v12, s[8:11], s44 offen offset:256 lds
  v_mfma_f32_16x16x32_bf16 v[124:127], a[8:11], a[176:179], v[124:127]
  s_nop 0
  ds_read_b128 a[188:191], v10 offset:2048
  ds_read_b128 a[192:195], v10 offset:4096
  v_mfma_f32_16x16x32_bf16 v[128:131], a[8:11], a[180:183], v[128:131]
  s_waitcnt lgkmcnt(9)
  s_mov_b32 s45, s56
  s_add_u32 m0, s37, 0x15000
  v_mfma_f32_16x16x32_bf16 v[140:143], a[12:15], a[180:183], v[140:143]
  buffer_load_dwordx4 v12, s[8:11], s45 offen lds
L_hop0:
  s_cbranch_execz L_hop4
  v_mfma_f32_16x16x32_bf16 v[136:139], a[12:15], a[176:179], v[136:139]
  s_nop 0
  ds_read_b64_tr_b16 a[28:29], v7 offset:1024
  ds_read_b64_tr_b16 a[30:31], v7 offset:7168
  v_mfma_f32_16x16x32_bf16 v[132:135], a[12:15], a[172:175], v[132:135]
  s_waitcnt lgkmcnt(9)
  ds_read_b64_tr_b16 a[32:33], v4 offset:2048
  ds_read_b64_tr_b16 a[34:35], v4 offset:8192
  v_mfma_f32_16x16x32_bf16 v[144:147], a[16:19], a[172:175], v[144:147]
  s_add_u32 s56, s56, 0x60000
  s_cmp_eq_u32 s56, 0x780000
  s_cselect_b32 s56, 0, s56
  v_mfma_f32_16x16x32_bf16 v[148:151], a[16:19], a[176:179], v[148:151]
  s_add_u32 m0, s37, 0x15380
  ds_read_b128 a[196:199], v11 offset:0
  ds_read_b128 a[200:203], v11 offset:2048
  v_mfma_f32_16x16x32_bf16 v[152:155], a[16:19], a[180:183], v[152:155]
  s_waitcnt lgkmcnt(11)
  ds_read_b128 a[204:207], v11 offset:4096
  ds_read_b64_tr_b16 a[36:37], v5 offset:2048
  v_mfma_f32_16x16x32_bf16 v[164:167], a[20:23], a[180:183], v[164:167]
  buffer_load_dwordx4 v12, s[8:11], s45 offen offset:128 lds
  v_mfma_f32_16x16x32_bf16 v[160:163], a[20:23], a[176:179], v[160:163]
  s_add_u32 m0, s37, 0x15700
  ds_read_b64_tr_b16 a[38:39], v5 offset:8192
  v_mfma_f32_16x16x32_bf16 v[156:159], a[20:23], a[172:175], v[156:159]
  s_waitcnt lgkmcnt(11)
  ds_read_b64_tr_b16 a[40:41], v6 offset:2048
  ds_read_b64_tr_b16 a[42:43], v6 offset:8192
  v_mfma_f32_16x16x32_bf16 v[168:171], a[24:27], a[172:175], v[168:171]
  buffer_load_dwordx4 v12, s[8:11], s45 offen offset:256 lds
  v_mfma_f32_16x16x32_bf16 v[172:175], a[24:27], a[176:179], v[172:175]
  v_mfma_f32_16x16x32_bf16 v[176:179], a[24:27], a[180:183], v[176:179]
  s_waitcnt lgkmcnt(9)
  ds_read_b64_tr_b16 a[44:45], v7 offset:2048
  ds_read_b64_tr_b16 a[46:47], v7 offset:8192
  v_mfma_f32_16x16x32_bf16 v[188:191], a[28:31], a[180:183], v[188:191]
  v_mfma_f32_16x16x32_bf16 v[184:187], a[28:31], a[176:179], v[184:187]
  s_waitcnt vmcnt(12)
  s_waitcnt lgkmcnt(6)
  s_barrier
  v_mfma_f32_16x16x32_bf16 v[180:183], a[28:31], a[172:175], v[180:183]
  s_add_u32 s44, s57, 0
  s_add_u32 m0, s42, 0
  v_mfma_f32_16x16x32_bf16 v[192:195], a[32:35], a[172:175], v[192:195]
  buffer_load_dwordx4 v17, s[4:7], s44 offen lds
  v_mfma_f32_16x16x32_bf16 v[196:199], a[32:35], a[176:179], v[196:199]
  s_nop 0
  ds_read_b64_tr_b16 a[0:1], v4 offset:12288
  ds_read_b64_tr_b16 a[2:3], v4 offset:18432
  v_mfma_f32_16x16x32_bf16 v[200:203], a[32:35], a[180:183], v[200:203]
  s_waitcnt lgkmcnt(6)
  s_add_u32 m0, s42, 0x400
  ds_read_b64_tr_b16 a[4:5], v5 offset:12288
  v_mfma_f32_16x16x32_bf16 v[212:215], a[36:39], a[180:183], v[212:215]
  buffer_load_dwordx4 v18, s[4:7], s44 offen lds
  v_mfma_f32_16x16x32_bf16 v[208:211], a[36:39], a[176:179], v[208:211]
  ds_read_b64_tr_b16 a[6:7], v5 offset:18432
  v_mfma_f32_16x16x32_bf16 v[204:207], a[36:39], a[172:175], v[204:207]
  s_waitcnt lgkmcnt(6)
  ds_read_b64_tr_b16 a[8:9], v6 offset:12288
  ds_read_b64_tr_b16 a[10:11], v6 offset:18432
  v_mfma_f32_16x16x32_bf16 v[216:219], a[40:43], a[172:175], v[216:219]
  s_add_u32 s45, s57, 0x5000
  s_add_u32 m0, s42, 0x800
  v_mfma_f32_16x16x32_bf16 v[220:223], a[40:43], a[176:179], v[220:223]
  buffer_load_dwordx4 v17, s[4:7], s45 offen lds
  v_mfma_f32_16x16x32_bf16 v[224:227], a[40:43], a[180:183], v[224:227]
  s_waitcnt lgkmcnt(6)
  ds_read_b64_tr_b16 a[12:13], v7 offset:12288
  ds_read_b64_tr_b16 a[14:15], v7 offset:18432
  v_mfma_f32_16x16x32_bf16 v[236:239], a[44:47], a[180:183], v[236:239]
  s_add_u32 m0, s42, 0xc00
  v_mfma_f32_16x16x32_bf16 v[232:235], a[44:47], a[176:179], v[232:235]
  buffer_load_dwordx4 v18, s[4:7], s45 offen lds
  v_mfma_f32_16x16x32_bf16 v[228:231], a[44:47], a[172:175], v[228:231]
  s_waitcnt lgkmcnt(6)
  ds_read_b64_tr_b16 a[16:17], v4 offset:13312
  ds_read_b64_tr_b16 a[18:19], v4 offset:19456
  v_mfma_f32_16x16x32_bf16 v[96:99], a[0:3], a[184:187], v[96:99]
  s_nop 0
  ds_read_b128 a[208:211], v10 offset:24576
  ds_read_b128 a[212:215], v10 offset:26624
  v_mfma_f32_16x16x32_bf16 v[100:103], a[0:3], a[188:191], v[100:103]
  s_add_u32 s44, s57, 0xa000
  s_add_u32 m0, s42, 0x1000
  ds_read_b128 a[216:219], v10 offset:28672
  v_mfma_f32_16x16x32_bf16 v[104:107], a[0:3], a[192:195], v[104:107]
  s_waitcnt lgkmcnt(9)
  ds_read_b64_tr_b16 a[20:21], v5 offset:13312
  ds_read_b64_tr_b16 a[22:23], v5 offset:19456
  v_mfma_f32_16x16x32_bf16 v[116:119], a[4:7], a[192:195], v[116:119]
  buffer_load_dwordx4 v17, s[4:7], s44 offen lds
  v_mfma_f32_16x16x32_bf16 v[112:115], a[4:7], a[188:191], v[112:115]
  s_add_u32 s57, s57, 0x80
  s_cmp_eq_u32 s57, 0x500
  s_cselect_b32 s57, 0, s57
  v_mfma_f32_16x16x32_bf16 v[108:111], a[4:7], a[184:187], v[108:111]
  s_waitcnt lgkmcnt(9)
  s_add_u32 m0, s42, 0x1400
  ds_read_b64_tr_b16 a[24:25], v6 offset:13312
  v_mfma_f32_16x16x32_bf16 v[120:123], a[8:11], a[184:187], v[120:123]
  buffer_load_dwordx4 v18, s[4:7], s44 offen lds
  v_mfma_f32_16x16x32_bf16 v[124:127], a[8:11], a[188:191], v[124:127]
  s_nop 0
  ds_read_b64_tr_b16 a[26:27], v6 offset:19456
  ds_read_b128 a[220:223], v11 offset:24576
  v_mfma_f32_16x16x32_bf16 v[128:131], a[8:11], a[192:195], v[128:131]
  s_waitcnt lgkmcnt(10)
  s_mov_b32 s45, s56
  s_add_u32 m0, s37, 0x18000
  v_mfma_f32_16x16x32_bf16 v[140:143], a[12:15], a[192:195], v[140:143]
  buffer_load_dwordx4 v12, s[8:11], s45 offen lds
  v_mfma_f32_16x16x32_bf16 v[136:139], a[12:15], a[188:191], v[136:139]
  s_nop 0
  ds_read_b64_tr_b16 a[28:29], v7 offset:13312
  ds_read_b64_tr_b16 a[30:31], v7 offset:19456
  v_mfma_f32_16x16x32_bf16 v[132:135], a[12:15], a[184:187], v[132:135]
  s_waitcnt lgkmcnt(10)
  ds_read_b64_tr_b16 a[32:33], v4 offset:14336
  ds_read_b64_tr_b16 a[34:35], v4 offset:20480
  v_mfma_f32_16x16x32_bf16 v[144:147], a[16:19], a[184:187], v[144:147]
  s_add_u32 s56, s56, 0x60000
  s_cmp_eq_u32 s56, 0x780000
  s_cselect_b32 s56, 0, s56
  v_mfma_f32_16x16x32_bf16 v[148:151], a[16:19], a[188:191], v[148:151]
  s_add_u32 m0, s37, 0x18380
  ds_read_b128 a[224:227], v11 offset:26624
  ds_read_b128 a[228:231], v11 offset:28672
  v_mfma_f32_16x16x32_bf16 v[152:155], a[16:19], a[192:195], v[152:155]
  s_waitcnt lgkmcnt(9)
  ds_read_b64_tr_b16 a[36:37], v5 offset:14336
  ds_read_b64_tr_b16 a[38:39], v5 offset:20480
  v_mfma_f32_16x16x32_bf16 v[164:167], a[20:23], a[192:195], v[164:167]
  buffer_load_dwordx4 v12, s[8:11], s45 offen offset:128 lds
  v_mfma_f32_16x16x32_bf16 v[160:163], a[20:23], a[188:191], v[160:163]
  s_add_u32 m0, s37, 0x18700
  v_mfma_f32_16x16x32_bf16 v[156:159], a[20:23], a[184:187], v[156:159]
  s_waitcnt lgkmcnt(9)
  ds_read_b64_tr_b16 a[40:41], v6 offset:14336
  ds_read_b64_tr_b16 a[42:43], v6 offset:20480
  v_mfma_f32_16x16x32_bf16 v[168:171], a[24:27], a[184:187], v[168:171]
  buffer_load_dwordx4 v12, s[8:11], s45 offen offset:256 lds
  v_mfma_f32_16x16x32_bf16 v[172:175], a[24:27], a[188:191], v[172:175]
  v_mfma_f32_16x16x32_bf16 v[176:179], a[24:27], a[192:195], v[176:179]
  s_waitcnt lgkmcnt(8)
  ds_read_b64_tr_b16 a[44:45], v7 offset:14336
  ds_read_b64_tr_b16 a[46:47], v7 offset:20480
  v_mfma_f32_16x16x32_bf16 v[188:191], a[28:31], a[192:195], v[188:191]
  v_add_u32 v4, 0xffff1000, v4
  v_add_u32 v5, 0xffff1000, v5
  v_mfma_f32_16x16x32_bf16 v[184:187], a[28:31], a[188:191], v[184:187]
  s_waitcnt vmcnt(12)
  s_waitcnt lgkmcnt(6)
  s_barrier
  v_add_u32 v6, 0xffff1000, v6
  v_mfma_f32_16x16x32_bf16 v[180:183], a[28:31], a[184:187], v[180:183]
  s_add_u32 s44, s57, 0
  s_add_u32 m0, s42, 0x6000
  v_mfma_f32_16x16x32_bf16 v[192:195], a[32:35], a[184:187], v[192:195]
  buffer_load_dwordx4 v17, s[4:7], s44 offen lds
  v_mfma_f32_16x16x32_bf16 v[196:199], a[32:35], a[188:191], v[196:199]
  v_add_u32 v7, 0xffff1000, v7
  v_mfma_f32_16x16x32_bf16 v[200:203], a[32:35], a[192:195], v[200:203]
  s_waitcnt lgkmcnt(4)
  ds_read_b64_tr_b16 a[0:1], v4 offset:0
  ds_read_b64_tr_b16 a[2:3], v4 offset:6144
  v_mfma_f32_16x16x32_bf16 v[212:215], a[36:39], a[192:195], v[212:215]
  s_nop 0
  ds_read_b64_tr_b16 a[4:5], v5 offset:0
  ds_read_b64_tr_b16 a[6:7], v5 offset:6144
  v_mfma_f32_16x16x32_bf16 v[208:211], a[36:39], a[188:191], v[208:211]
  s_add_u32 m0, s42, 0x6400
  v_mfma_f32_16x16x32_bf16 v[204:207], a[36:39], a[184:187], v[204:207]
  s_waitcnt lgkmcnt(6)
  ds_read_b64_tr_b16 a[8:9], v6 offset:0
  ds_read_b64_tr_b16 a[10:11], v6 offset:6144
  v_mfma_f32_16x16x32_bf16 v[216:219], a[40:43], a[184:187], v[216:219]
  buffer_load_dwordx4 v18, s[4:7], s44 offen lds
  v_mfma_f32_16x16x32_bf16 v[220:223], a[40:43], a[188:191], v[220:223]
  v_mfma_f32_16x16x32_bf16 v[224:227], a[40:43], a[192:195], v[224:227]
  s_waitcnt lgkmcnt(6)
  ds_read_b64_tr_b16 a[12:13], v7 offset:0
  ds_read_b64_tr_b16 a[14:15], v7 offset:6144
  v_mfma_f32_16x16x32_bf16 v[236:239], a[44:47], a[192:195], v[236:239]
  s_add_u32 s45, s57, 0x5000
  s_add_u32 m0, s42, 0x6800
  v_mfma_f32_16x16x32_bf16 v[232:235], a[44:47], a[188:191], v[232:235]
  buffer_load_dwordx4 v17, s[4:7], s45 offen lds
  v_mfma_f32_16x16x32_bf16 v[228:231], a[44:47], a[184:187], v[228:231]
  s_waitcnt lgkmcnt(6)
  ds_read_b64_tr_b16 a[16:17], v4 offset:1024
  ds_read_b64_tr_b16 a[18:19], v4 offset:7168
  v_mfma_f32_16x16x32_bf16 v[96:99], a[0:3], a[196:199], v[96:99]
  s_nop 0
  ds_read_b128 a[232:235], v10 offset:49152
  ds_read_b128 a[236:239], v10 offset:51200
  v_mfma_f32_16x16x32_bf16 v[100:103], a[0:3], a[200:203], v[100:103]
  s_nop 0
  ds_read_b128 a[240:243], v10 offset:53248
  ds_read_b128 a[244:247], v11 offset:49152
  v_mfma_f32_16x16x32_bf16 v[104:107], a[0:3], a[204:207], v[104:107]
  s_waitcnt lgkmcnt(10)
  ds_read_b64_tr_b16 a[20:21], v5 offset:1024
  ds_read_b64_tr_b16 a[22:23], v5 offset:7168
  v_mfma_f32_16x16x32_bf16 v[116:119], a[4:7], a[204:207], v[116:119]
  s_add_u32 m0, s42, 0x6c00
  ds_read_b128 a[248:251], v11 offset:51200
  ds_read_b128 a[252:255], v11 offset:53248
  v_mfma_f32_16x16x32_bf16 v[112:115], a[4:7], a[200:203], v[112:115]
  buffer_load_dwordx4 v18, s[4:7], s45 offen lds
  v_mfma_f32_16x16x32_bf16 v[108:111], a[4:7], a[196:199], v[108:111]
  s_waitcnt lgkmcnt(12)
  ds_read_b64_tr_b16 a[24:25], v6 offset:1024
  ds_read_b64_tr_b16 a[26:27], v6 offset:7168
  v_mfma_f32_16x16x32_bf16 v[120:123], a[8:11], a[196:199], v[120:123]
  v_mfma_f32_16x16x32_bf16 v[124:127], a[8:11], a[200:203], v[124:127]
  v_mfma_f32_16x16x32_bf16 v[128:131], a[8:11], a[204:207], v[128:131]
  s_waitcnt lgkmcnt(12)
  s_add_u32 s44, s57, 0xa000
  s_add_u32 m0, s42, 0x7000
  v_mfma_f32_16x16x32_bf16 v[140:143], a[12:15], a[204:207], v[140:143]
  buffer_load_dwordx4 v17, s[4:7], s44 offen lds
  v_mfma_f32_16x16x32_bf16 v[136:139], a[12:15], a[200:203], v[136:139]
  s_nop 0
  ds_read_b64_tr_b16 a[28:29], v7 offset:1024
  ds_read_b64_tr_b16 a[30:31], v7 offset:7168
  v_mfma_f32_16x16x32_bf16 v[132:135], a[12:15], a[196:199], v[132:135]
  s_waitcnt lgkmcnt(12)
  ds_read_b64_tr_b16 a[32:33], v4 offset:2048
  ds_read_b64_tr_b16 a[34:35], v4 offset:8192
  v_mfma_f32_16x16x32_bf16 v[144:147], a[16:19], a[196:199], v[144:147]
  v_mfma_f32_16x16x32_bf16 v[148:151], a[16:19], a[200:203], v[148:151]
  s_add_u32 s57, s57, 0x80
  s_cmp_eq_u32 s57, 0x500
  s_cselect_b32 s57, 0, s57
  v_mfma_f32_16x16x32_bf16 v[152:155], a[16:19], a[204:207], v[152:155]
  s_waitcnt lgkmcnt(8)
  s_add_u32 m0, s42, 0x7400
  ds_read_b64_tr_b16 a[36:37], v5 offset:2048
  v_mfma_f32_16x16x32_bf16 v[164:167], a[20:23], a[204:207], v[164:167]
  buffer_load_dwordx4 v18, s[4:7], s44 offen lds
  v_mfma_f32_16x16x32_bf16 v[160:163], a[20:23], a[200:203], v[160:163]
  ds_read_b64_tr_b16 a[38:39], v5 offset:8192
  v_mfma_f32_16x16x32_bf16 v[156:159], a[20:23], a[196:199], v[156:159]
  s_waitcnt lgkmcnt(6)
  ds_read_b64_tr_b16 a[40:41], v6 offset:2048
  ds_read_b64_tr_b16 a[42:43], v6 offset:8192
  v_mfma_f32_16x16x32_bf16 v[168:171], a[24:27], a[196:199], v[168:171]
  v_mfma_f32_16x16x32_bf16 v[172:175], a[24:27], a[200:203], v[172:175]
  v_mfma_f32_16x16x32_bf16 v[176:179], a[24:27], a[204:207], v[176:179]
  s_waitcnt lgkmcnt(6)
  ds_read_b64_tr_b16 a[44:45], v7 offset:2048
  ds_read_b64_tr_b16 a[46:47], v7 offset:8192
  v_mfma_f32_16x16x32_bf16 v[188:191], a[28:31], a[204:207], v[188:191]
  v_mfma_f32_16x16x32_bf16 v[184:187], a[28:31], a[200:203], v[184:187]
  s_waitcnt vmcnt(15)
  s_barrier
  v_mfma_f32_16x16x32_bf16 v[180:183], a[28:31], a[196:199], v[180:183]
  s_waitcnt lgkmcnt(6)
  s_mov_b32 s45, s56
  s_add_u32 m0, s37, 0x1b000
  v_mfma_f32_16x16x32_bf16 v[192:195], a[32:35], a[196:199], v[192:195]
  buffer_load_dwordx4 v12, s[8:11], s45 offen lds
  v_mfma_f32_16x16x32_bf16 v[196:199], a[32:35], a[200:203], v[196:199]
  s_nop 0
  ds_read_b64_tr_b16 a[0:1], v4 offset:12288
  ds_read_b64_tr_b16 a[2:3], v4 offset:18432
  v_mfma_f32_16x16x32_bf16 v[200:203], a[32:35], a[204:207], v[200:203]
  s_waitcnt lgkmcnt(6)
  ds_read_b64_tr_b16 a[4:5], v5 offset:12288
  ds_read_b64_tr_b16 a[6:7], v5 offset:18432
  v_mfma_f32_16x16x32_bf16 v[212:215], a[36:39], a[204:207], v[212:215]
  s_add_u32 s56, s56, 0x60000
  s_cmp_eq_u32 s56, 0x780000
  s_cselect_b32 s56, 0, s56
  v_mfma_f32_16x16x32_bf16 v[208:211], a[36:39], a[200:203], v[208:211]
  s_add_u32 m0, s37, 0x1b380
  v_mfma_f32_16x16x32_bf16 v[204:207], a[36:39], a[196:199], v[204:207]
  s_waitcnt lgkmcnt(6)
  ds_read_b64_tr_b16 a[8:9], v6 offset:12288
  ds_read_b64_tr_b16 a[10:11], v6 offset:18432
  v_mfma_f32_16x16x32_bf16 v[216:219], a[40:43], a[196:199], v[216:219]
  buffer_load_dwordx4 v12, s[8:11], s45 offen offset:128 lds
  v_mfma_f32_16x16x32_bf16 v[220:223], a[40:43], a[200:203], v[220:223]
  s_add_u32 m0, s37, 0x1b700
  v_mfma_f32_16x16x32_bf16 v[224:227], a[40:43], a[204:207], v[224:227]
  s_waitcnt lgkmcnt(6)
  ds_read_b64_tr_b16 a[12:13], v7 offset:12288
  ds_read_b64_tr_b16 a[14:15], v7 offset:18432
  v_mfma_f32_16x16x32_bf16 v[236:239], a[44:47], a[204:207], v[236:239]
  buffer_load_dwordx4 v12, s[8:11], s45 offen offset:256 lds
  v_mfma_f32_16x16x32_bf16 v[232:235], a[44:47], a[200:203], v[232:235]
  s_add_u32 s44, s57, 0
  s_add_u32 m0, s42, 0xc000
  v_mfma_f32_16x16x32_bf16 v[228:231], a[44:47], a[196:199], v[228:231]
  s_waitcnt lgkmcnt(6)
  ds_read_b64_tr_b16 a[16:17], v4 offset:13312
  ds_read_b64_tr_b16 a[18:19], v4 offset:19456
  v_mfma_f32_16x16x32_bf16 v[96:99], a[0:3], a[208:211], v[96:99]
  buffer_load_dwordx4 v17, s[4:7], s44 offen lds
  v_mfma_f32_16x16x32_bf16 v[100:103], a[0:3], a[212:215], v[100:103]
  s_add_u32 m0, s42, 0xc400
  v_mfma_f32_16x16x32_bf16 v[104:107], a[0:3], a[216:219], v[104:107]
  s_waitcnt lgkmcnt(6)
  ds_read_b64_tr_b16 a[20:21], v5 offset:13312
  ds_read_b64_tr_b16 a[22:23], v5 offset:19456
  v_mfma_f32_16x16x32_bf16 v[116:119], a[4:7], a[216:219], v[116:119]
  buffer_load_dwordx4 v18, s[4:7], s44 offen lds
  v_mfma_f32_16x16x32_bf16 v[112:115], a[4:7], a[212:215], v[112:115]
  s_add_u32 s45, s57, 0x5000
  s_add_u32 m0, s42, 0xc800
  v_mfma_f32_16x16x32_bf16 v[108:111], a[4:7], a[208:211], v[108:111]
  s_waitcnt lgkmcnt(6)
  ds_read_b64_tr_b16 a[24:25], v6 offset:13312
  ds_read_b64_tr_b16 a[26:27], v6 offset:19456
  v_mfma_f32_16x16x32_bf16 v[120:123], a[8:11], a[208:211], v[120:123]
  buffer_load_dwordx4 v17, s[4:7], s45 offen lds
  v_mfma_f32_16x16x32_bf16 v[124:127], a[8:11], a[212:215], v[124:127]
  v_mfma_f32_16x16x32_bf16 v[128:131], a[8:11], a[216:219], v[128:131]
  s_waitcnt lgkmcnt(6)
  s_add_u32 m0, s42, 0xcc00
  ds_read_b64_tr_b16 a[28:29], v7 offset:13312
  v_mfma_f32_16x16x32_bf16 v[140:143], a[12:15], a[216:219], v[140:143]
  buffer_load_dwordx4 v18, s[4:7], s45 offen lds
  v_mfma_f32_16x16x32_bf16 v[136:139], a[12:15], a[212:215], v[136:139]
  ds_read_b64_tr_b16 a[30:31], v7 offset:19456
  v_mfma_f32_16x16x32_bf16 v[132:135], a[12:15], a[208:211], v[132:135]
  s_waitcnt lgkmcnt(6)
  s_add_u32 s44, s57, 0xa000
  s_add_u32 m0, s42, 0xd000
  v_mfma_f32_16x16x32_bf16 v[144:147], a[16:19], a[208:211], v[144:147]
  buffer_load_dwordx4 v17, s[4:7], s44 offen lds
  v_mfma_f32_16x16x32_bf16 v[148:151], a[16:19], a[212:215], v[148:151]
  s_nop 0
  ds_read_b64_tr_b16 a[32:33], v4 offset:14336
  ds_read_b64_tr_b16 a[34:35], v4 offset:20480
  v_mfma_f32_16x16x32_bf16 v[152:155], a[16:19], a[216:219], v[152:155]
  s_waitcnt lgkmcnt(6)
  ds_read_b64_tr_b16 a[36:37], v5 offset:14336
  ds_read_b64_tr_b16 a[38:39], v5 offset:20480
  v_mfma_f32_16x16x32_bf16 v[164:167], a[20:23], a[216:219], v[164:167]
  s_add_u32 s57, s57, 0x80
  s_cmp_eq_u32 s57, 0x500
  s_cselect_b32 s57, 0, s57
  v_mfma_f32_16x16x32_bf16 v[160:163], a[20:23], a[212:215], v[160:163]
  s_add_u32 m0, s42, 0xd400
  v_mfma_f32_16x16x32_bf16 v[156:159], a[20:23], a[208:211], v[156:159]
  s_waitcnt lgkmcnt(6)
  ds_read_b64_tr_b16 a[40:41], v6 offset:14336
  ds_read_b64_tr_b16 a[42:43], v6 offset:20480
  v_mfma_f32_16x16x32_bf16 v[168:171], a[24:27], a[208:211], v[168:171]
  buffer_load_dwordx4 v18, s[4:7], s44 offen lds
  v_mfma_f32_16x16x32_bf16 v[172:175], a[24:27], a[212:215], v[172:175]
  v_mfma_f32_16x16x32_bf16 v[176:179], a[24:27], a[216:219], v[176:179]
  s_waitcnt lgkmcnt(6)
  ds_read_b64_tr_b16 a[44:45], v7 offset:14336
  ds_read_b64_tr_b16 a[46:47], v7 offset:20480
  v_mfma_f32_16x16x32_bf16 v[188:191], a[28:31], a[216:219], v[188:191]
  v_mfma_f32_16x16x32_bf16 v[184:187], a[28:31], a[212:215], v[184:187]
  s_waitcnt vmcnt(15)
  s_barrier
  v_mfma_f32_16x16x32_bf16 v[180:183], a[28:31], a[208:211], v[180:183]
  s_waitcnt lgkmcnt(6)
  s_mov_b32 s45, s56
  s_add_u32 m0, s37, 0x1e000
  v_mfma_f32_16x16x32_bf16 v[192:195], a[32:35], a[208:211], v[192:195]
  buffer_load_dwordx4 v12, s[8:11], s45 offen lds
  v_mfma_f32_16x16x32_bf16 v[196:199], a[32:35], a[212:215], v[196:199]
  s_nop 0
  ds_read_b64_tr_b16 a[0:1], v4 offset:24576
  ds_read_b64_tr_b16 a[2:3], v4 offset:30720
  v_mfma_f32_16x16x32_bf16 v[200:203], a[32:35], a[216:219], v[200:203]
  s_waitcnt lgkmcnt(6)
  ds_read_b64_tr_b16 a[4:5], v5 offset:24576
  ds_read_b64_tr_b16 a[6:7], v5 offset:30720
  v_mfma_f32_16x16x32_bf16 v[212:215], a[36:39], a[216:219], v[212:215]
  s_add_u32 s56, s56, 0x60000
  s_cmp_eq_u32 s56, 0x780000
  s_cselect_b32 s56, 0, s56
  v_mfma_f32_16x16x32_bf16 v[208:211], a[36:39], a[212:215], v[208:211]
  s_add_u32 m0, s37, 0x1e380
  v_mfma_f32_16x16x32_bf16 v[204:207], a[36:39], a[208:211], v[204:207]
  s_waitcnt lgkmcnt(6)
  ds_read_b64_tr_b16 a[8:9], v6 offset:24576
  ds_read_b64_tr_b16 a[10:11], v6 offset:30720
  v_mfma_f32_16x16x32_bf16 v[216:219], a[40:43], a[208:211], v[216:219]
  buffer_load_dwordx4 v12, s[8:11], s45 offen offset:128 lds
  v_mfma_f32_16x16x32_bf16 v[220:223], a[40:43], a[212:215], v[220:223]
  s_add_u32 m0, s37, 0x1e700
  v_mfma_f32_16x16x32_bf16 v[224:227], a[40:43], a[216:219], v[224:227]
  s_waitcnt lgkmcnt(6)
  ds_read_b64_tr_b16 a[12:13], v7 offset:24576
  ds_read_b64_tr_b16 a[14:15], v7 offset:30720
  v_mfma_f32_16x16x32_bf16 v[236:239], a[44:47], a[216:219], v[236:239]
  buffer_load_dwordx4 v12, s[8:11], s45 offen offset:256 lds
  v_mfma_f32_16x16x32_bf16 v[232:235], a[44:47], a[212:215], v[232:235]
  s_mov_b32 s44, s56
  s_add_u32 m0, s37, 0x21000
  v_mfma_f32_16x16x32_bf16 v[228:231], a[44:47], a[208:211], v[228:231]
  s_waitcnt lgkmcnt(6)
  ds_read_b64_tr_b16 a[16:17], v4 offset:25600
  ds_read_b64_tr_b16 a[18:19], v4 offset:31744
  v_mfma_f32_16x16x32_bf16 v[96:99], a[0:3], a[220:223], v[96:99]
  buffer_load_dwordx4 v12, s[8:11], s44 offen lds
  v_mfma_f32_16x16x32_bf16 v[100:103], a[0:3], a[224:227], v[100:103]
  s_add_u32 s56, s56, 0x60000
  s_cmp_eq_u32 s56, 0x780000
  s_cselect_b32 s56, 0, s56
  v_mfma_f32_16x16x32_bf16 v[104:107], a[0:3], a[228:231], v[104:107]
  s_waitcnt lgkmcnt(6)
  s_add_u32 m0, s37, 0x21380
  ds_read_b64_tr_b16 a[20:21], v5 offset:25600
  v_mfma_f32_16x16x32_bf16 v[116:119], a[4:7], a[228:231], v[116:119]
  buffer_load_dwordx4 v12, s[8:11], s44 offen offset:128 lds
  v_mfma_f32_16x16x32_bf16 v[112:115], a[4:7], a[224:227], v[112:115]
  s_add_u32 m0, s37, 0x21700
  ds_read_b64_tr_b16 a[22:23], v5 offset:31744
  ds_read_b128 a[112:115], v10 offset:0
  v_mfma_f32_16x16x32_bf16 v[108:111], a[4:7], a[220:223], v[108:111]
  s_waitcnt lgkmcnt(7)
  ds_read_b64_tr_b16 a[24:25], v6 offset:25600
  ds_read_b64_tr_b16 a[26:27], v6 offset:31744
  v_mfma_f32_16x16x32_bf16 v[120:123], a[8:11], a[220:223], v[120:123]
  buffer_load_dwordx4 v12, s[8:11], s44 offen offset:256 lds
  v_mfma_f32_16x16x32_bf16 v[124:127], a[8:11], a[224:227], v[124:127]
  s_nop 0
  ds_read_b128 a[116:119], v10 offset:2048
  ds_read_b128 a[120:123], v10 offset:4096
  v_mfma_f32_16x16x32_bf16 v[128:131], a[8:11], a[228:231], v[128:131]
  s_waitcnt lgkmcnt(9)
  ds_read_b64_tr_b16 a[28:29], v7 offset:25600
  ds_read_b64_tr_b16 a[30:31], v7 offset:31744
  v_mfma_f32_16x16x32_bf16 v[140:143], a[12:15], a[228:231], v[140:143]
  s_nop 0
  ds_read_b128 a[124:127], v11 offset:0
  ds_read_b128 a[128:131], v11 offset:2048
  v_mfma_f32_16x16x32_bf16 v[136:139], a[12:15], a[224:227], v[136:139]
  ds_read_b128 a[132:135], v11 offset:4096
  v_mfma_f32_16x16x32_bf16 v[132:135], a[12:15], a[220:223], v[132:135]
  s_waitcnt lgkmcnt(12)
  ds_read_b64_tr_b16 a[32:33], v4 offset:26624
  ds_read_b64_tr_b16 a[34:35], v4 offset:32768
  v_mfma_f32_16x16x32_bf16 v[144:147], a[16:19], a[220:223], v[144:147]
  v_mfma_f32_16x16x32_bf16 v[148:151], a[16:19], a[224:227], v[148:151]
  v_mfma_f32_16x16x32_bf16 v[152:155], a[16:19], a[228:231], v[152:155]
  s_waitcnt lgkmcnt(12)
  ds_read_b64_tr_b16 a[36:37], v5 offset:26624
  ds_read_b64_tr_b16 a[38:39], v5 offset:32768
  v_mfma_f32_16x16x32_bf16 v[164:167], a[20:23], a[228:231], v[164:167]
  v_mfma_f32_16x16x32_bf16 v[160:163], a[20:23], a[224:227], v[160:163]
  v_mfma_f32_16x16x32_bf16 v[156:159], a[20:23], a[220:223], v[156:159]
  s_waitcnt lgkmcnt(11)
  ds_read_b64_tr_b16 a[40:41], v6 offset:26624
  ds_read_b64_tr_b16 a[42:43], v6 offset:32768
  v_mfma_f32_16x16x32_bf16 v[168:171], a[24:27], a[220:223], v[168:171]
  v_mfma_f32_16x16x32_bf16 v[172:175], a[24:27], a[224:227], v[172:175]
  v_mfma_f32_16x16x32_bf16 v[176:179], a[24:27], a[228:231], v[176:179]
  s_waitcnt lgkmcnt(9)
  ds_read_b64_tr_b16 a[44:45], v7 offset:26624
  ds_read_b64_tr_b16 a[46:47], v7 offset:32768
  v_mfma_f32_16x16x32_bf16 v[188:191], a[28:31], a[228:231], v[188:191]
  v_mfma_f32_16x16x32_bf16 v[184:187], a[28:31], a[224:227], v[184:187]
  s_waitcnt vmcnt(12)
  s_waitcnt lgkmcnt(8)
  s_barrier
  s_add_u32 s45, s57, 0
  v_mfma_f32_16x16x32_bf16 v[180:183], a[28:31], a[220:223], v[180:183]
  s_waitcnt lgkmcnt(6)
  s_add_u32 m0, s42, 0
  ds_read_b64_tr_b16 a[0:1], v4 offset:36864
  v_mfma_f32_16x16x32_bf16 v[192:195], a[32:35], a[220:223], v[192:195]
  buffer_load_dwordx4 v17, s[4:7], s45 offen lds
  v_mfma_f32_16x16x32_bf16 v[196:199], a[32:35], a[224:227], v[196:199]
  s_add_u32 m0, s42, 0x400
  ds_read_b64_tr_b16 a[2:3], v4 offset:43008
  v_mfma_f32_16x16x32_bf16 v[200:203], a[32:35], a[228:231], v[200:203]
  s_waitcnt lgkmcnt(6)
  ds_read_b64_tr_b16 a[4:5], v5 offset:36864
  ds_read_b64_tr_b16 a[6:7], v5 offset:43008
  v_mfma_f32_16x16x32_bf16 v[212:215], a[36:39], a[228:231], v[212:215]
  buffer_load_dwordx4 v18, s[4:7], s45 offen lds
  v_mfma_f32_16x16x32_bf16 v[208:211], a[36:39], a[224:227], v[208:211]
  s_add_u32 s44, s57, 0x5000
  s_add_u32 m0, s42, 0x800
  v_mfma_f32_16x16x32_bf16 v[204:207], a[36:39], a[220:223], v[204:207]
  s_waitcnt lgkmcnt(6)
  ds_read_b64_tr_b16 a[8:9], v6 offset:36864
  ds_read_b64_tr_b16 a[10:11], v6 offset:43008
  v_mfma_f32_16x16x32_bf16 v[216:219], a[40:43], a[220:223], v[216:219]
  buffer_load_dwordx4 v17, s[4:7], s44 offen lds
  v_mfma_f32_16x16x32_bf16 v[220:223], a[40:43], a[224:227], v[220:223]
  s_add_u32 m0, s42, 0xc00
  v_mfma_f32_16x16x32_bf16 v[224:227], a[40:43], a[228:231], v[224:227]
  s_waitcnt lgkmcnt(6)
  ds_read_b64_tr_b16 a[12:13], v7 offset:36864
  ds_read_b64_tr_b16 a[14:15], v7 offset:43008
  v_mfma_f32_16x16x32_bf16 v[236:239], a[44:47], a[228:231], v[236:239]
  buffer_load_dwordx4 v18, s[4:7], s44 offen lds
  v_mfma_f32_16x16x32_bf16 v[232:235], a[44:47], a[224:227], v[232:235]
  s_add_u32 s45, s57, 0xa000
  s_add_u32 m0, s42, 0x1000
  v_mfma_f32_16x16x32_bf16 v[228:231], a[44:47], a[220:223], v[228:231]
  s_waitcnt lgkmcnt(6)
  ds_read_b64_tr_b16 a[16:17], v4 offset:37888
  ds_read_b64_tr_b16 a[18:19], v4 offset:44032
  v_mfma_f32_16x16x32_bf16 v[96:99], a[0:3], a[232:235], v[96:99]
  buffer_load_dwordx4 v17, s[4:7], s45 offen lds
  v_mfma_f32_16x16x32_bf16 v[100:103], a[0:3], a[236:239], v[100:103]
  s_add_u32 s57, s57, 0x80
  s_cmp_eq_u32 s57, 0x500
  s_cselect_b32 s57, 0, s57
  v_mfma_f32_16x16x32_bf16 v[104:107], a[0:3], a[240:243], v[104:107]
  s_waitcnt lgkmcnt(6)
  s_add_u32 m0, s42, 0x1400
  ds_read_b64_tr_b16 a[20:21], v5 offset:37888
  v_mfma_f32_16x16x32_bf16 v[116:119], a[4:7], a[240:243], v[116:119]
  buffer_load_dwordx4 v18, s[4:7], s45 offen lds
  v_mfma_f32_16x16x32_bf16 v[112:115], a[4:7], a[236:239], v[112:115]
  s_mov_b32 s44, s56
  s_add_u32 m0, s37, 0x24000
  ds_read_b64_tr_b16 a[22:23], v5 offset:44032
  v_mfma_f32_16x16x32_bf16 v[108:111], a[4:7], a[232:235], v[108:111]
  s_waitcnt lgkmcnt(6)
  ds_read_b64_tr_b16 a[24:25], v6 offset:37888
  ds_read_b64_tr_b16 a[26:27], v6 offset:44032
  v_mfma_f32_16x16x32_bf16 v[120:123], a[8:11], a[232:235], v[120:123]
  buffer_load_dwordx4 v12, s[8:11], s44 offen lds
  v_mfma_f32_16x16x32_bf16 v[124:127], a[8:11], a[236:239], v[124:127]
  s_add_u32 s56, s56, 0x60000
  s_cmp_eq_u32 s56, 0x780000
  s_cselect_b32 s56, 0, s56
  v_mfma_f32_16x16x32_bf16 v[128:131], a[8:11], a[240:243], v[128:131]
  s_waitcnt lgkmcnt(6)
  s_add_u32 m0, s37, 0x24380
  ds_read_b64_tr_b16 a[28:29], v7 offset:37888
  v_mfma_f32_16x16x32_bf16 v[140:143], a[12:15], a[240:243], v[140:143]
  buffer_load_dwordx4 v12, s[8:11], s44 offen offset:128 lds
  v_mfma_f32_16x16x32_bf16 v[136:139], a[12:15], a[236:239], v[136:139]
  s_add_u32 m0, s37, 0x24700
  ds_read_b64_tr_b16 a[30:31], v7 offset:44032
  ds_read_b128 a[136:139], v10 offset:24576
  v_mfma_f32_16x16x32_bf16 v[132:135], a[12:15], a[232:235], v[132:135]
  s_waitcnt lgkmcnt(7)
  ds_read_b64_tr_b16 a[32:33], v4 offset:38912
  ds_read_b64_tr_b16 a[34:35], v4 offset:45056
  v_mfma_f32_16x16x32_bf16 v[144:147], a[16:19], a[232:235], v[144:147]
  buffer_load_dwordx4 v12, s[8:11], s44 offen offset:256 lds
  v_mfma_f32_16x16x32_bf16 v[148:151], a[16:19], a[236:239], v[148:151]
  s_nop 0
  ds_read_b128 a[140:143], v10 offset:26624
  ds_read_b128 a[144:147], v10 offset:28672
  v_mfma_f32_16x16x32_bf16 v[152:155], a[16:19], a[240:243], v[152:155]
  s_waitcnt lgkmcnt(9)
  s_mov_b32 s45, s56
  s_add_u32 m0, s37, 0x12000
  v_mfma_f32_16x16x32_bf16 v[164:167], a[20:23], a[240:243], v[164:167]
  buffer_load_dwordx4 v12, s[8:11], s45 offen lds
  v_mfma_f32_16x16x32_bf16 v[160:163], a[20:23], a[236:239], v[160:163]
  ds_read_b128 a[148:151], v11 offset:24576
  ds_read_b128 a[152:155], v11 offset:26624
  ds_read_b128 a[156:159], v11 offset:28672
  v_mfma_f32_16x16x32_bf16 v[156:159], a[20:23], a[232:235], v[156:159]
  s_waitcnt lgkmcnt(10)
  ds_read_b64_tr_b16 a[36:37], v5 offset:38912
  ds_read_b64_tr_b16 a[38:39], v5 offset:45056
  v_mfma_f32_16x16x32_bf16 v[168:171], a[24:27], a[232:235], v[168:171]
L_hop1:
  s_cbranch_execz L_hop5
  s_nop 0
  ds_read_b64_tr_b16 a[40:41], v6 offset:38912
  ds_read_b64_tr_b16 a[42:43], v6 offset:45056
  v_mfma_f32_16x16x32_bf16 v[172:175], a[24:27], a[236:239], v[172:175]
  v_mfma_f32_16x16x32_bf16 v[176:179], a[24:27], a[240:243], v[176:179]
  s_waitcnt lgkmcnt(12)
  ds_read_b64_tr_b16 a[44:45], v7 offset:38912
  ds_read_b64_tr_b16 a[46:47], v7 offset:45056
  v_mfma_f32_16x16x32_bf16 v[188:191], a[28:31], a[240:243], v[188:191]
  v_mfma_f32_16x16x32_bf16 v[184:187], a[28:31], a[236:239], v[184:187]
  s_waitcnt vmcnt(13)
  s_waitcnt lgkmcnt(6)
  s_barrier
  v_mfma_f32_16x16x32_bf16 v[180:183], a[28:31], a[232:235], v[180:183]
  ds_read_b64_tr_b16 a[0:1], v4 offset:49152
  ds_read_b64_tr_b16 a[2:3], v4 offset:55296
  v_mfma_f32_16x16x32_bf16 v[192:195], a[32:35], a[232:235], v[192:195]
  s_add_u32 s56, s56, 0x60000
  s_cmp_eq_u32 s56, 0x780000
  s_cselect_b32 s56, 0, s56
  v_mfma_f32_16x16x32_bf16 v[196:199], a[32:35], a[236:239], v[196:199]
  s_add_u32 m0, s37, 0x12380
  v_mfma_f32_16x16x32_bf16 v[200:203], a[32:35], a[240:243], v[200:203]
  s_waitcnt lgkmcnt(6)
  ds_read_b64_tr_b16 a[4:5], v5 offset:49152
  ds_read_b64_tr_b16 a[6:7], v5 offset:55296
  v_mfma_f32_16x16x32_bf16 v[212:215], a[36:39], a[240:243], v[212:215]
  buffer_load_dwordx4 v12, s[8:11], s45 offen offset:128 lds
  v_mfma_f32_16x16x32_bf16 v[208:211], a[36:39], a[236:239], v[208:211]
  s_add_u32 m0, s37, 0x12700
  v_mfma_f32_16x16x32_bf16 v[204:207], a[36:39], a[232:235], v[204:207]
  s_waitcnt lgkmcnt(6)
  ds_read_b64_tr_b16 a[8:9], v6 offset:49152
  ds_read_b64_tr_b16 a[10:11], v6 offset:55296
  v_mfma_f32_16x16x32_bf16 v[216:219], a[40:43], a[232:235], v[216:219]
  buffer_load_dwordx4 v12, s[8:11], s45 offen offset:256 lds
  v_mfma_f32_16x16x32_bf16 v[220:223], a[40:43], a[236:239], v[220:223]
  v_mfma_f32_16x16x32_bf16 v[224:227], a[40:43], a[240:243], v[224:227]
  s_waitcnt lgkmcnt(6)
  s_mov_b32 s44, s56
  s_add_u32 m0, s37, 0x15000
  v_mfma_f32_16x16x32_bf16 v[236:239], a[44:47], a[240:243], v[236:239]
  buffer_load_dwordx4 v12, s[8:11], s44 offen lds
  v_mfma_f32_16x16x32_bf16 v[232:235], a[44:47], a[236:239], v[232:235]
  s_nop 0
  ds_read_b64_tr_b16 a[12:13], v7 offset:49152
  ds_read_b64_tr_b16 a[14:15], v7 offset:55296
  v_mfma_f32_16x16x32_bf16 v[228:231], a[44:47], a[232:235], v[228:231]
  s_waitcnt lgkmcnt(6)
  ds_read_b64_tr_b16 a[16:17], v4 offset:50176
  ds_read_b64_tr_b16 a[18:19], v4 offset:56320
  v_mfma_f32_16x16x32_bf16 v[96:99], a[0:3], a[244:247], v[96:99]
  s_add_u32 s56, s56, 0x60000
  s_cmp_eq_u32 s56, 0x780000
  s_cselect_b32 s56, 0, s56
  v_mfma_f32_16x16x32_bf16 v[100:103], a[0:3], a[248:251], v[100:103]
  s_add_u32 m0, s37, 0x15380
  ds_read_b128 a[160:163], v10 offset:49152
  ds_read_b128 a[164:167], v10 offset:51200
  v_mfma_f32_16x16x32_bf16 v[104:107], a[0:3], a[252:255], v[104:107]
  s_waitcnt lgkmcnt(8)
  ds_read_b64_tr_b16 a[20:21], v5 offset:50176
  ds_read_b64_tr_b16 a[22:23], v5 offset:56320
  v_mfma_f32_16x16x32_bf16 v[116:119], a[4:7], a[252:255], v[116:119]
  buffer_load_dwordx4 v12, s[8:11], s44 offen offset:128 lds
  v_mfma_f32_16x16x32_bf16 v[112:115], a[4:7], a[248:251], v[112:115]
  s_nop 0
  ds_read_b128 a[168:171], v10 offset:53248
  ds_read_b128 a[172:175], v11 offset:49152
  v_mfma_f32_16x16x32_bf16 v[108:111], a[4:7], a[244:247], v[108:111]
  s_waitcnt lgkmcnt(10)
  s_add_u32 m0, s37, 0x15700
  ds_read_b64_tr_b16 a[24:25], v6 offset:50176
  v_mfma_f32_16x16x32_bf16 v[120:123], a[8:11], a[244:247], v[120:123]
  buffer_load_dwordx4 v12, s[8:11], s44 offen offset:256 lds
  v_mfma_f32_16x16x32_bf16 v[124:127], a[8:11], a[248:251], v[124:127]
  s_nop 0
  ds_read_b64_tr_b16 a[26:27], v6 offset:56320
  ds_read_b128 a[176:179], v11 offset:51200
  v_mfma_f32_16x16x32_bf16 v[128:131], a[8:11], a[252:255], v[128:131]
  s_waitcnt lgkmcnt(11)
  ds_read_b64_tr_b16 a[28:29], v7 offset:50176
  ds_read_b64_tr_b16 a[30:31], v7 offset:56320
  v_mfma_f32_16x16x32_bf16 v[140:143], a[12:15], a[252:255], v[140:143]
  s_mov_b32 s45, s56
  s_add_u32 m0, s37, 0x6000
  ds_read_b128 a[180:183], v11 offset:53248
  v_mfma_f32_16x16x32_bf16 v[136:139], a[12:15], a[248:251], v[136:139]
  buffer_load_dwordx4 v12, s[8:11], s45 offen lds
  v_mfma_f32_16x16x32_bf16 v[132:135], a[12:15], a[244:247], v[132:135]
  s_waitcnt lgkmcnt(12)
  ds_read_b64_tr_b16 a[32:33], v4 offset:51200
  ds_read_b64_tr_b16 a[34:35], v4 offset:57344
  v_mfma_f32_16x16x32_bf16 v[144:147], a[16:19], a[244:247], v[144:147]
  v_mfma_f32_16x16x32_bf16 v[148:151], a[16:19], a[248:251], v[148:151]
  v_mfma_f32_16x16x32_bf16 v[152:155], a[16:19], a[252:255], v[152:155]
  s_waitcnt lgkmcnt(10)
  ds_read_b64_tr_b16 a[36:37], v5 offset:51200
  ds_read_b64_tr_b16 a[38:39], v5 offset:57344
  v_mfma_f32_16x16x32_bf16 v[164:167], a[20:23], a[252:255], v[164:167]
  s_add_u32 s56, s56, 0x60000
  s_cmp_eq_u32 s56, 0x780000
  s_cselect_b32 s56, 0, s56
  v_mfma_f32_16x16x32_bf16 v[160:163], a[20:23], a[248:251], v[160:163]
  s_add_u32 m0, s37, 0x6380
  v_mfma_f32_16x16x32_bf16 v[156:159], a[20:23], a[244:247], v[156:159]
  s_waitcnt lgkmcnt(8)
  ds_read_b64_tr_b16 a[40:41], v6 offset:51200
  ds_read_b64_tr_b16 a[42:43], v6 offset:57344
  v_mfma_f32_16x16x32_bf16 v[168:171], a[24:27], a[244:247], v[168:171]
  buffer_load_dwordx4 v12, s[8:11], s45 offen offset:128 lds
  v_mfma_f32_16x16x32_bf16 v[172:175], a[24:27], a[248:251], v[172:175]
  v_mfma_f32_16x16x32_bf16 v[176:179], a[24:27], a[252:255], v[176:179]
  s_waitcnt lgkmcnt(7)
  ds_read_b64_tr_b16 a[44:45], v7 offset:51200
  ds_read_b64_tr_b16 a[46:47], v7 offset:57344
  v_mfma_f32_16x16x32_bf16 v[188:191], a[28:31], a[252:255], v[188:191]
  v_add_u32 v4, 0xf000, v4
  v_add_u32 v5, 0xf000, v5
  v_mfma_f32_16x16x32_bf16 v[184:187], a[28:31], a[248:251], v[184:187]
  s_waitcnt vmcnt(17)
  s_waitcnt lgkmcnt(8)
  s_barrier
  v_add_u32 v6, 0xf000, v6
  v_mfma_f32_16x16x32_bf16 v[180:183], a[28:31], a[244:247], v[180:183]
  s_waitcnt lgkmcnt(6)
  s_add_u32 m0, s37, 0x6700
  v_add_u32 v7, 0xf000, v7
  v_mfma_f32_16x16x32_bf16 v[192:195], a[32:35], a[244:247], v[192:195]
  buffer_load_dwordx4 v12, s[8:11], s45 offen offset:256 lds
  v_mfma_f32_16x16x32_bf16 v[196:199], a[32:35], a[248:251], v[196:199]
  s_nop 0
  ds_read_b64_tr_b16 a[0:1], v4 offset:0
  ds_read_b64_tr_b16 a[2:3], v4 offset:6144
  v_mfma_f32_16x16x32_bf16 v[200:203], a[32:35], a[252:255], v[200:203]
  s_waitcnt lgkmcnt(6)
  ds_read_b64_tr_b16 a[4:5], v5 offset:0
  ds_read_b64_tr_b16 a[6:7], v5 offset:6144
  v_mfma_f32_16x16x32_bf16 v[212:215], a[36:39], a[252:255], v[212:215]
  v_mfma_f32_16x16x32_bf16 v[208:211], a[36:39], a[248:251], v[208:211]
  s_mov_b32 s44, s56
  s_add_u32 m0, s37, 0x9000
  v_mfma_f32_16x16x32_bf16 v[204:207], a[36:39], a[244:247], v[204:207]
  s_waitcnt lgkmcnt(6)
  ds_read_b64_tr_b16 a[8:9], v6 offset:0
  ds_read_b64_tr_b16 a[10:11], v6 offset:6144
  v_mfma_f32_16x16x32_bf16 v[216:219], a[40:43], a[244:247], v[216:219]
  buffer_load_dwordx4 v12, s[8:11], s44 offen lds
  v_mfma_f32_16x16x32_bf16 v[220:223], a[40:43], a[248:251], v[220:223]
  v_mfma_f32_16x16x32_bf16 v[224:227], a[40:43], a[252:255], v[224:227]
  s_waitcnt lgkmcnt(6)
  ds_read_b64_tr_b16 a[12:13], v7 offset:0
  ds_read_b64_tr_b16 a[14:15], v7 offset:6144
  v_mfma_f32_16x16x32_bf16 v[236:239], a[44:47], a[252:255], v[236:239]
  s_add_u32 s56, s56, 0x60000
  s_cmp_eq_u32 s56, 0x780000
  s_cselect_b32 s56, 0, s56
  v_mfma_f32_16x16x32_bf16 v[232:235], a[44:47], a[248:251], v[232:235]
  s_add_u32 m0, s37, 0x9380
  v_mfma_f32_16x16x32_bf16 v[228:231], a[44:47], a[244:247], v[228:231]
  s_waitcnt lgkmcnt(6)
  ds_read_b64_tr_b16 a[16:17], v4 offset:1024
  ds_read_b64_tr_b16 a[18:19], v4 offset:7168
  v_mfma_f32_16x16x32_bf16 v[96:99], a[0:3], a[112:115], v[96:99]
  buffer_load_dwordx4 v12, s[8:11], s44 offen offset:128 lds
  v_mfma_f32_16x16x32_bf16 v[100:103], a[0:3], a[116:119], v[100:103]
  v_mfma_f32_16x16x32_bf16 v[104:107], a[0:3], a[120:123], v[104:107]
  s_waitcnt lgkmcnt(6)
  ds_read_b64_tr_b16 a[20:21], v5 offset:1024
  ds_read_b64_tr_b16 a[22:23], v5 offset:7168
  v_mfma_f32_16x16x32_bf16 v[116:119], a[4:7], a[120:123], v[116:119]
  s_add_u32 m0, s37, 0x9700
  v_mfma_f32_16x16x32_bf16 v[112:115], a[4:7], a[116:119], v[112:115]
  buffer_load_dwordx4 v12, s[8:11], s44 offen offset:256 lds
  v_mfma_f32_16x16x32_bf16 v[108:111], a[4:7], a[112:115], v[108:111]
  s_waitcnt lgkmcnt(6)
  ds_read_b64_tr_b16 a[24:25], v6 offset:1024
  ds_read_b64_tr_b16 a[26:27], v6 offset:7168
  v_mfma_f32_16x16x32_bf16 v[120:123], a[8:11], a[112:115], v[120:123]
  v_mfma_f32_16x16x32_bf16 v[124:127], a[8:11], a[116:119], v[124:127]
  v_mfma_f32_16x16x32_bf16 v[128:131], a[8:11], a[120:123], v[128:131]
  s_waitcnt lgkmcnt(6)
  s_mov_b32 s45, 0
  s_add_u32 m0, s37, 0x18000
  v_mfma_f32_16x16x32_bf16 v[140:143], a[12:15], a[120:123], v[140:143]
  buffer_load_dwordx4 v13, s[12:15], s45 offen nt lds
  v_mfma_f32_16x16x32_bf16 v[136:139], a[12:15], a[116:119], v[136:139]
  s_nop 0
  ds_read_b64_tr_b16 a[28:29], v7 offset:1024
  ds_read_b64_tr_b16 a[30:31], v7 offset:7168
  v_mfma_f32_16x16x32_bf16 v[132:135], a[12:15], a[112:115], v[132:135]
  s_waitcnt lgkmcnt(6)
  ds_read_b64_tr_b16 a[32:33], v4 offset:2048
  ds_read_b64_tr_b16 a[34:35], v4 offset:8192
  v_mfma_f32_16x16x32_bf16 v[144:147], a[16:19], a[112:115], v[144:147]
  v_mfma_f32_16x16x32_bf16 v[148:151], a[16:19], a[116:119], v[148:151]
  s_add_u32 m0, s37, 0x18380
  v_mfma_f32_16x16x32_bf16 v[152:155], a[16:19], a[120:123], v[152:155]
  s_waitcnt lgkmcnt(6)
  ds_read_b64_tr_b16 a[36:37], v5 offset:2048
  ds_read_b64_tr_b16 a[38:39], v5 offset:8192
  v_mfma_f32_16x16x32_bf16 v[164:167], a[20:23], a[120:123], v[164:167]
  buffer_load_dwordx4 v13, s[12:15], s45 offen offset:128 nt lds
  v_mfma_f32_16x16x32_bf16 v[160:163], a[20:23], a[116:119], v[160:163]
  v_mfma_f32_16x16x32_bf16 v[156:159], a[20:23], a[112:115], v[156:159]
  s_waitcnt lgkmcnt(6)
  ds_read_b64_tr_b16 a[40:41], v6 offset:2048
  ds_read_b64_tr_b16 a[42:43], v6 offset:8192
  v_mfma_f32_16x16x32_bf16 v[168:171], a[24:27], a[112:115], v[168:171]
  v_mfma_f32_16x16x32_bf16 v[172:175], a[24:27], a[116:119], v[172:175]
  v_mfma_f32_16x16x32_bf16 v[176:179], a[24:27], a[120:123], v[176:179]
  s_waitcnt lgkmcnt(6)
  ds_read_b64_tr_b16 a[44:45], v7 offset:2048
  ds_read_b64_tr_b16 a[46:47], v7 offset:8192
  v_mfma_f32_16x16x32_bf16 v[188:191], a[28:31], a[120:123], v[188:191]
  v_mfma_f32_16x16x32_bf16 v[184:187], a[28:31], a[116:119], v[184:187]
  s_waitcnt vmcnt(14)
  s_barrier
  v_mfma_f32_16x16x32_bf16 v[180:183], a[28:31], a[112:115], v[180:183]
  s_waitcnt lgkmcnt(6)
  s_add_u32 m0, s37, 0x18700
  ds_read_b64_tr_b16 a[0:1], v4 offset:12288
  v_mfma_f32_16x16x32_bf16 v[192:195], a[32:35], a[112:115], v[192:195]
  buffer_load_dwordx4 v13, s[12:15], s45 offen offset:256 nt lds
  v_mfma_f32_16x16x32_bf16 v[196:199], a[32:35], a[116:119], v[196:199]
  ds_read_b64_tr_b16 a[2:3], v4 offset:18432
  v_mfma_f32_16x16x32_bf16 v[200:203], a[32:35], a[120:123], v[200:203]
  s_waitcnt lgkmcnt(6)
  ds_read_b64_tr_b16 a[4:5], v5 offset:12288
  ds_read_b64_tr_b16 a[6:7], v5 offset:18432
  v_mfma_f32_16x16x32_bf16 v[212:215], a[36:39], a[120:123], v[212:215]
  v_mfma_f32_16x16x32_bf16 v[208:211], a[36:39], a[116:119], v[208:211]
  s_mov_b32 s44, s56
  s_add_u32 m0, s37, 0xc000
  v_mfma_f32_16x16x32_bf16 v[204:207], a[36:39], a[112:115], v[204:207]
  s_waitcnt lgkmcnt(6)
  ds_read_b64_tr_b16 a[8:9], v6 offset:12288
  ds_read_b64_tr_b16 a[10:11], v6 offset:18432
  v_mfma_f32_16x16x32_bf16 v[216:219], a[40:43], a[112:115], v[216:219]
  buffer_load_dwordx4 v12, s[8:11], s44 offen lds
  v_mfma_f32_16x16x32_bf16 v[220:223], a[40:43], a[116:119], v[220:223]
  v_mfma_f32_16x16x32_bf16 v[224:227], a[40:43], a[120:123], v[224:227]
  s_waitcnt lgkmcnt(6)
  ds_read_b64_tr_b16 a[12:13], v7 offset:12288
  ds_read_b64_tr_b16 a[14:15], v7 offset:18432
  v_mfma_f32_16x16x32_bf16 v[236:239], a[44:47], a[120:123], v[236:239]
  s_add_u32 s56, s56, 0x60000
  s_cmp_eq_u32 s56, 0x780000
  s_cselect_b32 s56, 0, s56
  v_mfma_f32_16x16x32_bf16 v[232:235], a[44:47], a[116:119], v[232:235]
  s_add_u32 m0, s37, 0xc380
  v_mfma_f32_16x16x32_bf16 v[228:231], a[44:47], a[112:115], v[228:231]
  s_waitcnt lgkmcnt(6)
  ds_read_b64_tr_b16 a[16:17], v4 offset:13312
  ds_read_b64_tr_b16 a[18:19], v4 offset:19456
  v_mfma_f32_16x16x32_bf16 v[96:99], a[0:3], a[124:127], v[96:99]
  buffer_load_dwordx4 v12, s[8:11], s44 offen offset:128 lds
  v_mfma_f32_16x16x32_bf16 v[100:103], a[0:3], a[128:131], v[100:103]
  s_nop 0
  ds_read_b128 a[184:187], v10 offset:0
  ds_read_b128 a[188:191], v10 offset:2048
  v_mfma_f32_16x16x32_bf16 v[104:107], a[0:3], a[132:135], v[104:107]
  s_waitcnt lgkmcnt(8)
  ds_read_b64_tr_b16 a[20:21], v5 offset:13312
  ds_read_b64_tr_b16 a[22:23], v5 offset:19456
  v_mfma_f32_16x16x32_bf16 v[116:119], a[4:7], a[132:135], v[116:119]
  s_add_u32 m0, s37, 0xc700
  ds_read_b128 a[192:195], v10 offset:4096
  ds_read_b128 a[196:199], v11 offset:0
  v_mfma_f32_16x16x32_bf16 v[112:115], a[4:7], a[128:131], v[112:115]
  buffer_load_dwordx4 v12, s[8:11], s44 offen offset:256 lds
  v_mfma_f32_16x16x32_bf16 v[108:111], a[4:7], a[124:127], v[108:111]
  s_waitcnt lgkmcnt(10)
  ds_read_b64_tr_b16 a[24:25], v6 offset:13312
  ds_read_b64_tr_b16 a[26:27], v6 offset:19456
  v_mfma_f32_16x16x32_bf16 v[120:123], a[8:11], a[124:127], v[120:123]
  s_nop 0
  ds_read_b128 a[200:203], v11 offset:2048
  ds_read_b128 a[204:207], v11 offset:4096
  v_mfma_f32_16x16x32_bf16 v[124:127], a[8:11], a[128:131], v[124:127]
  v_mfma_f32_16x16x32_bf16 v[128:131], a[8:11], a[132:135], v[128:131]
  s_waitcnt lgkmcnt(12)
  s_mov_b32 s45, 0x3000
  s_add_u32 m0, s37, 0xf000
  v_mfma_f32_16x16x32_bf16 v[140:143], a[12:15], a[132:135], v[140:143]
  buffer_load_dwordx4 v13, s[12:15], s45 offen nt lds
  v_mfma_f32_16x16x32_bf16 v[136:139], a[12:15], a[128:131], v[136:139]
  s_nop 0
  ds_read_b64_tr_b16 a[28:29], v7 offset:13312
  ds_read_b64_tr_b16 a[30:31], v7 offset:19456
  v_mfma_f32_16x16x32_bf16 v[132:135], a[12:15], a[124:127], v[132:135]
  s_waitcnt lgkmcnt(12)
  ds_read_b64_tr_b16 a[32:33], v4 offset:14336
  ds_read_b64_tr_b16 a[34:35], v4 offset:20480
  v_mfma_f32_16x16x32_bf16 v[144:147], a[16:19], a[124:127], v[144:147]
  v_mfma_f32_16x16x32_bf16 v[148:151], a[16:19], a[128:131], v[148:151]
  s_add_u32 m0, s37, 0xf380
  v_mfma_f32_16x16x32_bf16 v[152:155], a[16:19], a[132:135], v[152:155]
  s_waitcnt lgkmcnt(10)
  ds_read_b64_tr_b16 a[36:37], v5 offset:14336
  ds_read_b64_tr_b16 a[38:39], v5 offset:20480
  v_mfma_f32_16x16x32_bf16 v[164:167], a[20:23], a[132:135], v[164:167]
  buffer_load_dwordx4 v13, s[12:15], s45 offen offset:128 nt lds
  v_mfma_f32_16x16x32_bf16 v[160:163], a[20:23], a[128:131], v[160:163]
  v_mfma_f32_16x16x32_bf16 v[156:159], a[20:23], a[124:127], v[156:159]
  s_waitcnt lgkmcnt(8)
  ds_read_b64_tr_b16 a[40:41], v6 offset:14336
  ds_read_b64_tr_b16 a[42:43], v6 offset:20480
  v_mfma_f32_16x16x32_bf16 v[168:171], a[24:27], a[124:127], v[168:171]
  v_mfma_f32_16x16x32_bf16 v[172:175], a[24:27], a[128:131], v[172:175]
  v_mfma_f32_16x16x32_bf16 v[176:179], a[24:27], a[132:135], v[176:179]
  s_waitcnt lgkmcnt(6)
  ds_read_b64_tr_b16 a[44:45], v7 offset:14336
  ds_read_b64_tr_b16 a[46:47], v7 offset:20480
  v_mfma_f32_16x16x32_bf16 v[188:191], a[28:31], a[132:135], v[188:191]
  v_add_u32 v4, 0xffff1000, v4
  v_add_u32 v5, 0xffff1000, v5
  v_mfma_f32_16x16x32_bf16 v[184:187], a[28:31], a[128:131], v[184:187]
  s_waitcnt vmcnt(17)
  s_barrier
  v_add_u32 v6, 0xffff1000, v6
  v_mfma_f32_16x16x32_bf16 v[180:183], a[28:31], a[124:127], v[180:183]
  s_waitcnt lgkmcnt(6)
  s_add_u32 m0, s37, 0xf700
  v_add_u32 v7, 0xffff1000, v7
  v_mfma_f32_16x16x32_bf16 v[192:195], a[32:35], a[124:127], v[192:195]
  buffer_load_dwordx4 v13, s[12:15], s45 offen offset:256 nt lds
  v_mfma_f32_16x16x32_bf16 v[196:199], a[32:35], a[128:131], v[196:199]
  s_nop 0
  ds_read_b64_tr_b16 a[0:1], v4 offset:0
  ds_read_b64_tr_b16 a[2:3], v4 offset:6144
  v_mfma_f32_16x16x32_bf16 v[200:203], a[32:35], a[132:135], v[200:203]
  s_waitcnt lgkmcnt(6)
  ds_read_b64_tr_b16 a[4:5], v5 offset:0
  ds_read_b64_tr_b16 a[6:7], v5 offset:6144
  v_mfma_f32_16x16x32_bf16 v[212:215], a[36:39], a[132:135], v[212:215]
  v_mfma_f32_16x16x32_bf16 v[208:211], a[36:39], a[128:131], v[208:211]
  s_mov_b32 s44, s56
  s_add_u32 m0, s37, 0x1b000
  v_mfma_f32_16x16x32_bf16 v[204:207], a[36:39], a[124:127], v[204:207]
  s_waitcnt lgkmcnt(6)
  ds_read_b64_tr_b16 a[8:9], v6 offset:0
  ds_read_b64_tr_b16 a[10:11], v6 offset:6144
  v_mfma_f32_16x16x32_bf16 v[216:219], a[40:43], a[124:127], v[216:219]
  buffer_load_dwordx4 v12, s[8:11], s44 offen lds
  v_mfma_f32_16x16x32_bf16 v[220:223], a[40:43], a[128:131], v[220:223]
  v_mfma_f32_16x16x32_bf16 v[224:227], a[40:43], a[132:135], v[224:227]
  s_waitcnt lgkmcnt(6)
  ds_read_b64_tr_b16 a[12:13], v7 offset:0
  ds_read_b64_tr_b16 a[14:15], v7 offset:6144
  v_mfma_f32_16x16x32_bf16 v[236:239], a[44:47], a[132:135], v[236:239]
  s_add_u32 s56, s56, 0x60000
  s_cmp_eq_u32 s56, 0x780000
  s_cselect_b32 s56, 0, s56
  v_mfma_f32_16x16x32_bf16 v[232:235], a[44:47], a[128:131], v[232:235]
  s_add_u32 m0, s37, 0x1b380
  v_mfma_f32_16x16x32_bf16 v[228:231], a[44:47], a[124:127], v[228:231]
  s_waitcnt lgkmcnt(6)
  ds_read_b64_tr_b16 a[16:17], v4 offset:1024
  ds_read_b64_tr_b16 a[18:19], v4 offset:7168
  v_mfma_f32_16x16x32_bf16 v[96:99], a[0:3], a[136:139], v[96:99]
  buffer_load_dwordx4 v12, s[8:11], s44 offen offset:128 lds
  v_mfma_f32_16x16x32_bf16 v[100:103], a[0:3], a[140:143], v[100:103]
  v_mfma_f32_16x16x32_bf16 v[104:107], a[0:3], a[144:147], v[104:107]
  s_waitcnt lgkmcnt(6)
  ds_read_b64_tr_b16 a[20:21], v5 offset:1024
  ds_read_b64_tr_b16 a[22:23], v5 offset:7168
  v_mfma_f32_16x16x32_bf16 v[116:119], a[4:7], a[144:147], v[116:119]
  s_add_u32 m0, s37, 0x1b700
  v_mfma_f32_16x16x32_bf16 v[112:115], a[4:7], a[140:143], v[112:115]
  buffer_load_dwordx4 v12, s[8:11], s44 offen offset:256 lds
  v_mfma_f32_16x16x32_bf16 v[108:111], a[4:7], a[136:139], v[108:111]
  s_waitcnt lgkmcnt(6)
  ds_read_b64_tr_b16 a[24:25], v6 offset:1024
  ds_read_b64_tr_b16 a[26:27], v6 offset:7168
  v_mfma_f32_16x16x32_bf16 v[120:123], a[8:11], a[136:139], v[120:123]
  v_mfma_f32_16x16x32_bf16 v[124:127], a[8:11], a[140:143], v[124:127]
  v_mfma_f32_16x16x32_bf16 v[128:131], a[8:11], a[144:147], v[128:131]
  s_waitcnt lgkmcnt(6)
  s_mov_b32 s45, 0
  s_add_u32 m0, s37, 0x1e000
  v_mfma_f32_16x16x32_bf16 v[140:143], a[12:15], a[144:147], v[140:143]
  buffer_load_dwordx4 v14, s[16:19], s45 offen nt lds
  v_mfma_f32_16x16x32_bf16 v[136:139], a[12:15], a[140:143], v[136:139]
  s_nop 0
  ds_read_b64_tr_b16 a[28:29], v7 offset:1024
  ds_read_b64_tr_b16 a[30:31], v7 offset:7168
  v_mfma_f32_16x16x32_bf16 v[132:135], a[12:15], a[136:139], v[132:135]
  s_waitcnt lgkmcnt(6)
  ds_read_b64_tr_b16 a[32:33], v4 offset:2048
  ds_read_b64_tr_b16 a[34:35], v4 offset:8192
  v_mfma_f32_16x16x32_bf16 v[144:147], a[16:19], a[136:139], v[144:147]
  v_mfma_f32_16x16x32_bf16 v[148:151], a[16:19], a[140:143], v[148:151]
  s_add_u32 m0, s37, 0x1e380
  v_mfma_f32_16x16x32_bf16 v[152:155], a[16:19], a[144:147], v[152:155]
  s_waitcnt lgkmcnt(6)
  ds_read_b64_tr_b16 a[36:37], v5 offset:2048
  ds_read_b64_tr_b16 a[38:39], v5 offset:8192
  v_mfma_f32_16x16x32_bf16 v[164:167], a[20:23], a[144:147], v[164:167]
  buffer_load_dwordx4 v14, s[16:19], s45 offen offset:128 nt lds
  v_mfma_f32_16x16x32_bf16 v[160:163], a[20:23], a[140:143], v[160:163]
  v_mfma_f32_16x16x32_bf16 v[156:159], a[20:23], a[136:139], v[156:159]
  s_waitcnt lgkmcnt(6)
  ds_read_b64_tr_b16 a[40:41], v6 offset:2048
  ds_read_b64_tr_b16 a[42:43], v6 offset:8192
  v_mfma_f32_16x16x32_bf16 v[168:171], a[24:27], a[136:139], v[168:171]
  v_mfma_f32_16x16x32_bf16 v[172:175], a[24:27], a[140:143], v[172:175]
  v_mfma_f32_16x16x32_bf16 v[176:179], a[24:27], a[144:147], v[176:179]
  s_waitcnt lgkmcnt(6)
  ds_read_b64_tr_b16 a[44:45], v7 offset:2048
  ds_read_b64_tr_b16 a[46:47], v7 offset:8192
  v_mfma_f32_16x16x32_bf16 v[188:191], a[28:31], a[144:147], v[188:191]
  v_mfma_f32_16x16x32_bf16 v[184:187], a[28:31], a[140:143], v[184:187]
  s_waitcnt vmcnt(20)
  s_barrier
  v_mfma_f32_16x16x32_bf16 v[180:183], a[28:31], a[136:139], v[180:183]
  s_waitcnt lgkmcnt(6)
  s_add_u32 m0, s37, 0x1e700
  ds_read_b64_tr_b16 a[0:1], v4 offset:12288
  v_mfma_f32_16x16x32_bf16 v[192:195], a[32:35], a[136:139], v[192:195]
  buffer_load_dwordx4 v14, s[16:19], s45 offen offset:256 nt lds
  v_mfma_f32_16x16x32_bf16 v[196:199], a[32:35], a[140:143], v[196:199]
  ds_read_b64_tr_b16 a[2:3], v4 offset:18432
  v_mfma_f32_16x16x32_bf16 v[200:203], a[32:35], a[144:147], v[200:203]
  s_waitcnt lgkmcnt(6)
  ds_read_b64_tr_b16 a[4:5], v5 offset:12288
  ds_read_b64_tr_b16 a[6:7], v5 offset:18432
  v_mfma_f32_16x16x32_bf16 v[212:215], a[36:39], a[144:147], v[212:215]
  v_mfma_f32_16x16x32_bf16 v[208:211], a[36:39], a[140:143], v[208:211]
  v_mfma_f32_16x16x32_bf16 v[204:207], a[36:39], a[136:139], v[204:207]
  s_waitcnt lgkmcnt(6)
  s_mov_b32 s44, 0x6000
  s_add_u32 m0, s37, 0
  v_mfma_f32_16x16x32_bf16 v[216:219], a[40:43], a[136:139], v[216:219]
  buffer_load_dwordx4 v13, s[12:15], s44 offen nt lds
  v_mfma_f32_16x16x32_bf16 v[220:223], a[40:43], a[140:143], v[220:223]
  s_nop 0
  ds_read_b64_tr_b16 a[8:9], v6 offset:12288
  ds_read_b64_tr_b16 a[10:11], v6 offset:18432
  v_mfma_f32_16x16x32_bf16 v[224:227], a[40:43], a[144:147], v[224:227]
  s_waitcnt lgkmcnt(6)
  ds_read_b64_tr_b16 a[12:13], v7 offset:12288
  ds_read_b64_tr_b16 a[14:15], v7 offset:18432
  v_mfma_f32_16x16x32_bf16 v[236:239], a[44:47], a[144:147], v[236:239]
  v_mfma_f32_16x16x32_bf16 v[232:235], a[44:47], a[140:143], v[232:235]
  v_mfma_f32_16x16x32_bf16 v[228:231], a[44:47], a[136:139], v[228:231]
  s_waitcnt lgkmcnt(6)
  s_add_u32 m0, s37, 0x380
  ds_read_b64_tr_b16 a[16:17], v4 offset:13312
  v_mfma_f32_16x16x32_bf16 v[96:99], a[0:3], a[148:151], v[96:99]
  buffer_load_dwordx4 v13, s[12:15], s44 offen offset:128 nt lds
  v_mfma_f32_16x16x32_bf16 v[100:103], a[0:3], a[152:155], v[100:103]
  ds_read_b64_tr_b16 a[18:19], v4 offset:19456
  v_mfma_f32_16x16x32_bf16 v[104:107], a[0:3], a[156:159], v[104:107]
  s_waitcnt lgkmcnt(6)
  ds_read_b64_tr_b16 a[20:21], v5 offset:13312
  ds_read_b64_tr_b16 a[22:23], v5 offset:19456
  v_mfma_f32_16x16x32_bf16 v[116:119], a[4:7], a[156:159], v[116:119]
  v_mfma_f32_16x16x32_bf16 v[112:115], a[4:7], a[152:155], v[112:115]
  v_mfma_f32_16x16x32_bf16 v[108:111], a[4:7], a[148:151], v[108:111]
  s_waitcnt lgkmcnt(6)
  ds_read_b64_tr_b16 a[24:25], v6 offset:13312
  ds_read_b64_tr_b16 a[26:27], v6 offset:19456
  v_mfma_f32_16x16x32_bf16 v[120:123], a[8:11], a[148:151], v[120:123]
  s_add_u32 m0, s37, 0x700
  v_mfma_f32_16x16x32_bf16 v[124:127], a[8:11], a[152:155], v[124:127]
  buffer_load_dwordx4 v13, s[12:15], s44 offen offset:256 nt lds
  v_mfma_f32_16x16x32_bf16 v[128:131], a[8:11], a[156:159], v[128:131]
  s_waitcnt lgkmcnt(6)
  ds_read_b64_tr_b16 a[28:29], v7 offset:13312
  ds_read_b64_tr_b16 a[30:31], v7 offset:19456
  v_mfma_f32_16x16x32_bf16 v[140:143], a[12:15], a[156:159], v[140:143]
  v_mfma_f32_16x16x32_bf16 v[136:139], a[12:15], a[152:155], v[136:139]
  v_mfma_f32_16x16x32_bf16 v[132:135], a[12:15], a[148:151], v[132:135]
  s_waitcnt lgkmcnt(6)
  ds_read_b64_tr_b16 a[32:33], v4 offset:14336
  ds_read_b64_tr_b16 a[34:35], v4 offset:20480
  v_mfma_f32_16x16x32_bf16 v[144:147], a[16:19], a[148:151], v[144:147]
  s_mov_b32 s45, 0x3000
  s_add_u32 m0, s37, 0x3000
  v_mfma_f32_16x16x32_bf16 v[148:151], a[16:19], a[152:155], v[148:151]
  buffer_load_dwordx4 v14, s[16:19], s45 offen nt lds
  v_mfma_f32_16x16x32_bf16 v[152:155], a[16:19], a[156:159], v[152:155]
  s_waitcnt lgkmcnt(6)
  ds_read_b64_tr_b16 a[36:37], v5 offset:14336
  ds_read_b64_tr_b16 a[38:39], v5 offset:20480
  v_mfma_f32_16x16x32_bf16 v[164:167], a[20:23], a[156:159], v[164:167]
  v_mfma_f32_16x16x32_bf16 v[160:163], a[20:23], a[152:155], v[160:163]
  v_mfma_f32_16x16x32_bf16 v[156:159], a[20:23], a[148:151], v[156:159]
  s_waitcnt lgkmcnt(6)
  ds_read_b64_tr_b16 a[40:41], v6 offset:14336
  ds_read_b64_tr_b16 a[42:43], v6 offset:20480
  v_mfma_f32_16x16x32_bf16 v[168:171], a[24:27], a[148:151], v[168:171]
  v_mfma_f32_16x16x32_bf16 v[172:175], a[24:27], a[152:155], v[172:175]
  v_mfma_f32_16x16x32_bf16 v[176:179], a[24:27], a[156:159], v[176:179]
  s_waitcnt lgkmcnt(6)
  ds_read_b64_tr_b16 a[44:45], v7 offset:14336
  ds_read_b64_tr_b16 a[46:47], v7 offset:20480
  v_mfma_f32_16x16x32_bf16 v[188:191], a[28:31], a[156:159], v[188:191]
  v_add_u32 v72, 0xfffee000, v4
  v_add_u32 v73, 0xfffee000, v5
  v_mfma_f32_16x16x32_bf16 v[184:187], a[28:31], a[152:155], v[184:187]
  s_waitcnt vmcnt(7)
  s_barrier
  v_add_u32 v74, 0xfffee000, v6
  v_mfma_f32_16x16x32_bf16 v[180:183], a[28:31], a[148:151], v[180:183]
  s_waitcnt lgkmcnt(6)
  s_add_u32 m0, s37, 0x3380
  v_add_u32 v75, 0xfffee000, v7
  v_mfma_f32_16x16x32_bf16 v[192:195], a[32:35], a[148:151], v[192:195]
  buffer_load_dwordx4 v14, s[16:19], s45 offen offset:128 nt lds
  v_mfma_f32_16x16x32_bf16 v[196:199], a[32:35], a[152:155], v[196:199]
  v_add_u32 v76, 0xffffd000, v4
  v_add_u32 v77, 0xffffd000, v5
  v_mfma_f32_16x16x32_bf16 v[200:203], a[32:35], a[156:159], v[200:203]
  s_waitcnt lgkmcnt(4)
  v_add_u32 v78, 0xffffd000, v6
  v_add_u32 v79, 0xffffd000, v7
  v_mfma_f32_16x16x32_bf16 v[212:215], a[36:39], a[156:159], v[212:215]
  v_add_u32 v80, 0xc000, v4
  v_add_u32 v81, 0xc000, v5
  v_mfma_f32_16x16x32_bf16 v[208:211], a[36:39], a[152:155], v[208:211]
  v_add_u32 v82, 0xc000, v6
  v_add_u32 v83, 0xc000, v7
  v_mfma_f32_16x16x32_bf16 v[204:207], a[36:39], a[148:151], v[204:207]
  s_waitcnt lgkmcnt(2)
  ds_read_b64_tr_b16 a[0:1], v72 offset:24576
  ds_read_b64_tr_b16 a[2:3], v72 offset:30720
  v_mfma_f32_16x16x32_bf16 v[216:219], a[40:43], a[148:151], v[216:219]
  s_add_u32 m0, s37, 0x3700
  ds_read_b64_tr_b16 a[4:5], v72 offset:36864
  ds_read_b64_tr_b16 a[6:7], v72 offset:43008
  v_mfma_f32_16x16x32_bf16 v[220:223], a[40:43], a[152:155], v[220:223]
  s_nop 0
  ds_read_b64_tr_b16 a[8:9], v72 offset:49152
  ds_read_b64_tr_b16 a[10:11], v72 offset:55296
  v_mfma_f32_16x16x32_bf16 v[224:227], a[40:43], a[156:159], v[224:227]
  s_waitcnt lgkmcnt(6)
  ds_read_b64_tr_b16 a[12:13], v76 offset:49152
  ds_read_b64_tr_b16 a[14:15], v76 offset:55296
  v_mfma_f32_16x16x32_bf16 v[236:239], a[44:47], a[156:159], v[236:239]
  buffer_load_dwordx4 v14, s[16:19], s45 offen offset:256 nt lds
  v_mfma_f32_16x16x32_bf16 v[232:235], a[44:47], a[152:155], v[232:235]
  s_nop 0
  ds_read_b64_tr_b16 a[16:17], v73 offset:24576
  ds_read_b64_tr_b16 a[18:19], v73 offset:30720
  v_mfma_f32_16x16x32_bf16 v[228:231], a[44:47], a[148:151], v[228:231]
  s_waitcnt lgkmcnt(8)
  s_mov_b32 s44, 0x9000
  s_add_u32 m0, s37, 0x21000
  v_mfma_f32_16x16x32_bf16 v[96:99], a[0:3], a[160:163], v[96:99]
  s_waitcnt lgkmcnt(6)
  buffer_load_dwordx4 v13, s[12:15], s44 offen nt lds
  v_mfma_f32_16x16x32_bf16 v[96:99], a[4:7], a[172:175], v[96:99]
  s_waitcnt lgkmcnt(4)
  ds_read_b64_tr_b16 a[20:21], v73 offset:36864
  ds_read_b64_tr_b16 a[22:23], v73 offset:43008
  v_mfma_f32_16x16x32_bf16 v[96:99], a[8:11], a[184:187], v[96:99]
  s_waitcnt lgkmcnt(4)
  s_nop 0
  ds_read_b64_tr_b16 a[24:25], v73 offset:49152
  ds_read_b64_tr_b16 a[26:27], v73 offset:55296
  v_mfma_f32_16x16x32_bf16 v[96:99], a[12:15], a[196:199], v[96:99]
  s_nop 0
  ds_read_b64_tr_b16 a[28:29], v77 offset:49152
  ds_read_b64_tr_b16 a[30:31], v77 offset:55296
  v_mfma_f32_16x16x32_bf16 v[100:103], a[0:3], a[164:167], v[100:103]
L_hop2:
  s_cbranch_execz L_hop6
  v_mov_b32 v26, 0x3dd53b95
  v_mfma_f32_16x16x32_bf16 v[100:103], a[4:7], a[176:179], v[100:103]
  v_mfma_f32_16x16x32_bf16 v[100:103], a[8:11], a[188:191], v[100:103]
  s_add_u32 m0, s37, 0x21380
  ds_read_b64_tr_b16 a[32:33], v74 offset:24576
  ds_read_b64_tr_b16 a[34:35], v74 offset:30720
  v_mfma_f32_16x16x32_bf16 v[100:103], a[12:15], a[200:203], v[100:103]
  buffer_load_dwordx4 v13, s[12:15], s44 offen offset:128 nt lds
  v_mfma_f32_16x16x32_bf16 v[104:107], a[0:3], a[168:171], v[104:107]
  s_nop 0
  ds_read_b64_tr_b16 a[36:37], v74 offset:36864
  ds_read_b64_tr_b16 a[38:39], v74 offset:43008
  v_mfma_f32_16x16x32_bf16 v[104:107], a[4:7], a[180:183], v[104:107]
  s_nop 0
  ds_read_b64_tr_b16 a[40:41], v74 offset:49152
  ds_read_b64_tr_b16 a[42:43], v74 offset:55296
  v_mfma_f32_16x16x32_bf16 v[104:107], a[8:11], a[192:195], v[104:107]
  s_nop 0
  ds_read_b64_tr_b16 a[44:45], v78 offset:49152
  ds_read_b64_tr_b16 a[46:47], v78 offset:55296
  v_mfma_f32_16x16x32_bf16 v[104:107], a[12:15], a[204:207], v[104:107]
  s_waitcnt lgkmcnt(14)
  v_mfma_f32_16x16x32_bf16 v[108:111], a[16:19], a[160:163], v[108:111]
  s_waitcnt lgkmcnt(12)
  s_add_u32 m0, s37, 0x21700
  v_mfma_f32_16x16x32_bf16 v[108:111], a[20:23], a[172:175], v[108:111]
  s_waitcnt lgkmcnt(10)
  v_mfma_f32_16x16x32_bf16 v[108:111], a[24:27], a[184:187], v[108:111]
  s_waitcnt lgkmcnt(8)
  buffer_load_dwordx4 v13, s[12:15], s44 offen offset:256 nt lds
  v_mfma_f32_16x16x32_bf16 v[108:111], a[28:31], a[196:199], v[108:111]
  v_mfma_f32_16x16x32_bf16 v[112:115], a[16:19], a[164:167], v[112:115]
  v_mfma_f32_16x16x32_bf16 v[112:115], a[20:23], a[176:179], v[112:115]
  v_mul_f32 v96, v26, v96
  v_mul_f32 v97, v26, v97
  v_mfma_f32_16x16x32_bf16 v[112:115], a[24:27], a[188:191], v[112:115]
  v_cvt_pk_bf16_f32 v240, v96, v97
  v_mul_f32 v98, v26, v98
  v_mfma_f32_16x16x32_bf16 v[112:115], a[28:31], a[200:203], v[112:115]
  v_mul_f32 v99, v26, v99
  v_cvt_pk_bf16_f32 v241, v98, v99
  v_mfma_f32_16x16x32_bf16 v[116:119], a[16:19], a[168:171], v[116:119]
  v_mul_f32 v108, v26, v108
  v_mul_f32 v109, v26, v109
  v_mfma_f32_16x16x32_bf16 v[116:119], a[20:23], a[180:183], v[116:119]
  v_cvt_pk_bf16_f32 v242, v108, v109
  v_mul_f32 v110, v26, v110
  v_mfma_f32_16x16x32_bf16 v[116:119], a[24:27], a[192:195], v[116:119]
  s_barrier
  v_mul_f32 v111, v26, v111
  v_cvt_pk_bf16_f32 v243, v110, v111
  v_mfma_f32_16x16x32_bf16 v[116:119], a[28:31], a[204:207], v[116:119]
  s_waitcnt lgkmcnt(6)
  v_permlane16_swap_b32 v240, v242
  v_mfma_f32_16x16x32_bf16 v[120:123], a[32:35], a[160:163], v[120:123]
  s_waitcnt lgkmcnt(4)
  s_mov_b32 s45, 0x6000
  v_permlane16_swap_b32 v241, v243
  v_accvgpr_write_b32 a48, v240
  v_mfma_f32_16x16x32_bf16 v[120:123], a[36:39], a[172:175], v[120:123]
  s_waitcnt lgkmcnt(2)
  v_accvgpr_write_b32 a49, v241
  v_accvgpr_write_b32 a50, v242
  v_accvgpr_write_b32 a51, v243
  v_mfma_f32_16x16x32_bf16 v[120:123], a[40:43], a[184:187], v[120:123]
  s_waitcnt lgkmcnt(0)
  s_add_u32 m0, s37, 0x24000
  v_mul_f32 v100, v26, v100
  v_mul_f32 v101, v26, v101
  v_cvt_pk_bf16_f32 v244, v100, v101
  v_mfma_f32_16x16x32_bf16 v[120:123], a[44:47], a[196:199], v[120:123]
  buffer_load_dwordx4 v14, s[16:19], s45 offen nt lds
  v_mul_f32 v102, v26, v102
  v_mfma_f32_16x16x32_bf16 v[124:127], a[32:35], a[164:167], v[124:127]
  v_mul_f32 v103, v26, v103
  v_cvt_pk_bf16_f32 v245, v102, v103
  v_mul_f32 v112, v26, v112
  v_mfma_f32_16x16x32_bf16 v[124:127], a[36:39], a[176:179], v[124:127]
  ds_read_b64_tr_b16 a[0:1], v75 offset:24576
  ds_read_b64_tr_b16 a[2:3], v75 offset:30720
  v_mul_f32 v113, v26, v113
  v_mfma_f32_16x16x32_bf16 v[124:127], a[40:43], a[188:191], v[124:127]
  ds_read_b64_tr_b16 a[4:5], v75 offset:36864
  ds_read_b64_tr_b16 a[6:7], v75 offset:43008
  v_cvt_pk_bf16_f32 v246, v112, v113
  v_mfma_f32_16x16x32_bf16 v[124:127], a[44:47], a[200:203], v[124:127]
  ds_read_b64_tr_b16 a[8:9], v75 offset:49152
  ds_read_b64_tr_b16 a[10:11], v75 offset:55296
  v_mul_f32 v114, v26, v114
  v_mfma_f32_16x16x32_bf16 v[128:131], a[32:35], a[168:171], v[128:131]
  ds_read_b64_tr_b16 a[12:13], v79 offset:49152
  ds_read_b64_tr_b16 a[14:15], v79 offset:55296
  v_mul_f32 v115, v26, v115
  v_mfma_f32_16x16x32_bf16 v[128:131], a[36:39], a[180:183], v[128:131]
  s_add_u32 m0, s37, 0x24380
  ds_read_b64_tr_b16 a[16:17], v72 offset:25600
  ds_read_b64_tr_b16 a[18:19], v72 offset:31744
  v_cvt_pk_bf16_f32 v247, v114, v115
  v_mfma_f32_16x16x32_bf16 v[128:131], a[40:43], a[192:195], v[128:131]
  buffer_load_dwordx4 v14, s[16:19], s45 offen offset:128 nt lds
  ds_read_b64_tr_b16 a[20:21], v72 offset:37888
  v_mfma_f32_16x16x32_bf16 v[128:131], a[44:47], a[204:207], v[128:131]
  s_waitcnt lgkmcnt(9)
  ds_read_b64_tr_b16 a[22:23], v72 offset:44032
  v_permlane16_swap_b32 v244, v246
  v_mfma_f32_16x16x32_bf16 v[132:135], a[0:3], a[160:163], v[132:135]
  s_waitcnt lgkmcnt(8)
  v_permlane16_swap_b32 v245, v247
  v_accvgpr_write_b32 a52, v244
  v_mfma_f32_16x16x32_bf16 v[132:135], a[4:7], a[172:175], v[132:135]
  s_waitcnt lgkmcnt(6)
  v_accvgpr_write_b32 a53, v245
  v_accvgpr_write_b32 a54, v246
  v_accvgpr_write_b32 a55, v247
  v_mfma_f32_16x16x32_bf16 v[132:135], a[8:11], a[184:187], v[132:135]
  s_waitcnt lgkmcnt(4)
  v_mul_f32 v104, v26, v104
  v_mul_f32 v105, v26, v105
  v_cvt_pk_bf16_f32 v248, v104, v105
  v_mfma_f32_16x16x32_bf16 v[132:135], a[12:15], a[196:199], v[132:135]
  v_mul_f32 v106, v26, v106
  v_mul_f32 v107, v26, v107
  v_cvt_pk_bf16_f32 v249, v106, v107
  v_mfma_f32_16x16x32_bf16 v[136:139], a[0:3], a[164:167], v[136:139]
  v_mul_f32 v116, v26, v116
  v_mul_f32 v117, v26, v117
  v_cvt_pk_bf16_f32 v250, v116, v117
  v_mfma_f32_16x16x32_bf16 v[136:139], a[4:7], a[176:179], v[136:139]
  v_mul_f32 v118, v26, v118
  v_mul_f32 v119, v26, v119
  v_cvt_pk_bf16_f32 v251, v118, v119
  v_mfma_f32_16x16x32_bf16 v[136:139], a[8:11], a[188:191], v[136:139]
  ds_read_b64_tr_b16 a[24:25], v72 offset:50176
  v_permlane16_swap_b32 v248, v250
  v_mfma_f32_16x16x32_bf16 v[136:139], a[12:15], a[200:203], v[136:139]
  ds_read_b64_tr_b16 a[26:27], v72 offset:56320
  v_permlane16_swap_b32 v249, v251
  v_mfma_f32_16x16x32_bf16 v[140:143], a[0:3], a[168:171], v[140:143]
  s_add_u32 m0, s37, 0x24700
  ds_read_b64_tr_b16 a[28:29], v76 offset:50176
  ds_read_b64_tr_b16 a[30:31], v76 offset:56320
  v_accvgpr_write_b32 a56, v248
  v_mfma_f32_16x16x32_bf16 v[140:143], a[4:7], a[180:183], v[140:143]
  buffer_load_dwordx4 v14, s[16:19], s45 offen offset:256 nt lds
  v_accvgpr_write_b32 a57, v249
  v_mfma_f32_16x16x32_bf16 v[140:143], a[8:11], a[192:195], v[140:143]
  v_accvgpr_write_b32 a58, v250
  v_accvgpr_write_b32 a59, v251
  v_mul_f32 v120, v26, v120
  v_mfma_f32_16x16x32_bf16 v[140:143], a[12:15], a[204:207], v[140:143]
  s_waitcnt lgkmcnt(6)
  v_mul_f32 v121, v26, v121
  v_cvt_pk_bf16_f32 v252, v120, v121
  v_mul_f32 v122, v26, v122
  v_mfma_f32_16x16x32_bf16 v[144:147], a[16:19], a[160:163], v[144:147]
  s_waitcnt lgkmcnt(4)
  v_mul_f32 v123, v26, v123
  v_cvt_pk_bf16_f32 v253, v122, v123
  v_mul_f32 v132, v26, v132
  v_mfma_f32_16x16x32_bf16 v[144:147], a[20:23], a[172:175], v[144:147]
  s_waitcnt lgkmcnt(2)
  v_mul_f32 v133, v26, v133
  v_cvt_pk_bf16_f32 v254, v132, v133
  v_mul_f32 v134, v26, v134
  v_mfma_f32_16x16x32_bf16 v[144:147], a[24:27], a[184:187], v[144:147]
  s_waitcnt lgkmcnt(0)
  ds_read_b64_tr_b16 a[32:33], v73 offset:25600
  v_mul_f32 v135, v26, v135
  v_cvt_pk_bf16_f32 v255, v134, v135
  v_mfma_f32_16x16x32_bf16 v[144:147], a[28:31], a[196:199], v[144:147]
  ds_read_b64_tr_b16 a[34:35], v73 offset:31744
  v_permlane16_swap_b32 v252, v254
  v_mfma_f32_16x16x32_bf16 v[148:151], a[16:19], a[164:167], v[148:151]
  v_permlane16_swap_b32 v253, v255
  v_accvgpr_write_b32 a60, v252
  v_mfma_f32_16x16x32_bf16 v[148:151], a[20:23], a[176:179], v[148:151]
  v_accvgpr_write_b32 a61, v253
  v_accvgpr_write_b32 a62, v254
  v_accvgpr_write_b32 a63, v255
  v_mfma_f32_16x16x32_bf16 v[148:151], a[24:27], a[188:191], v[148:151]
  ds_read_b64_tr_b16 a[36:37], v73 offset:37888
  ds_read_b64_tr_b16 a[38:39], v73 offset:44032
  v_mul_f32 v124, v26, v124
  v_mfma_f32_16x16x32_bf16 v[148:151], a[28:31], a[200:203], v[148:151]
  ds_read_b64_tr_b16 a[40:41], v73 offset:50176
  ds_read_b64_tr_b16 a[42:43], v73 offset:56320
  v_mul_f32 v125, v26, v125
  v_mfma_f32_16x16x32_bf16 v[152:155], a[16:19], a[168:171], v[152:155]
  ds_read_b64_tr_b16 a[44:45], v77 offset:50176
  ds_read_b64_tr_b16 a[46:47], v77 offset:56320
  v_cvt_pk_bf16_f32 v240, v124, v125
  v_mfma_f32_16x16x32_bf16 v[152:155], a[20:23], a[180:183], v[152:155]
  v_mul_f32 v126, v26, v126
  v_mul_f32 v127, v26, v127
  v_cvt_pk_bf16_f32 v241, v126, v127
  v_mfma_f32_16x16x32_bf16 v[152:155], a[24:27], a[192:195], v[152:155]
  v_mul_f32 v136, v26, v136
  v_mul_f32 v137, v26, v137
  v_cvt_pk_bf16_f32 v242, v136, v137
  v_mfma_f32_16x16x32_bf16 v[152:155], a[28:31], a[204:207], v[152:155]
  s_waitcnt lgkmcnt(6)
  v_mul_f32 v138, v26, v138
  v_mul_f32 v139, v26, v139
  v_cvt_pk_bf16_f32 v243, v138, v139
  v_mfma_f32_16x16x32_bf16 v[156:159], a[32:35], a[160:163], v[156:159]
  s_waitcnt lgkmcnt(4)
  s_mov_b32 s44, 0xc000
  ds_read_b64_tr_b16 a[0:1], v74 offset:25600
  v_permlane16_swap_b32 v240, v242
  v_mfma_f32_16x16x32_bf16 v[156:159], a[36:39], a[172:175], v[156:159]
  s_waitcnt lgkmcnt(3)
  v_permlane16_swap_b32 v241, v243
  v_accvgpr_write_b32 a64, v240
  v_mfma_f32_16x16x32_bf16 v[156:159], a[40:43], a[184:187], v[156:159]
  s_waitcnt lgkmcnt(1)
  s_add_u32 m0, s37, 0x12000
  v_accvgpr_write_b32 a65, v241
  v_accvgpr_write_b32 a66, v242
  v_accvgpr_write_b32 a67, v243
  v_mfma_f32_16x16x32_bf16 v[156:159], a[44:47], a[196:199], v[156:159]
  buffer_load_dwordx4 v13, s[12:15], s44 offen nt lds
  v_mul_f32 v128, v26, v128
  v_mfma_f32_16x16x32_bf16 v[160:163], a[32:35], a[164:167], v[160:163]
  v_mul_f32 v129, v26, v129
  v_cvt_pk_bf16_f32 v244, v128, v129
  v_mul_f32 v130, v26, v130
  v_mfma_f32_16x16x32_bf16 v[160:163], a[36:39], a[176:179], v[160:163]
  ds_read_b64_tr_b16 a[2:3], v74 offset:31744
  v_mul_f32 v131, v26, v131
  v_cvt_pk_bf16_f32 v245, v130, v131
  v_mfma_f32_16x16x32_bf16 v[160:163], a[40:43], a[188:191], v[160:163]
  ds_read_b64_tr_b16 a[4:5], v74 offset:37888
  ds_read_b64_tr_b16 a[6:7], v74 offset:44032
  v_mul_f32 v140, v26, v140
  v_mfma_f32_16x16x32_bf16 v[160:163], a[44:47], a[200:203], v[160:163]
  ds_read_b64_tr_b16 a[8:9], v74 offset:50176
  ds_read_b64_tr_b16 a[10:11], v74 offset:56320
  v_mul_f32 v141, v26, v141
  v_mfma_f32_16x16x32_bf16 v[164:167], a[32:35], a[168:171], v[164:167]
  ds_read_b64_tr_b16 a[12:13], v78 offset:50176
  ds_read_b64_tr_b16 a[14:15], v78 offset:56320
  v_cvt_pk_bf16_f32 v246, v140, v141
  v_mfma_f32_16x16x32_bf16 v[164:167], a[36:39], a[180:183], v[164:167]
  s_add_u32 m0, s37, 0x12380
  v_mul_f32 v142, v26, v142
  v_mul_f32 v143, v26, v143
  v_cvt_pk_bf16_f32 v247, v142, v143
  v_mfma_f32_16x16x32_bf16 v[164:167], a[40:43], a[192:195], v[164:167]
  buffer_load_dwordx4 v13, s[12:15], s44 offen offset:128 nt lds
  ds_read_b64_tr_b16 a[16:17], v75 offset:25600
  v_mfma_f32_16x16x32_bf16 v[164:167], a[44:47], a[204:207], v[164:167]
  s_waitcnt lgkmcnt(7)
  ds_read_b64_tr_b16 a[18:19], v75 offset:31744
  v_permlane16_swap_b32 v244, v246
  v_mfma_f32_16x16x32_bf16 v[168:171], a[0:3], a[160:163], v[168:171]
  s_waitcnt lgkmcnt(6)
  v_permlane16_swap_b32 v245, v247
  v_accvgpr_write_b32 a68, v244
  v_mfma_f32_16x16x32_bf16 v[168:171], a[4:7], a[172:175], v[168:171]
  s_waitcnt lgkmcnt(4)
  v_accvgpr_write_b32 a69, v245
  v_accvgpr_write_b32 a70, v246
  v_accvgpr_write_b32 a71, v247
  v_mfma_f32_16x16x32_bf16 v[168:171], a[8:11], a[184:187], v[168:171]
  s_waitcnt lgkmcnt(2)
  v_mul_f32 v144, v26, v144
  v_mul_f32 v145, v26, v145
  v_cvt_pk_bf16_f32 v248, v144, v145
  v_mfma_f32_16x16x32_bf16 v[168:171], a[12:15], a[196:199], v[168:171]
  v_mul_f32 v146, v26, v146
  v_mul_f32 v147, v26, v147
  v_cvt_pk_bf16_f32 v249, v146, v147
  v_mfma_f32_16x16x32_bf16 v[172:175], a[0:3], a[164:167], v[172:175]
  v_mul_f32 v156, v26, v156
  v_mul_f32 v157, v26, v157
  v_cvt_pk_bf16_f32 v250, v156, v157
  v_mfma_f32_16x16x32_bf16 v[172:175], a[4:7], a[176:179], v[172:175]
  v_mul_f32 v158, v26, v158
  v_mul_f32 v159, v26, v159
  v_cvt_pk_bf16_f32 v251, v158, v159
  v_mfma_f32_16x16x32_bf16 v[172:175], a[8:11], a[188:191], v[172:175]
  ds_read_b64_tr_b16 a[20:21], v75 offset:37888
  ds_read_b64_tr_b16 a[22:23], v75 offset:44032
  ds_read_b64_tr_b16 a[24:25], v75 offset:50176
  v_mfma_f32_16x16x32_bf16 v[172:175], a[12:15], a[200:203], v[172:175]
  ds_read_b64_tr_b16 a[26:27], v75 offset:56320
  v_permlane16_swap_b32 v248, v250
  v_mfma_f32_16x16x32_bf16 v[176:179], a[0:3], a[168:171], v[176:179]
  s_add_u32 m0, s37, 0x12700
  ds_read_b64_tr_b16 a[28:29], v79 offset:50176
  ds_read_b64_tr_b16 a[30:31], v79 offset:56320
  ds_read_b64_tr_b16 a[32:33], v72 offset:26624
  v_mfma_f32_16x16x32_bf16 v[176:179], a[4:7], a[180:183], v[176:179]
  buffer_load_dwordx4 v13, s[12:15], s44 offen offset:256 nt lds
  ds_read_b64_tr_b16 a[34:35], v72 offset:32768
  v_mfma_f32_16x16x32_bf16 v[176:179], a[8:11], a[192:195], v[176:179]
  v_permlane16_swap_b32 v249, v251
  v_accvgpr_write_b32 a72, v248
  v_mfma_f32_16x16x32_bf16 v[176:179], a[12:15], a[204:207], v[176:179]
  s_waitcnt lgkmcnt(8)
  v_accvgpr_write_b32 a73, v249
  v_accvgpr_write_b32 a74, v250
  v_accvgpr_write_b32 a75, v251
  v_mfma_f32_16x16x32_bf16 v[180:183], a[16:19], a[160:163], v[180:183]
  s_waitcnt lgkmcnt(6)
  v_mul_f32 v148, v26, v148
  v_mul_f32 v149, v26, v149
  v_cvt_pk_bf16_f32 v252, v148, v149
  v_mfma_f32_16x16x32_bf16 v[180:183], a[20:23], a[172:175], v[180:183]
  s_waitcnt lgkmcnt(4)
  v_mul_f32 v150, v26, v150
  v_mul_f32 v151, v26, v151
  v_cvt_pk_bf16_f32 v253, v150, v151
  v_mfma_f32_16x16x32_bf16 v[180:183], a[24:27], a[184:187], v[180:183]
  s_waitcnt lgkmcnt(2)
  v_mul_f32 v160, v26, v160
  v_mul_f32 v161, v26, v161
  v_cvt_pk_bf16_f32 v254, v160, v161
  v_mfma_f32_16x16x32_bf16 v[180:183], a[28:31], a[196:199], v[180:183]
  v_mul_f32 v162, v26, v162
  v_mul_f32 v163, v26, v163
  v_cvt_pk_bf16_f32 v255, v162, v163
  v_mfma_f32_16x16x32_bf16 v[184:187], a[16:19], a[164:167], v[184:187]
  ds_read_b64_tr_b16 a[36:37], v72 offset:38912
  v_permlane16_swap_b32 v252, v254
  v_mfma_f32_16x16x32_bf16 v[184:187], a[20:23], a[176:179], v[184:187]
  v_permlane16_swap_b32 v253, v255
  v_accvgpr_write_b32 a76, v252
  v_mfma_f32_16x16x32_bf16 v[184:187], a[24:27], a[188:191], v[184:187]
  ds_read_b64_tr_b16 a[38:39], v72 offset:45056
  v_accvgpr_write_b32 a77, v253
  v_accvgpr_write_b32 a78, v254
  v_mfma_f32_16x16x32_bf16 v[184:187], a[28:31], a[200:203], v[184:187]
  ds_read_b64_tr_b16 a[40:41], v72 offset:51200
  ds_read_b64_tr_b16 a[42:43], v72 offset:57344
  v_accvgpr_write_b32 a79, v255
  v_mfma_f32_16x16x32_bf16 v[188:191], a[16:19], a[168:171], v[188:191]
  ds_read_b64_tr_b16 a[44:45], v76 offset:51200
  ds_read_b64_tr_b16 a[46:47], v76 offset:57344
  v_mul_f32 v152, v26, v152
  v_mfma_f32_16x16x32_bf16 v[188:191], a[20:23], a[180:183], v[188:191]
  v_mul_f32 v153, v26, v153
  v_cvt_pk_bf16_f32 v240, v152, v153
  v_mul_f32 v154, v26, v154
  v_mfma_f32_16x16x32_bf16 v[188:191], a[24:27], a[192:195], v[188:191]
  v_mul_f32 v155, v26, v155
  v_cvt_pk_bf16_f32 v241, v154, v155
  v_mul_f32 v164, v26, v164
  v_mfma_f32_16x16x32_bf16 v[188:191], a[28:31], a[204:207], v[188:191]
  s_waitcnt lgkmcnt(6)
  v_mul_f32 v165, v26, v165
  v_cvt_pk_bf16_f32 v242, v164, v165
  v_mul_f32 v166, v26, v166
  v_mfma_f32_16x16x32_bf16 v[192:195], a[32:35], a[160:163], v[192:195]
  s_waitcnt lgkmcnt(4)
  s_mov_b32 s45, 0x9000
  ds_read_b64_tr_b16 a[0:1], v73 offset:26624
  v_mul_f32 v167, v26, v167
  v_cvt_pk_bf16_f32 v243, v166, v167
  v_mfma_f32_16x16x32_bf16 v[192:195], a[36:39], a[172:175], v[192:195]
  s_waitcnt lgkmcnt(3)
  ds_read_b64_tr_b16 a[2:3], v73 offset:32768
  v_permlane16_swap_b32 v240, v242
  v_mfma_f32_16x16x32_bf16 v[192:195], a[40:43], a[184:187], v[192:195]
  s_waitcnt lgkmcnt(2)
  s_add_u32 m0, s37, 0x15000
  v_permlane16_swap_b32 v241, v243
  v_accvgpr_write_b32 a80, v240
  v_mfma_f32_16x16x32_bf16 v[192:195], a[44:47], a[196:199], v[192:195]
  buffer_load_dwordx4 v14, s[16:19], s45 offen nt lds
  v_accvgpr_write_b32 a81, v241
  v_mfma_f32_16x16x32_bf16 v[196:199], a[32:35], a[164:167], v[196:199]
  v_accvgpr_write_b32 a82, v242
  v_accvgpr_write_b32 a83, v243
  v_mul_f32 v168, v26, v168
  v_mfma_f32_16x16x32_bf16 v[196:199], a[36:39], a[176:179], v[196:199]
  v_mul_f32 v169, v26, v169
  v_cvt_pk_bf16_f32 v244, v168, v169
  v_mul_f32 v170, v26, v170
  v_mfma_f32_16x16x32_bf16 v[196:199], a[40:43], a[188:191], v[196:199]
  ds_read_b64_tr_b16 a[4:5], v73 offset:38912
  ds_read_b64_tr_b16 a[6:7], v73 offset:45056
  v_mul_f32 v171, v26, v171
  v_mfma_f32_16x16x32_bf16 v[196:199], a[44:47], a[200:203], v[196:199]
  ds_read_b64_tr_b16 a[8:9], v73 offset:51200
  ds_read_b64_tr_b16 a[10:11], v73 offset:57344
  v_cvt_pk_bf16_f32 v245, v170, v171
  v_mfma_f32_16x16x32_bf16 v[200:203], a[32:35], a[168:171], v[200:203]
  ds_read_b64_tr_b16 a[12:13], v77 offset:51200
  ds_read_b64_tr_b16 a[14:15], v77 offset:57344
  v_mul_f32 v180, v26, v180
  v_mfma_f32_16x16x32_bf16 v[200:203], a[36:39], a[180:183], v[200:203]
  s_add_u32 m0, s37, 0x15380
  v_mul_f32 v181, v26, v181
  v_cvt_pk_bf16_f32 v246, v180, v181
  v_mul_f32 v182, v26, v182
  v_mfma_f32_16x16x32_bf16 v[200:203], a[40:43], a[192:195], v[200:203]
  buffer_load_dwordx4 v14, s[16:19], s45 offen offset:128 nt lds
  v_mul_f32 v183, v26, v183
  v_mfma_f32_16x16x32_bf16 v[200:203], a[44:47], a[204:207], v[200:203]
  s_waitcnt lgkmcnt(6)
  ds_read_b64_tr_b16 a[16:17], v74 offset:26624
  ds_read_b64_tr_b16 a[18:19], v74 offset:32768
  v_cvt_pk_bf16_f32 v247, v182, v183
  v_mfma_f32_16x16x32_bf16 v[204:207], a[0:3], a[160:163], v[204:207]
  s_waitcnt lgkmcnt(6)
  ds_read_b64_tr_b16 a[20:21], v74 offset:38912
  v_permlane16_swap_b32 v244, v246
  v_mfma_f32_16x16x32_bf16 v[204:207], a[4:7], a[172:175], v[204:207]
  s_waitcnt lgkmcnt(5)
  v_permlane16_swap_b32 v245, v247
  v_accvgpr_write_b32 a84, v244
  v_mfma_f32_16x16x32_bf16 v[204:207], a[8:11], a[184:187], v[204:207]
  s_waitcnt lgkmcnt(3)
  v_accvgpr_write_b32 a85, v245
  v_accvgpr_write_b32 a86, v246
  v_accvgpr_write_b32 a87, v247
  v_mfma_f32_16x16x32_bf16 v[204:207], a[12:15], a[196:199], v[204:207]
  v_mul_f32 v172, v26, v172
  v_mul_f32 v173, v26, v173
  v_cvt_pk_bf16_f32 v248, v172, v173
  v_mfma_f32_16x16x32_bf16 v[208:211], a[0:3], a[164:167], v[208:211]
  v_mul_f32 v174, v26, v174
  v_mul_f32 v175, v26, v175
  v_cvt_pk_bf16_f32 v249, v174, v175
  v_mfma_f32_16x16x32_bf16 v[208:211], a[4:7], a[176:179], v[208:211]
  v_mul_f32 v184, v26, v184
  v_mul_f32 v185, v26, v185
  v_cvt_pk_bf16_f32 v250, v184, v185
  v_mfma_f32_16x16x32_bf16 v[208:211], a[8:11], a[188:191], v[208:211]
  ds_read_b64_tr_b16 a[22:23], v74 offset:45056
  v_mul_f32 v186, v26, v186
  v_mul_f32 v187, v26, v187
  v_mfma_f32_16x16x32_bf16 v[208:211], a[12:15], a[200:203], v[208:211]
  ds_read_b64_tr_b16 a[24:25], v74 offset:51200
  ds_read_b64_tr_b16 a[26:27], v74 offset:57344
  v_cvt_pk_bf16_f32 v251, v186, v187
  v_mfma_f32_16x16x32_bf16 v[212:215], a[0:3], a[168:171], v[212:215]
  s_add_u32 m0, s37, 0x15700
  ds_read_b64_tr_b16 a[28:29], v78 offset:51200
  ds_read_b64_tr_b16 a[30:31], v78 offset:57344
  ds_read_b64_tr_b16 a[32:33], v75 offset:26624
  v_mfma_f32_16x16x32_bf16 v[212:215], a[4:7], a[180:183], v[212:215]
  buffer_load_dwordx4 v14, s[16:19], s45 offen offset:256 nt lds
  ds_read_b64_tr_b16 a[34:35], v75 offset:32768
  v_mfma_f32_16x16x32_bf16 v[212:215], a[8:11], a[192:195], v[212:215]
  ds_read_b64_tr_b16 a[36:37], v75 offset:38912
  v_permlane16_swap_b32 v248, v250
  v_mfma_f32_16x16x32_bf16 v[212:215], a[12:15], a[204:207], v[212:215]
  s_waitcnt lgkmcnt(9)
  v_permlane16_swap_b32 v249, v251
  v_accvgpr_write_b32 a88, v248
  v_mfma_f32_16x16x32_bf16 v[216:219], a[16:19], a[160:163], v[216:219]
  s_waitcnt lgkmcnt(7)
  v_accvgpr_write_b32 a89, v249
  v_accvgpr_write_b32 a90, v250
  v_accvgpr_write_b32 a91, v251
  v_mfma_f32_16x16x32_bf16 v[216:219], a[20:23], a[172:175], v[216:219]
  s_waitcnt lgkmcnt(5)
  v_mul_f32 v176, v26, v176
  v_mul_f32 v177, v26, v177
  v_cvt_pk_bf16_f32 v252, v176, v177
  v_mfma_f32_16x16x32_bf16 v[216:219], a[24:27], a[184:187], v[216:219]
  s_waitcnt lgkmcnt(3)
  v_mul_f32 v178, v26, v178
  v_mul_f32 v179, v26, v179
  v_cvt_pk_bf16_f32 v253, v178, v179
  v_mfma_f32_16x16x32_bf16 v[216:219], a[28:31], a[196:199], v[216:219]
  v_mul_f32 v188, v26, v188
  v_mul_f32 v189, v26, v189
  v_cvt_pk_bf16_f32 v254, v188, v189
  v_mfma_f32_16x16x32_bf16 v[220:223], a[16:19], a[164:167], v[220:223]
  v_mul_f32 v190, v26, v190
  v_mul_f32 v191, v26, v191
  v_cvt_pk_bf16_f32 v255, v190, v191
  v_mfma_f32_16x16x32_bf16 v[220:223], a[20:23], a[176:179], v[220:223]
  ds_read_b64_tr_b16 a[38:39], v75 offset:45056
  v_permlane16_swap_b32 v252, v254
  v_mfma_f32_16x16x32_bf16 v[220:223], a[24:27], a[188:191], v[220:223]
  v_permlane16_swap_b32 v253, v255
  v_accvgpr_write_b32 a92, v252
  v_mfma_f32_16x16x32_bf16 v[220:223], a[28:31], a[200:203], v[220:223]
  ds_read_b64_tr_b16 a[40:41], v75 offset:51200
  ds_read_b64_tr_b16 a[42:43], v75 offset:57344
  v_accvgpr_write_b32 a93, v253
  v_mfma_f32_16x16x32_bf16 v[224:227], a[16:19], a[168:171], v[224:227]
  ds_read_b64_tr_b16 a[44:45], v79 offset:51200
  ds_read_b64_tr_b16 a[46:47], v79 offset:57344
  v_accvgpr_write_b32 a94, v254
  v_mfma_f32_16x16x32_bf16 v[224:227], a[20:23], a[180:183], v[224:227]
  v_accvgpr_write_b32 a95, v255
  v_mul_f32 v192, v26, v192
  v_mul_f32 v193, v26, v193
  v_mfma_f32_16x16x32_bf16 v[224:227], a[24:27], a[192:195], v[224:227]
  s_barrier
  v_cvt_pk_bf16_f32 v240, v192, v193
  v_mul_f32 v194, v26, v194
  v_mfma_f32_16x16x32_bf16 v[224:227], a[28:31], a[204:207], v[224:227]
  s_waitcnt lgkmcnt(6)
  v_mul_f32 v195, v26, v195
  v_cvt_pk_bf16_f32 v241, v194, v195
  v_mul_f32 v204, v26, v204
  v_mfma_f32_16x16x32_bf16 v[228:231], a[32:35], a[160:163], v[228:231]
  s_waitcnt lgkmcnt(4)
  v_mul_f32 v205, v26, v205
  v_cvt_pk_bf16_f32 v242, v204, v205
  v_mul_f32 v206, v26, v206
  v_mfma_f32_16x16x32_bf16 v[228:231], a[36:39], a[172:175], v[228:231]
  s_waitcnt lgkmcnt(2)
  v_mul_f32 v207, v26, v207
  v_cvt_pk_bf16_f32 v243, v206, v207
  v_add_u32 v8, 0x18000, v8
  v_mfma_f32_16x16x32_bf16 v[228:231], a[40:43], a[184:187], v[228:231]
  s_waitcnt lgkmcnt(0)
  v_permlane16_swap_b32 v240, v242
  v_add_u32 v9, 0x18000, v9
  v_mfma_f32_16x16x32_bf16 v[228:231], a[44:47], a[196:199], v[228:231]
  v_permlane16_swap_b32 v241, v243
  v_accvgpr_write_b32 a96, v240
  v_mfma_f32_16x16x32_bf16 v[232:235], a[32:35], a[164:167], v[232:235]
  v_accvgpr_write_b32 a97, v241
  v_accvgpr_write_b32 a98, v242
  v_accvgpr_write_b32 a99, v243
  v_mfma_f32_16x16x32_bf16 v[232:235], a[36:39], a[176:179], v[232:235]
  ds_read_b128 a[0:3], v8 offset:0
  v_mul_f32 v196, v26, v196
  v_mul_f32 v197, v26, v197
  v_mfma_f32_16x16x32_bf16 v[232:235], a[40:43], a[188:191], v[232:235]
  v_cvt_pk_bf16_f32 v244, v196, v197
  v_mul_f32 v198, v26, v198
  v_mul_f32 v199, v26, v199
  v_mfma_f32_16x16x32_bf16 v[232:235], a[44:47], a[200:203], v[232:235]
  v_cvt_pk_bf16_f32 v245, v198, v199
  v_mul_f32 v208, v26, v208
  v_mul_f32 v209, v26, v209
  v_mfma_f32_16x16x32_bf16 v[236:239], a[32:35], a[168:171], v[236:239]
  ds_read_b128 a[4:7], v9 offset:0
  v_cvt_pk_bf16_f32 v246, v208, v209
  v_mul_f32 v210, v26, v210
  v_mfma_f32_16x16x32_bf16 v[236:239], a[36:39], a[180:183], v[236:239]
  ds_read_b128 a[8:11], v8 offset:1024
  v_mul_f32 v211, v26, v211
  v_cvt_pk_bf16_f32 v247, v210, v211
  v_mfma_f32_16x16x32_bf16 v[236:239], a[40:43], a[192:195], v[236:239]
  ds_read_b128 a[12:15], v9 offset:1024
  v_permlane16_swap_b32 v244, v246
  v_mfma_f32_16x16x32_bf16 v[236:239], a[44:47], a[204:207], v[236:239]
  s_waitcnt lgkmcnt(3)
  v_permlane16_swap_b32 v245, v247
  v_accvgpr_write_b32 a100, v244
  v_mfma_f32_16x16x32_bf16 v[48:51], a[0:3], a[48:51], 0
  v_accvgpr_write_b32 a101, v245
  v_accvgpr_write_b32 a102, v246
  v_accvgpr_write_b32 a103, v247
  v_mfma_f32_16x16x32_bf16 v[56:59], a[0:3], a[52:55], 0
  v_mul_f32 v200, v26, v200
  v_mul_f32 v201, v26, v201
  v_cvt_pk_bf16_f32 v248, v200, v201
  v_mfma_f32_16x16x32_bf16 v[64:67], a[0:3], a[56:59], 0
  s_waitcnt lgkmcnt(2)
  v_mul_f32 v202, v26, v202
  v_mul_f32 v203, v26, v203
  v_cvt_pk_bf16_f32 v249, v202, v203
  v_mfma_f32_16x16x32_bf16 v[48:51], a[4:7], a[60:63], v[48:51]
  v_mul_f32 v212, v26, v212
  v_mul_f32 v213, v26, v213
  v_cvt_pk_bf16_f32 v250, v212, v213
  v_mfma_f32_16x16x32_bf16 v[56:59], a[4:7], a[64:67], v[56:59]
  v_mul_f32 v214, v26, v214
  v_mul_f32 v215, v26, v215
  v_cvt_pk_bf16_f32 v251, v214, v215
  v_mfma_f32_16x16x32_bf16 v[64:67], a[4:7], a[68:71], v[64:67]
  s_waitcnt lgkmcnt(1)
  ds_read_b128 a[16:19], v8 offset:2048
  v_permlane16_swap_b32 v248, v250
  v_mfma_f32_16x16x32_bf16 v[48:51], a[8:11], a[72:75], v[48:51]
  v_permlane16_swap_b32 v249, v251
  v_accvgpr_write_b32 a104, v248
  v_mfma_f32_16x16x32_bf16 v[56:59], a[8:11], a[76:79], v[56:59]
  v_accvgpr_write_b32 a105, v249
  v_accvgpr_write_b32 a106, v250
  v_accvgpr_write_b32 a107, v251
  v_mfma_f32_16x16x32_bf16 v[64:67], a[8:11], a[80:83], v[64:67]
  s_waitcnt lgkmcnt(1)
  ds_read_b128 a[20:23], v9 offset:2048
  v_mul_f32 v216, v26, v216
  v_mul_f32 v217, v26, v217
  v_mfma_f32_16x16x32_bf16 v[48:51], a[12:15], a[84:87], v[48:51]
  v_cvt_pk_bf16_f32 v252, v216, v217
  v_mul_f32 v218, v26, v218
  v_mul_f32 v219, v26, v219
  v_cvt_pk_bf16_f32 v253, v218, v219
  v_mul_f32 v228, v26, v228
  v_mul_f32 v229, v26, v229
  v_cvt_pk_bf16_f32 v254, v228, v229
  v_mul_f32 v230, v26, v230
  v_mul_f32 v231, v26, v231
  v_cvt_pk_bf16_f32 v255, v230, v231
  v_mfma_f32_16x16x32_bf16 v[56:59], a[12:15], a[88:91], v[56:59]
  ds_read_b128 a[24:27], v8 offset:6144
  v_permlane16_swap_b32 v252, v254
  v_mfma_f32_16x16x32_bf16 v[64:67], a[12:15], a[92:95], v[64:67]
  s_waitcnt lgkmcnt(2)
  v_permlane16_swap_b32 v253, v255
  v_accvgpr_write_b32 a108, v252
  v_accvgpr_write_b32 a109, v253
  v_accvgpr_write_b32 a110, v254
  v_accvgpr_write_b32 a111, v255
  v_mul_f32 v220, v26, v220
  v_mul_f32 v221, v26, v221
  v_cvt_pk_bf16_f32 v240, v220, v221
  v_mul_f32 v222, v26, v222
  v_mul_f32 v223, v26, v223
  v_cvt_pk_bf16_f32 v241, v222, v223
  v_mul_f32 v232, v26, v232
  v_mul_f32 v233, v26, v233
  v_cvt_pk_bf16_f32 v242, v232, v233
  v_mul_f32 v234, v26, v234
  v_mul_f32 v235, v26, v235
  v_cvt_pk_bf16_f32 v243, v234, v235
  v_mfma_f32_16x16x32_bf16 v[48:51], a[16:19], a[96:99], v[48:51]
  ds_read_b128 a[28:31], v9 offset:6144
  v_permlane16_swap_b32 v240, v242
L_hop3:
  s_cbranch_execz L_hop7
  v_mfma_f32_16x16x32_bf16 v[56:59], a[16:19], a[100:103], v[56:59]
  v_permlane16_swap_b32 v241, v243
  v_accvgpr_write_b32 a112, v240
  v_accvgpr_write_b32 a113, v241
  v_accvgpr_write_b32 a114, v242
  v_accvgpr_write_b32 a115, v243
  v_mul_f32 v224, v26, v224
  v_mul_f32 v225, v26, v225
  v_cvt_pk_bf16_f32 v244, v224, v225
  v_mul_f32 v226, v26, v226
  v_mul_f32 v227, v26, v227
  v_cvt_pk_bf16_f32 v245, v226, v227
  v_mul_f32 v236, v26, v236
  v_mul_f32 v237, v26, v237
  v_cvt_pk_bf16_f32 v246, v236, v237
  v_mul_f32 v238, v26, v238
  v_mul_f32 v239, v26, v239
  v_cvt_pk_bf16_f32 v247, v238, v239
  v_mfma_f32_16x16x32_bf16 v[64:67], a[16:19], a[104:107], v[64:67]
  s_waitcnt lgkmcnt(2)
  ds_read_b128 a[32:35], v8 offset:7168
  v_permlane16_swap_b32 v244, v246
  v_mfma_f32_16x16x32_bf16 v[48:51], a[20:23], a[108:111], v[48:51]
  v_permlane16_swap_b32 v245, v247
  v_accvgpr_write_b32 a116, v244
  v_accvgpr_write_b32 a117, v245
  v_accvgpr_write_b32 a118, v246
  v_accvgpr_write_b32 a119, v247
  v_mfma_f32_16x16x32_bf16 v[56:59], a[20:23], a[112:115], v[56:59]
  ds_read_b128 a[36:39], v9 offset:7168
  v_mfma_f32_16x16x32_bf16 v[64:67], a[20:23], a[116:119], v[64:67]
  s_cmp_lg_u32 s99, 0
  s_cbranch_scc1 L_maxpass
L_maxpass_back:
  v_max3_f32 v20, v48, v49, v50
  s_waitcnt lgkmcnt(3)
  v_mfma_f32_16x16x32_bf16 v[52:55], a[24:27], a[48:51], 0
  v_max_f32 v20, v20, v51
  v_mov_b32 v21, v20
  v_max3_f32 v22, v56, v57, v58
  v_mfma_f32_16x16x32_bf16 v[60:63], a[24:27], a[52:55], 0
  v_permlane32_swap_b32 v20, v21
  v_max_f32 v20, v20, v21
  v_mfma_f32_16x16x32_bf16 v[68:71], a[24:27], a[56:59], 0
  s_waitcnt vmcnt(18)
  s_barrier
  v_mov_b32 v21, v20
  s_waitcnt lgkmcnt(2)
  v_mfma_f32_16x16x32_bf16 v[52:55], a[28:31], a[60:63], v[52:55]
  v_permlane16_swap_b32 v20, v21
  v_max3_f32 v20, v20, v21, v28
  v_mfma_f32_16x16x32_bf16 v[60:63], a[28:31], a[64:67], v[60:63]
  v_sub_f32 v32, 0, v20
  v_sub_f32 v33, 0, v20
  v_sub_f32 v34, 0, v20
  v_mfma_f32_16x16x32_bf16 v[68:71], a[28:31], a[68:71], v[68:71]
  s_waitcnt lgkmcnt(1)
  ds_read_b128 a[40:43], v8 offset:8192
  v_sub_f32 v35, 0, v20
  v_add_f32 v48, v32, v48
  v_mfma_f32_16x16x32_bf16 v[52:55], a[32:35], a[72:75], v[52:55]
  s_mov_b32 s44, 0xf000
  v_exp_f32 v48, v48
  v_max_f32 v22, v22, v59
  v_mfma_f32_16x16x32_bf16 v[60:63], a[32:35], a[76:79], v[60:63]
  s_add_u32 m0, s37, 0x6000
  v_mov_b32 v23, v22
  v_mov_b32 v28, v48
  v_add_f32 v49, v32, v49
  v_mfma_f32_16x16x32_bf16 v[68:71], a[32:35], a[80:83], v[68:71]
  s_waitcnt lgkmcnt(1)
  ds_read_b128 a[44:47], v9 offset:8192
  v_permlane32_swap_b32 v22, v23
  v_mfma_f32_16x16x32_bf16 v[52:55], a[36:39], a[84:87], v[52:55]
  buffer_load_dwordx4 v13, s[12:15], s44 offen nt lds
  v_max_f32 v22, v22, v23
  v_mfma_f32_16x16x32_bf16 v[60:63], a[36:39], a[88:91], v[60:63]
  v_add_u32 v8, 0xffff7000, v8
  v_add_u32 v9, 0xffff7000, v9
  v_mov_b32 v23, v22
  v_mfma_f32_16x16x32_bf16 v[68:71], a[36:39], a[92:95], v[68:71]
  s_waitcnt lgkmcnt(1)
  ds_read_b128 a[0:3], v8 offset:0
  v_permlane16_swap_b32 v22, v23
  v_mfma_f32_16x16x32_bf16 v[52:55], a[40:43], a[96:99], v[52:55]
  s_lshr_b32 s51, s2, 3
  ds_read_b128 a[4:7], v9 offset:0
  v_max3_f32 v22, v22, v23, v29
  v_sub_f32 v36, 0, v22
  v_mfma_f32_16x16x32_bf16 v[60:63], a[40:43], a[100:103], v[60:63]
  s_lshl_b32 s51, s51, 2
  ds_read_b128 a[8:11], v8 offset:1024
  v_sub_f32 v37, 0, v22
  v_sub_f32 v38, 0, v22
  v_mfma_f32_16x16x32_bf16 v[68:71], a[40:43], a[104:107], v[68:71]
  s_waitcnt lgkmcnt(3)
  ds_read_b128 a[12:15], v9 offset:1024
  v_sub_f32 v39, 0, v22
  v_max3_f32 v24, v64, v65, v66
  v_mfma_f32_16x16x32_bf16 v[52:55], a[44:47], a[108:111], v[52:55]
  s_add_u32 s51, s51, s36
  ds_read_b128 a[16:19], v8 offset:2048
  v_exp_f32 v49, v49
  v_mfma_f32_16x16x32_bf16 v[60:63], a[44:47], a[112:115], v[60:63]
  s_mul_i32 s51, s51, 0x1e00
  ds_read_b128 a[20:23], v9 offset:2048
  v_max_f32 v24, v24, v67
  v_mov_b32 v25, v24
  v_mfma_f32_16x16x32_bf16 v[68:71], a[44:47], a[116:119], v[68:71]
  s_waitcnt lgkmcnt(5)
  v_permlane32_swap_b32 v24, v25
  v_max_f32 v24, v24, v25
  v_mfma_f32_16x16x32_bf16 v[72:75], a[0:3], a[48:51], v[32:35]
  s_waitcnt lgkmcnt(4)
  s_mul_i32 s52, s41, 0x140
  v_mov_b32 v25, v24
  v_add_f32 v28, v28, v49
  v_add_f32 v50, v32, v50
  v_mfma_f32_16x16x32_bf16 v[72:75], a[4:7], a[60:63], v[72:75]
  s_waitcnt lgkmcnt(3)
  s_add_u32 m0, s37, 0x6380
  v_permlane16_swap_b32 v24, v25
  v_max3_f32 v24, v24, v25, v30
  v_mfma_f32_16x16x32_bf16 v[72:75], a[8:11], a[72:75], v[72:75]
  s_waitcnt lgkmcnt(2)
  v_sub_f32 v40, 0, v24
  v_sub_f32 v41, 0, v24
  v_sub_f32 v42, 0, v24
  v_mfma_f32_16x16x32_bf16 v[72:75], a[12:15], a[84:87], v[72:75]
  s_waitcnt lgkmcnt(1)
  buffer_load_dwordx4 v13, s[12:15], s44 offen offset:128 nt lds
  v_sub_f32 v43, 0, v24
  v_mfma_f32_16x16x32_bf16 v[72:75], a[16:19], a[96:99], v[72:75]
  s_waitcnt lgkmcnt(0)
  s_sub_u32 s51, s51, s52
  v_exp_f32 v50, v50
  v_cvt_pk_bf16_f32 v48, v48, v49
  v_mfma_f32_16x16x32_bf16 v[72:75], a[20:23], a[108:111], v[72:75]
  v_add_f32 v28, v28, v50
  v_add_f32 v51, v32, v51
  v_add_f32 v52, v32, v52
  v_mfma_f32_16x16x32_bf16 v[80:83], a[0:3], a[52:55], v[36:39]
  v_exp_f32 v51, v51
  v_add_f32 v53, v32, v53
  v_mfma_f32_16x16x32_bf16 v[80:83], a[4:7], a[64:67], v[80:83]
  v_add_f32 v28, v28, v51
  v_exp_f32 v52, v52
  v_mfma_f32_16x16x32_bf16 v[80:83], a[8:11], a[76:79], v[80:83]
  v_cvt_pk_bf16_f32 v49, v50, v51
  v_add_f32 v28, v28, v52
  v_add_f32 v54, v32, v54
  v_mfma_f32_16x16x32_bf16 v[80:83], a[12:15], a[88:91], v[80:83]
  v_exp_f32 v53, v53
  v_add_f32 v55, v32, v55
  v_mfma_f32_16x16x32_bf16 v[80:83], a[16:19], a[100:103], v[80:83]
  v_add_f32 v28, v28, v53
  v_exp_f32 v54, v54
  v_mfma_f32_16x16x32_bf16 v[80:83], a[20:23], a[112:115], v[80:83]
  ds_read_b128 a[24:27], v8 offset:6144
  v_cvt_pk_bf16_f32 v50, v52, v53
  v_add_f32 v28, v28, v54
  v_mfma_f32_16x16x32_bf16 v[88:91], a[0:3], a[56:59], v[40:43]
  ds_read_b128 a[28:31], v9 offset:6144
  v_exp_f32 v55, v55
  v_mfma_f32_16x16x32_bf16 v[88:91], a[4:7], a[68:71], v[88:91]
  ds_read_b128 a[32:35], v8 offset:7168
  v_add_f32 v28, v28, v55
  v_add_f32 v56, v36, v56
  v_mfma_f32_16x16x32_bf16 v[88:91], a[8:11], a[80:83], v[88:91]
  s_add_u32 m0, s37, 0x6700
  ds_read_b128 a[36:39], v9 offset:7168
  v_exp_f32 v56, v56
  v_mfma_f32_16x16x32_bf16 v[88:91], a[12:15], a[92:95], v[88:91]
  ds_read_b128 a[40:43], v8 offset:8192
  v_cvt_pk_bf16_f32 v51, v54, v55
  v_mov_b32 v29, v56
  v_mfma_f32_16x16x32_bf16 v[88:91], a[16:19], a[104:107], v[88:91]
  ds_read_b128 a[44:47], v9 offset:8192
  v_add_f32 v57, v36, v57
  v_add_f32 v58, v36, v58
  v_mfma_f32_16x16x32_bf16 v[88:91], a[20:23], a[116:119], v[88:91]
  s_waitcnt lgkmcnt(5)
  v_exp_f32 v57, v57
  v_add_f32 v59, v36, v59
  v_mfma_f32_16x16x32_bf16 v[76:79], a[24:27], a[48:51], v[32:35]
  s_waitcnt lgkmcnt(4)
  buffer_load_dwordx4 v13, s[12:15], s44 offen offset:256 nt lds
  v_add_f32 v29, v29, v57
  v_mfma_f32_16x16x32_bf16 v[76:79], a[28:31], a[60:63], v[76:79]
  s_waitcnt lgkmcnt(3)
  v_cvt_pk_bf16_f32 v56, v56, v57
  v_exp_f32 v58, v58
  v_mfma_f32_16x16x32_bf16 v[76:79], a[32:35], a[72:75], v[76:79]
  s_waitcnt lgkmcnt(2)
  v_add_f32 v29, v29, v58
  v_exp_f32 v59, v59
  v_mfma_f32_16x16x32_bf16 v[76:79], a[36:39], a[84:87], v[76:79]
  s_waitcnt lgkmcnt(1)
  v_lshlrev_b32 v1, 7, v0
  v_add_f32 v29, v29, v59
  v_add_f32 v60, v36, v60
  v_mfma_f32_16x16x32_bf16 v[76:79], a[40:43], a[96:99], v[76:79]
  s_waitcnt lgkmcnt(0)
  v_exp_f32 v60, v60
  v_cvt_pk_bf16_f32 v57, v58, v59
  v_mfma_f32_16x16x32_bf16 v[76:79], a[44:47], a[108:111], v[76:79]
  v_add_u32 v1, s51, v1
  v_max_i32 v1, 0, v1
  v_add_f32 v29, v29, v60
  v_mfma_f32_16x16x32_bf16 v[84:87], a[24:27], a[52:55], v[36:39]
  s_mov_b32 exec_lo, 0x3ff
  s_mov_b32 exec_hi, 0x0
  buffer_load_dword v17, v1, s[20:23], 0 offen
  s_mov_b64 exec, -1
  v_mfma_f32_16x16x32_bf16 v[84:87], a[28:31], a[64:67], v[84:87]
  v_add_f32 v61, v36, v61
  v_exp_f32 v61, v61
  v_mfma_f32_16x16x32_bf16 v[84:87], a[32:35], a[76:79], v[84:87]
  v_add_f32 v29, v29, v61
  v_add_f32 v62, v36, v62
  v_cvt_pk_bf16_f32 v58, v60, v61
  v_mfma_f32_16x16x32_bf16 v[84:87], a[36:39], a[88:91], v[84:87]
  v_exp_f32 v62, v62
  v_add_f32 v63, v36, v63
  v_mfma_f32_16x16x32_bf16 v[84:87], a[40:43], a[100:103], v[84:87]
  v_add_f32 v29, v29, v62
  v_exp_f32 v63, v63
  v_mfma_f32_16x16x32_bf16 v[84:87], a[44:47], a[112:115], v[84:87]
  s_mov_b32 s45, 0xc000
  ds_read_b64_tr_b16 a[0:1], v4 offset:49152
  ds_read_b64_tr_b16 a[2:3], v4 offset:55296
  v_add_f32 v29, v29, v63
  v_mfma_f32_16x16x32_bf16 v[92:95], a[24:27], a[56:59], v[40:43]
  s_add_u32 m0, s37, 0x9000
  v_add_f32 v64, v40, v64
  v_exp_f32 v64, v64
  v_mfma_f32_16x16x32_bf16 v[92:95], a[28:31], a[68:71], v[92:95]
  buffer_load_dwordx4 v14, s[16:19], s45 offen nt lds
  v_cvt_pk_bf16_f32 v59, v62, v63
  v_mfma_f32_16x16x32_bf16 v[92:95], a[32:35], a[80:83], v[92:95]
  ds_read_b64_tr_b16 a[4:5], v5 offset:49152
  ds_read_b64_tr_b16 a[6:7], v5 offset:55296
  v_mov_b32 v30, v64
  v_mfma_f32_16x16x32_bf16 v[92:95], a[36:39], a[92:95], v[92:95]
  v_add_f32 v65, v40, v65
  v_exp_f32 v65, v65
  v_add_f32 v66, v40, v66
  v_exp_f32 v66, v66
  v_add_f32 v67, v40, v67
  v_exp_f32 v67, v67
  v_add_f32 v68, v40, v68
  v_exp_f32 v68, v68
  v_add_f32 v69, v40, v69
  v_exp_f32 v69, v69
  v_add_f32 v70, v40, v70
  v_exp_f32 v70, v70
  v_add_f32 v71, v40, v71
  v_exp_f32 v71, v71
  v_mfma_f32_16x16x32_bf16 v[92:95], a[40:43], a[104:107], v[92:95]
  v_add_f32 v30, v30, v65
  v_cvt_pk_bf16_f32 v64, v64, v65
  v_add_f32 v30, v30, v66
  v_add_f32 v30, v30, v67
  v_cvt_pk_bf16_f32 v65, v66, v67
  v_add_f32 v30, v30, v68
  v_add_f32 v30, v30, v69
  v_cvt_pk_bf16_f32 v66, v68, v69
  v_add_f32 v30, v30, v70
  v_add_f32 v30, v30, v71
  v_cvt_pk_bf16_f32 v67, v70, v71
  v_mfma_f32_16x16x32_bf16 v[92:95], a[44:47], a[116:119], v[92:95]
  s_waitcnt lgkmcnt(2)
  ds_read_b64_tr_b16 a[8:9], v6 offset:49152
  ds_read_b64_tr_b16 a[10:11], v6 offset:55296
  ds_read_b64_tr_b16 a[12:13], v7 offset:49152
  v_mfma_f32_16x16x32_bf16 v[96:99], a[0:3], v[48:51], 0
  v_exp_f32 v72, v72
  v_mfma_f32_16x16x32_bf16 v[100:103], a[0:3], v[56:59], 0
  v_exp_f32 v73, v73
  v_mfma_f32_16x16x32_bf16 v[104:107], a[0:3], v[64:67], 0
  s_waitcnt lgkmcnt(3)
  ds_read_b64_tr_b16 a[14:15], v7 offset:55296
  ds_read_b64_tr_b16 a[16:17], v4 offset:50176
  v_mfma_f32_16x16x32_bf16 v[116:119], a[4:7], v[64:67], 0
  v_pk_mul_f32 v[252:253], v[72:73], 1.0 op_sel_hi:[1,0]
  v_mfma_f32_16x16x32_bf16 v[112:115], a[4:7], v[56:59], 0
  ds_read_b64_tr_b16 a[18:19], v4 offset:56320
  v_cvt_pk_bf16_f32 v72, v72, v73
  v_mfma_f32_16x16x32_bf16 v[108:111], a[4:7], v[48:51], 0
  s_waitcnt lgkmcnt(4)
  v_exp_f32 v74, v74
  v_mfma_f32_16x16x32_bf16 v[120:123], a[8:11], v[48:51], 0
  s_add_u32 m0, s37, 0x9380
  v_exp_f32 v75, v75
  v_mfma_f32_16x16x32_bf16 v[124:127], a[8:11], v[56:59], 0
  buffer_load_dwordx4 v14, s[16:19], s45 offen offset:128 nt lds
  v_mfma_f32_16x16x32_bf16 v[128:131], a[8:11], v[64:67], 0
  s_waitcnt lgkmcnt(2)
  ds_read_b64_tr_b16 a[20:21], v5 offset:50176
  ds_read_b64_tr_b16 a[22:23], v5 offset:56320
  v_mfma_f32_16x16x32_bf16 v[140:143], a[12:15], v[64:67], 0
  v_pk_add_f32 v[252:253], v[252:253], v[74:75]
  v_mfma_f32_16x16x32_bf16 v[136:139], a[12:15], v[56:59], 0
  ds_read_b64_tr_b16 a[24:25], v6 offset:50176
  v_cvt_pk_bf16_f32 v73, v74, v75
  v_mfma_f32_16x16x32_bf16 v[132:135], a[12:15], v[48:51], 0
  s_waitcnt lgkmcnt(3)
  ds_read_b64_tr_b16 a[26:27], v6 offset:56320
  ds_read_b64_tr_b16 a[28:29], v7 offset:50176
  v_mfma_f32_16x16x32_bf16 v[144:147], a[16:19], v[48:51], 0
  v_exp_f32 v76, v76
  v_mfma_f32_16x16x32_bf16 v[148:151], a[16:19], v[56:59], 0
  v_exp_f32 v77, v77
  v_mfma_f32_16x16x32_bf16 v[152:155], a[16:19], v[64:67], 0
  s_waitcnt lgkmcnt(3)
  ds_read_b64_tr_b16 a[30:31], v7 offset:56320
  ds_read_b64_tr_b16 a[32:33], v4 offset:51200
  v_mfma_f32_16x16x32_bf16 v[164:167], a[20:23], v[64:67], 0
  v_pk_add_f32 v[252:253], v[252:253], v[76:77]
  v_mfma_f32_16x16x32_bf16 v[160:163], a[20:23], v[56:59], 0
  ds_read_b64_tr_b16 a[34:35], v4 offset:57344
  v_cvt_pk_bf16_f32 v74, v76, v77
  v_mfma_f32_16x16x32_bf16 v[156:159], a[20:23], v[48:51], 0
  s_waitcnt lgkmcnt(4)
  v_exp_f32 v78, v78
  v_mfma_f32_16x16x32_bf16 v[168:171], a[24:27], v[48:51], 0
  v_exp_f32 v79, v79
  v_mfma_f32_16x16x32_bf16 v[172:175], a[24:27], v[56:59], 0
  s_add_u32 m0, s37, 0x9700
  v_pk_add_f32 v[252:253], v[252:253], v[78:79]
  v_mfma_f32_16x16x32_bf16 v[176:179], a[24:27], v[64:67], 0
  s_waitcnt lgkmcnt(2)
  ds_read_b64_tr_b16 a[36:37], v5 offset:51200
  ds_read_b64_tr_b16 a[38:39], v5 offset:57344
  v_mfma_f32_16x16x32_bf16 v[188:191], a[28:31], v[64:67], 0
  buffer_load_dwordx4 v14, s[16:19], s45 offen offset:256 nt lds
  v_mfma_f32_16x16x32_bf16 v[184:187], a[28:31], v[56:59], 0
  s_waitcnt vmcnt(19)
  s_barrier
  v_cvt_pk_bf16_f32 v75, v78, v79
  v_mfma_f32_16x16x32_bf16 v[180:183], a[28:31], v[48:51], 0
  s_waitcnt lgkmcnt(2)
  ds_read_b64_tr_b16 a[40:41], v6 offset:51200
  ds_read_b64_tr_b16 a[42:43], v6 offset:57344
  v_mfma_f32_16x16x32_bf16 v[192:195], a[32:35], v[48:51], 0
  v_exp_f32 v80, v80
  v_mfma_f32_16x16x32_bf16 v[196:199], a[32:35], v[56:59], 0
  v_exp_f32 v81, v81
  v_mfma_f32_16x16x32_bf16 v[200:203], a[32:35], v[64:67], 0
  s_waitcnt lgkmcnt(2)
  ds_read_b64_tr_b16 a[44:45], v7 offset:51200
  ds_read_b64_tr_b16 a[46:47], v7 offset:57344
  v_mfma_f32_16x16x32_bf16 v[212:215], a[36:39], v[64:67], 0
  v_pk_mul_f32 v[254:255], v[80:81], 1.0 op_sel_hi:[1,0]
  v_mfma_f32_16x16x32_bf16 v[208:211], a[36:39], v[56:59], 0
  v_add_u32 v8, 0xffff1000, v8
  v_add_u32 v9, 0xffff1000, v9
  v_mfma_f32_16x16x32_bf16 v[204:207], a[36:39], v[48:51], 0
  s_waitcnt lgkmcnt(2)
  ds_read_b128 a[0:3], v8 offset:0
  v_cvt_pk_bf16_f32 v80, v80, v81
  v_mfma_f32_16x16x32_bf16 v[216:219], a[40:43], v[48:51], 0
  s_nop 0
  ds_read_b128 a[4:7], v9 offset:0
  ds_read_b128 a[8:11], v8 offset:1024
  v_mfma_f32_16x16x32_bf16 v[220:223], a[40:43], v[56:59], 0
  v_exp_f32 v82, v82
  v_mfma_f32_16x16x32_bf16 v[224:227], a[40:43], v[64:67], 0
  s_waitcnt lgkmcnt(3)
  ds_read_b128 a[12:15], v9 offset:1024
  ds_read_b128 a[16:19], v8 offset:2048
  v_mfma_f32_16x16x32_bf16 v[236:239], a[44:47], v[64:67], 0
  v_exp_f32 v83, v83
  v_mfma_f32_16x16x32_bf16 v[232:235], a[44:47], v[56:59], 0
  s_nop 0
  ds_read_b128 a[20:23], v9 offset:2048
  ds_read_b128 a[24:27], v8 offset:6144
  v_mfma_f32_16x16x32_bf16 v[228:231], a[44:47], v[48:51], 0
  s_waitcnt lgkmcnt(6)
  v_pk_add_f32 v[254:255], v[254:255], v[82:83]
  v_mfma_f32_16x16x32_bf16 v[48:51], a[0:3], a[48:51], v[32:35]
  s_waitcnt lgkmcnt(5)
  s_mov_b32 s44, 0x12000
  s_add_u32 m0, s37, 0xc000
  v_cvt_pk_bf16_f32 v81, v82, v83
  v_mfma_f32_16x16x32_bf16 v[48:51], a[4:7], a[60:63], v[48:51]
  s_waitcnt lgkmcnt(4)
  buffer_load_dwordx4 v13, s[12:15], s44 offen nt lds
  v_mfma_f32_16x16x32_bf16 v[48:51], a[8:11], a[72:75], v[48:51]
  s_waitcnt lgkmcnt(3)
  v_exp_f32 v84, v84
  v_mfma_f32_16x16x32_bf16 v[48:51], a[12:15], a[84:87], v[48:51]
  s_waitcnt lgkmcnt(2)
  v_exp_f32 v85, v85
  v_mfma_f32_16x16x32_bf16 v[48:51], a[16:19], a[96:99], v[48:51]
  s_waitcnt lgkmcnt(1)
  v_pk_add_f32 v[254:255], v[254:255], v[84:85]
  v_mfma_f32_16x16x32_bf16 v[48:51], a[20:23], a[108:111], v[48:51]
  ds_read_b128 a[28:31], v9 offset:6144
  v_cvt_pk_bf16_f32 v82, v84, v85
  v_mfma_f32_16x16x32_bf16 v[56:59], a[0:3], a[52:55], v[36:39]
  v_exp_f32 v86, v86
  v_mfma_f32_16x16x32_bf16 v[56:59], a[4:7], a[64:67], v[56:59]
  v_exp_f32 v87, v87
  v_mfma_f32_16x16x32_bf16 v[56:59], a[8:11], a[76:79], v[56:59]
  v_pk_add_f32 v[254:255], v[254:255], v[86:87]
  v_mfma_f32_16x16x32_bf16 v[56:59], a[12:15], a[88:91], v[56:59]
  ds_read_b128 a[32:35], v8 offset:7168
  v_cvt_pk_bf16_f32 v83, v86, v87
  v_mfma_f32_16x16x32_bf16 v[56:59], a[16:19], a[100:103], v[56:59]
  v_exp_f32 v88, v88
  v_mfma_f32_16x16x32_bf16 v[56:59], a[20:23], a[112:115], v[56:59]
  v_exp_f32 v89, v89
  v_mfma_f32_16x16x32_bf16 v[64:67], a[0:3], a[56:59], v[40:43]
  s_add_u32 m0, s37, 0xc380
  v_pk_mul_f32 v[2:3], v[88:89], 1.0 op_sel_hi:[1,0]
  v_mfma_f32_16x16x32_bf16 v[64:67], a[4:7], a[68:71], v[64:67]
  buffer_load_dwordx4 v13, s[12:15], s44 offen offset:128 nt lds
  v_mfma_f32_16x16x32_bf16 v[64:67], a[8:11], a[80:83], v[64:67]
  ds_read_b128 a[36:39], v9 offset:7168
  v_cvt_pk_bf16_f32 v88, v88, v89
  v_mfma_f32_16x16x32_bf16 v[64:67], a[12:15], a[92:95], v[64:67]
  s_nop 0
  ds_read_b128 a[40:43], v8 offset:8192
  ds_read_b128 a[44:47], v9 offset:8192
  v_mfma_f32_16x16x32_bf16 v[64:67], a[16:19], a[104:107], v[64:67]
  v_exp_f32 v90, v90
  v_mfma_f32_16x16x32_bf16 v[64:67], a[20:23], a[116:119], v[64:67]
  s_waitcnt lgkmcnt(5)
  v_exp_f32 v91, v91
  v_mfma_f32_16x16x32_bf16 v[52:55], a[24:27], a[48:51], v[32:35]
  s_waitcnt lgkmcnt(4)
  v_pk_add_f32 v[2:3], v[2:3], v[90:91]
  v_mfma_f32_16x16x32_bf16 v[52:55], a[28:31], a[60:63], v[52:55]
  s_waitcnt lgkmcnt(3)
  v_cvt_pk_bf16_f32 v89, v90, v91
  v_mfma_f32_16x16x32_bf16 v[52:55], a[32:35], a[72:75], v[52:55]
  s_waitcnt lgkmcnt(2)
  v_exp_f32 v92, v92
  v_mfma_f32_16x16x32_bf16 v[52:55], a[36:39], a[84:87], v[52:55]
  s_waitcnt lgkmcnt(1)
  v_exp_f32 v93, v93
  v_mfma_f32_16x16x32_bf16 v[52:55], a[40:43], a[96:99], v[52:55]
  s_waitcnt lgkmcnt(0)
  s_mov_b32 exec_lo, 0xffc00
  s_mov_b32 exec_hi, 0x0
  buffer_load_dword v18, v1, s[20:23], 0 offen
  s_mov_b64 exec, -1
  v_mfma_f32_16x16x32_bf16 v[52:55], a[44:47], a[108:111], v[52:55]
  v_pk_add_f32 v[2:3], v[2:3], v[92:93]
  v_mfma_f32_16x16x32_bf16 v[60:63], a[24:27], a[52:55], v[36:39]
  v_cvt_pk_bf16_f32 v90, v92, v93
  v_add_u32 v4, 0xffff1000, v4
  v_mfma_f32_16x16x32_bf16 v[60:63], a[28:31], a[64:67], v[60:63]
  s_add_u32 m0, s37, 0xc700
  v_exp_f32 v94, v94
  v_mfma_f32_16x16x32_bf16 v[60:63], a[32:35], a[76:79], v[60:63]
  buffer_load_dwordx4 v13, s[12:15], s44 offen offset:256 nt lds
  v_mfma_f32_16x16x32_bf16 v[60:63], a[36:39], a[88:91], v[60:63]
  v_add_u32 v5, 0xffff1000, v5
  v_add_u32 v6, 0xffff1000, v6
  v_mfma_f32_16x16x32_bf16 v[60:63], a[40:43], a[100:103], v[60:63]
  v_add_u32 v7, 0xffff1000, v7
  v_mfma_f32_16x16x32_bf16 v[60:63], a[44:47], a[112:115], v[60:63]
  s_nop 0
  ds_read_b64_tr_b16 a[0:1], v4 offset:0
  ds_read_b64_tr_b16 a[2:3], v4 offset:6144
  v_mfma_f32_16x16x32_bf16 v[68:71], a[24:27], a[56:59], v[40:43]
  s_nop 0
  ds_read_b64_tr_b16 a[4:5], v5 offset:0
  ds_read_b64_tr_b16 a[6:7], v5 offset:6144
  v_mfma_f32_16x16x32_bf16 v[68:71], a[28:31], a[68:71], v[68:71]
  v_exp_f32 v95, v95
  v_mfma_f32_16x16x32_bf16 v[68:71], a[32:35], a[80:83], v[68:71]
  v_exp_f32 v48, v48
  v_mfma_f32_16x16x32_bf16 v[68:71], a[36:39], a[92:95], v[68:71]
  v_exp_f32 v49, v49
  v_mfma_f32_16x16x32_bf16 v[68:71], a[40:43], a[104:107], v[68:71]
  v_pk_add_f32 v[2:3], v[2:3], v[94:95]
  v_cvt_pk_bf16_f32 v91, v94, v95
  v_mfma_f32_16x16x32_bf16 v[68:71], a[44:47], a[116:119], v[68:71]
  s_waitcnt lgkmcnt(2)
  ds_read_b64_tr_b16 a[8:9], v6 offset:0
  ds_read_b64_tr_b16 a[10:11], v6 offset:6144
  v_mfma_f32_16x16x32_bf16 v[96:99], a[0:3], v[72:75], v[96:99]
  v_pk_add_f32 v[252:253], v[252:253], v[48:49]
  v_mfma_f32_16x16x32_bf16 v[100:103], a[0:3], v[80:83], v[100:103]
  ds_read_b64_tr_b16 a[12:13], v7 offset:0
  v_cvt_pk_bf16_f32 v48, v48, v49
  v_mfma_f32_16x16x32_bf16 v[104:107], a[0:3], v[88:91], v[104:107]
  s_waitcnt lgkmcnt(3)
  ds_read_b64_tr_b16 a[14:15], v7 offset:6144
  ds_read_b64_tr_b16 a[16:17], v4 offset:1024
  v_mfma_f32_16x16x32_bf16 v[116:119], a[4:7], v[88:91], v[116:119]
  v_exp_f32 v50, v50
  v_mfma_f32_16x16x32_bf16 v[112:115], a[4:7], v[80:83], v[112:115]
  v_exp_f32 v51, v51
  v_mfma_f32_16x16x32_bf16 v[108:111], a[4:7], v[72:75], v[108:111]
  s_waitcnt lgkmcnt(3)
  s_mov_b32 s45, 0xf000
  ds_read_b64_tr_b16 a[18:19], v4 offset:7168
  v_mfma_f32_16x16x32_bf16 v[120:123], a[8:11], v[72:75], v[120:123]
  s_add_u32 m0, s37, 0x1b000
  v_pk_add_f32 v[252:253], v[252:253], v[50:51]
  v_mfma_f32_16x16x32_bf16 v[124:127], a[8:11], v[80:83], v[124:127]
  buffer_load_dwordx4 v14, s[16:19], s45 offen nt lds
  v_mfma_f32_16x16x32_bf16 v[128:131], a[8:11], v[88:91], v[128:131]
  s_waitcnt lgkmcnt(2)
  ds_read_b64_tr_b16 a[20:21], v5 offset:1024
  ds_read_b64_tr_b16 a[22:23], v5 offset:7168
  v_mfma_f32_16x16x32_bf16 v[140:143], a[12:15], v[88:91], v[140:143]
  ds_read_b64_tr_b16 a[24:25], v6 offset:1024
  v_cvt_pk_bf16_f32 v49, v50, v51
  v_mfma_f32_16x16x32_bf16 v[136:139], a[12:15], v[80:83], v[136:139]
  v_exp_f32 v52, v52
  v_mfma_f32_16x16x32_bf16 v[132:135], a[12:15], v[72:75], v[132:135]
  s_waitcnt lgkmcnt(3)
  ds_read_b64_tr_b16 a[26:27], v6 offset:7168
  ds_read_b64_tr_b16 a[28:29], v7 offset:1024
  v_mfma_f32_16x16x32_bf16 v[144:147], a[16:19], v[72:75], v[144:147]
  v_exp_f32 v53, v53
  v_mfma_f32_16x16x32_bf16 v[148:151], a[16:19], v[80:83], v[148:151]
  v_pk_add_f32 v[252:253], v[252:253], v[52:53]
  v_mfma_f32_16x16x32_bf16 v[152:155], a[16:19], v[88:91], v[152:155]
  s_waitcnt lgkmcnt(3)
  ds_read_b64_tr_b16 a[30:31], v7 offset:7168
  v_cvt_pk_bf16_f32 v50, v52, v53
  v_mfma_f32_16x16x32_bf16 v[164:167], a[20:23], v[88:91], v[164:167]
  v_exp_f32 v54, v54
  v_mfma_f32_16x16x32_bf16 v[160:163], a[20:23], v[80:83], v[160:163]
  v_exp_f32 v55, v55
  v_mfma_f32_16x16x32_bf16 v[156:159], a[20:23], v[72:75], v[156:159]
  s_waitcnt lgkmcnt(2)
  ds_read_b64_tr_b16 a[32:33], v4 offset:2048
  ds_read_b64_tr_b16 a[34:35], v4 offset:8192
  v_mfma_f32_16x16x32_bf16 v[168:171], a[24:27], v[72:75], v[168:171]
  s_add_u32 m0, s37, 0x1b380
  v_pk_add_f32 v[252:253], v[252:253], v[54:55]
  v_mfma_f32_16x16x32_bf16 v[172:175], a[24:27], v[80:83], v[172:175]
  buffer_load_dwordx4 v14, s[16:19], s45 offen offset:128 nt lds
  v_mfma_f32_16x16x32_bf16 v[176:179], a[24:27], v[88:91], v[176:179]
  s_waitcnt lgkmcnt(2)
  ds_read_b64_tr_b16 a[36:37], v5 offset:2048
  ds_read_b64_tr_b16 a[38:39], v5 offset:8192
  v_mfma_f32_16x16x32_bf16 v[188:191], a[28:31], v[88:91], v[188:191]
  ds_read_b64_tr_b16 a[40:41], v6 offset:2048
  v_cvt_pk_bf16_f32 v51, v54, v55
  v_mfma_f32_16x16x32_bf16 v[184:187], a[28:31], v[80:83], v[184:187]
  s_waitcnt vmcnt(19)
  s_barrier
  ds_read_b64_tr_b16 a[42:43], v6 offset:8192
  v_mfma_f32_16x16x32_bf16 v[180:183], a[28:31], v[72:75], v[180:183]
  s_waitcnt lgkmcnt(4)
  v_exp_f32 v56, v56
  v_mfma_f32_16x16x32_bf16 v[192:195], a[32:35], v[72:75], v[192:195]
  v_exp_f32 v57, v57
  v_mfma_f32_16x16x32_bf16 v[196:199], a[32:35], v[80:83], v[196:199]
  v_pk_add_f32 v[254:255], v[254:255], v[56:57]
  v_mfma_f32_16x16x32_bf16 v[200:203], a[32:35], v[88:91], v[200:203]
  s_waitcnt lgkmcnt(2)
  ds_read_b64_tr_b16 a[44:45], v7 offset:2048
  ds_read_b64_tr_b16 a[46:47], v7 offset:8192
  v_mfma_f32_16x16x32_bf16 v[212:215], a[36:39], v[88:91], v[212:215]
  v_cvt_pk_bf16_f32 v56, v56, v57
  v_add_u32 v8, 0x21000, v8
  v_mfma_f32_16x16x32_bf16 v[208:211], a[36:39], v[80:83], v[208:211]
  v_add_u32 v9, 0x21000, v9
  v_mfma_f32_16x16x32_bf16 v[204:207], a[36:39], v[72:75], v[204:207]
  s_waitcnt lgkmcnt(2)
  ds_read_b128 a[0:3], v8 offset:0
  ds_read_b128 a[4:7], v9 offset:0
  v_mfma_f32_16x16x32_bf16 v[216:219], a[40:43], v[72:75], v[216:219]
  v_exp_f32 v58, v58
  v_mfma_f32_16x16x32_bf16 v[220:223], a[40:43], v[80:83], v[220:223]
  s_add_u32 m0, s37, 0x1b700
  ds_read_b128 a[8:11], v8 offset:1024
  ds_read_b128 a[12:15], v9 offset:1024
  v_mfma_f32_16x16x32_bf16 v[224:227], a[40:43], v[88:91], v[224:227]
  s_waitcnt lgkmcnt(4)
  v_exp_f32 v59, v59
  v_mfma_f32_16x16x32_bf16 v[236:239], a[44:47], v[88:91], v[236:239]
  s_nop 0
  ds_read_b128 a[16:19], v8 offset:2048
  ds_read_b128 a[20:23], v9 offset:2048
  v_mfma_f32_16x16x32_bf16 v[232:235], a[44:47], v[80:83], v[232:235]
  buffer_load_dwordx4 v14, s[16:19], s45 offen offset:256 nt lds
  v_mfma_f32_16x16x32_bf16 v[228:231], a[44:47], v[72:75], v[228:231]
  s_waitcnt lgkmcnt(5)
  v_pk_add_f32 v[254:255], v[254:255], v[58:59]
  v_mfma_f32_16x16x32_bf16 v[72:75], a[0:3], a[48:51], v[32:35]
  s_waitcnt lgkmcnt(4)
  ds_read_b128 a[24:27], v8 offset:6144
  v_cvt_pk_bf16_f32 v57, v58, v59
  v_mfma_f32_16x16x32_bf16 v[72:75], a[4:7], a[60:63], v[72:75]
  s_waitcnt lgkmcnt(4)
  v_exp_f32 v60, v60
  v_mfma_f32_16x16x32_bf16 v[72:75], a[8:11], a[72:75], v[72:75]
  s_waitcnt lgkmcnt(3)
  v_exp_f32 v61, v61
  v_mfma_f32_16x16x32_bf16 v[72:75], a[12:15], a[84:87], v[72:75]
  s_waitcnt lgkmcnt(2)
  v_pk_add_f32 v[254:255], v[254:255], v[60:61]
  v_mfma_f32_16x16x32_bf16 v[72:75], a[16:19], a[96:99], v[72:75]
  s_waitcnt lgkmcnt(1)
  ds_read_b128 a[28:31], v9 offset:6144
  v_cvt_pk_bf16_f32 v58, v60, v61
  v_mfma_f32_16x16x32_bf16 v[72:75], a[20:23], a[108:111], v[72:75]
  v_exp_f32 v62, v62
  v_mfma_f32_16x16x32_bf16 v[80:83], a[0:3], a[52:55], v[36:39]
  v_exp_f32 v63, v63
  v_mfma_f32_16x16x32_bf16 v[80:83], a[4:7], a[64:67], v[80:83]
  v_pk_add_f32 v[254:255], v[254:255], v[62:63]
  v_mfma_f32_16x16x32_bf16 v[80:83], a[8:11], a[76:79], v[80:83]
  ds_read_b128 a[32:35], v8 offset:7168
  v_cvt_pk_bf16_f32 v59, v62, v63
  v_mfma_f32_16x16x32_bf16 v[80:83], a[12:15], a[88:91], v[80:83]
  v_exp_f32 v64, v64
  v_mfma_f32_16x16x32_bf16 v[80:83], a[16:19], a[100:103], v[80:83]
  s_mov_b32 s44, 0x15000
  v_exp_f32 v65, v65
  v_mfma_f32_16x16x32_bf16 v[80:83], a[20:23], a[112:115], v[80:83]
  s_add_u32 m0, s37, 0xf000
  v_pk_add_f32 v[2:3], v[2:3], v[64:65]
  v_mfma_f32_16x16x32_bf16 v[88:91], a[0:3], a[56:59], v[40:43]
  buffer_load_dwordx4 v13, s[12:15], s44 offen nt lds
  v_mfma_f32_16x16x32_bf16 v[88:91], a[4:7], a[68:71], v[88:91]
  ds_read_b128 a[36:39], v9 offset:7168
  v_cvt_pk_bf16_f32 v64, v64, v65
  v_mfma_f32_16x16x32_bf16 v[88:91], a[8:11], a[80:83], v[88:91]
  v_exp_f32 v66, v66
  v_mfma_f32_16x16x32_bf16 v[88:91], a[12:15], a[92:95], v[88:91]
  s_nop 0
  ds_read_b128 a[40:43], v8 offset:8192
  ds_read_b128 a[44:47], v9 offset:8192
L_hop4:
  s_cbranch_execz L_hop8
  v_mfma_f32_16x16x32_bf16 v[88:91], a[16:19], a[104:107], v[88:91]
  v_exp_f32 v67, v67
  v_mfma_f32_16x16x32_bf16 v[88:91], a[20:23], a[116:119], v[88:91]
  s_waitcnt lgkmcnt(5)
  v_pk_add_f32 v[2:3], v[2:3], v[66:67]
  v_mfma_f32_16x16x32_bf16 v[76:79], a[24:27], a[48:51], v[32:35]
  s_waitcnt lgkmcnt(4)
  v_cvt_pk_bf16_f32 v65, v66, v67
  v_mfma_f32_16x16x32_bf16 v[76:79], a[28:31], a[60:63], v[76:79]
  s_waitcnt lgkmcnt(3)
  v_exp_f32 v68, v68
  v_mfma_f32_16x16x32_bf16 v[76:79], a[32:35], a[72:75], v[76:79]
  s_waitcnt lgkmcnt(2)
  s_mov_b32 exec_lo, 0x3ff00000
  s_mov_b32 exec_hi, 0x0
  s_waitcnt vmcnt(11)
  buffer_load_dword v17, v1, s[20:23], 0 offen
  s_mov_b64 exec, -1
  v_mfma_f32_16x16x32_bf16 v[76:79], a[36:39], a[84:87], v[76:79]
  s_waitcnt lgkmcnt(1)
  v_exp_f32 v69, v69
  v_mfma_f32_16x16x32_bf16 v[76:79], a[40:43], a[96:99], v[76:79]
  s_waitcnt lgkmcnt(0)
  v_pk_add_f32 v[2:3], v[2:3], v[68:69]
  v_mfma_f32_16x16x32_bf16 v[76:79], a[44:47], a[108:111], v[76:79]
  s_add_u32 m0, s37, 0xf380
  v_cvt_pk_bf16_f32 v66, v68, v69
  v_add_u32 v4, 0x21000, v4
  v_mfma_f32_16x16x32_bf16 v[84:87], a[24:27], a[52:55], v[36:39]
  buffer_load_dwordx4 v13, s[12:15], s44 offen offset:128 nt lds
  v_mfma_f32_16x16x32_bf16 v[84:87], a[28:31], a[64:67], v[84:87]
  v_exp_f32 v70, v70
  v_mfma_f32_16x16x32_bf16 v[84:87], a[32:35], a[76:79], v[84:87]
  v_add_u32 v5, 0x21000, v5
  v_add_u32 v6, 0x21000, v6
  v_mfma_f32_16x16x32_bf16 v[84:87], a[36:39], a[88:91], v[84:87]
  v_add_u32 v7, 0x21000, v7
  v_mfma_f32_16x16x32_bf16 v[84:87], a[40:43], a[100:103], v[84:87]
  s_nop 0
  ds_read_b64_tr_b16 a[0:1], v4 offset:0
  ds_read_b64_tr_b16 a[2:3], v4 offset:6144
  v_mfma_f32_16x16x32_bf16 v[84:87], a[44:47], a[112:115], v[84:87]
  s_nop 0
  ds_read_b64_tr_b16 a[4:5], v5 offset:0
  ds_read_b64_tr_b16 a[6:7], v5 offset:6144
  v_mfma_f32_16x16x32_bf16 v[92:95], a[24:27], a[56:59], v[40:43]
  v_exp_f32 v71, v71
  v_mfma_f32_16x16x32_bf16 v[92:95], a[28:31], a[68:71], v[92:95]
  v_exp_f32 v72, v72
  v_mfma_f32_16x16x32_bf16 v[92:95], a[32:35], a[80:83], v[92:95]
  v_exp_f32 v73, v73
  v_mfma_f32_16x16x32_bf16 v[92:95], a[36:39], a[92:95], v[92:95]
  v_exp_f32 v74, v74
  v_mfma_f32_16x16x32_bf16 v[92:95], a[40:43], a[104:107], v[92:95]
  v_pk_add_f32 v[2:3], v[2:3], v[70:71]
  v_cvt_pk_bf16_f32 v67, v70, v71
  v_mfma_f32_16x16x32_bf16 v[92:95], a[44:47], a[116:119], v[92:95]
  s_waitcnt lgkmcnt(2)
  ds_read_b64_tr_b16 a[8:9], v6 offset:0
  ds_read_b64_tr_b16 a[10:11], v6 offset:6144
  v_mfma_f32_16x16x32_bf16 v[96:99], a[0:3], v[48:51], v[96:99]
  s_add_u32 m0, s37, 0xf700
  v_pk_add_f32 v[252:253], v[252:253], v[72:73]
  v_mfma_f32_16x16x32_bf16 v[100:103], a[0:3], v[56:59], v[100:103]
  buffer_load_dwordx4 v13, s[12:15], s44 offen offset:256 nt lds
  v_mfma_f32_16x16x32_bf16 v[104:107], a[0:3], v[64:67], v[104:107]
  s_waitcnt lgkmcnt(2)
  ds_read_b64_tr_b16 a[12:13], v7 offset:0
  ds_read_b64_tr_b16 a[14:15], v7 offset:6144
  v_mfma_f32_16x16x32_bf16 v[116:119], a[4:7], v[64:67], v[116:119]
  ds_read_b64_tr_b16 a[16:17], v4 offset:1024
  v_cvt_pk_bf16_f32 v72, v72, v73
  v_mfma_f32_16x16x32_bf16 v[112:115], a[4:7], v[56:59], v[112:115]
  v_exp_f32 v75, v75
  v_mfma_f32_16x16x32_bf16 v[108:111], a[4:7], v[48:51], v[108:111]
  s_waitcnt lgkmcnt(3)
  ds_read_b64_tr_b16 a[18:19], v4 offset:7168
  ds_read_b64_tr_b16 a[20:21], v5 offset:1024
  v_mfma_f32_16x16x32_bf16 v[120:123], a[8:11], v[48:51], v[120:123]
  v_pk_add_f32 v[252:253], v[252:253], v[74:75]
  v_mfma_f32_16x16x32_bf16 v[124:127], a[8:11], v[56:59], v[124:127]
  ds_read_b64_tr_b16 a[22:23], v5 offset:7168
  v_cvt_pk_bf16_f32 v73, v74, v75
  v_mfma_f32_16x16x32_bf16 v[128:131], a[8:11], v[64:67], v[128:131]
  s_waitcnt lgkmcnt(4)
  v_exp_f32 v76, v76
  v_mfma_f32_16x16x32_bf16 v[140:143], a[12:15], v[64:67], v[140:143]
  v_exp_f32 v77, v77
  v_mfma_f32_16x16x32_bf16 v[136:139], a[12:15], v[56:59], v[136:139]
  v_pk_add_f32 v[252:253], v[252:253], v[76:77]
  v_mfma_f32_16x16x32_bf16 v[132:135], a[12:15], v[48:51], v[132:135]
  s_waitcnt lgkmcnt(2)
  ds_read_b64_tr_b16 a[24:25], v6 offset:1024
  ds_read_b64_tr_b16 a[26:27], v6 offset:7168
  v_mfma_f32_16x16x32_bf16 v[144:147], a[16:19], v[48:51], v[144:147]
  ds_read_b64_tr_b16 a[28:29], v7 offset:1024
  v_cvt_pk_bf16_f32 v74, v76, v77
  v_mfma_f32_16x16x32_bf16 v[148:151], a[16:19], v[56:59], v[148:151]
  v_exp_f32 v78, v78
  v_mfma_f32_16x16x32_bf16 v[152:155], a[16:19], v[64:67], v[152:155]
  s_waitcnt lgkmcnt(3)
  ds_read_b64_tr_b16 a[30:31], v7 offset:7168
  ds_read_b64_tr_b16 a[32:33], v4 offset:2048
  v_mfma_f32_16x16x32_bf16 v[164:167], a[20:23], v[64:67], v[164:167]
  v_exp_f32 v79, v79
  v_mfma_f32_16x16x32_bf16 v[160:163], a[20:23], v[56:59], v[160:163]
  s_mov_b32 s45, 0x12000
  v_pk_add_f32 v[252:253], v[252:253], v[78:79]
  v_mfma_f32_16x16x32_bf16 v[156:159], a[20:23], v[48:51], v[156:159]
  s_waitcnt lgkmcnt(3)
  ds_read_b64_tr_b16 a[34:35], v4 offset:8192
  v_cvt_pk_bf16_f32 v75, v78, v79
  v_mfma_f32_16x16x32_bf16 v[168:171], a[24:27], v[48:51], v[168:171]
  s_add_u32 m0, s37, 0x18000
  v_exp_f32 v80, v80
  v_mfma_f32_16x16x32_bf16 v[172:175], a[24:27], v[56:59], v[172:175]
  buffer_load_dwordx4 v14, s[16:19], s45 offen nt lds
  v_mfma_f32_16x16x32_bf16 v[176:179], a[24:27], v[64:67], v[176:179]
  s_waitcnt lgkmcnt(2)
  ds_read_b64_tr_b16 a[36:37], v5 offset:2048
  ds_read_b64_tr_b16 a[38:39], v5 offset:8192
  v_mfma_f32_16x16x32_bf16 v[188:191], a[28:31], v[64:67], v[188:191]
  v_exp_f32 v81, v81
  v_mfma_f32_16x16x32_bf16 v[184:187], a[28:31], v[56:59], v[184:187]
  s_barrier
  ds_read_b64_tr_b16 a[40:41], v6 offset:2048
  v_mfma_f32_16x16x32_bf16 v[180:183], a[28:31], v[48:51], v[180:183]
  s_waitcnt lgkmcnt(3)
  ds_read_b64_tr_b16 a[42:43], v6 offset:8192
  ds_read_b64_tr_b16 a[44:45], v7 offset:2048
  v_mfma_f32_16x16x32_bf16 v[192:195], a[32:35], v[48:51], v[192:195]
  v_pk_add_f32 v[254:255], v[254:255], v[80:81]
  v_mfma_f32_16x16x32_bf16 v[196:199], a[32:35], v[56:59], v[196:199]
  ds_read_b64_tr_b16 a[46:47], v7 offset:8192
  v_cvt_pk_bf16_f32 v80, v80, v81
  v_mfma_f32_16x16x32_bf16 v[200:203], a[32:35], v[64:67], v[200:203]
  s_waitcnt lgkmcnt(4)
  v_exp_f32 v82, v82
  v_mfma_f32_16x16x32_bf16 v[212:215], a[36:39], v[64:67], v[212:215]
  v_exp_f32 v83, v83
  v_mfma_f32_16x16x32_bf16 v[208:211], a[36:39], v[56:59], v[208:211]
  v_add_u32 v8, 0xffff1000, v8
  v_add_u32 v9, 0xffff1000, v9
  v_mfma_f32_16x16x32_bf16 v[204:207], a[36:39], v[48:51], v[204:207]
  s_waitcnt lgkmcnt(2)
  ds_read_b128 a[0:3], v8 offset:0
  ds_read_b128 a[4:7], v9 offset:0
  v_mfma_f32_16x16x32_bf16 v[216:219], a[40:43], v[48:51], v[216:219]
  s_add_u32 m0, s37, 0x18380
  v_pk_add_f32 v[254:255], v[254:255], v[82:83]
  v_mfma_f32_16x16x32_bf16 v[220:223], a[40:43], v[56:59], v[220:223]
  ds_read_b128 a[8:11], v8 offset:1024
  v_cvt_pk_bf16_f32 v81, v82, v83
  v_mfma_f32_16x16x32_bf16 v[224:227], a[40:43], v[64:67], v[224:227]
  s_waitcnt lgkmcnt(3)
  ds_read_b128 a[12:15], v9 offset:1024
  ds_read_b128 a[16:19], v8 offset:2048
  v_mfma_f32_16x16x32_bf16 v[236:239], a[44:47], v[64:67], v[236:239]
  buffer_load_dwordx4 v14, s[16:19], s45 offen offset:128 nt lds
  v_mfma_f32_16x16x32_bf16 v[232:235], a[44:47], v[56:59], v[232:235]
  s_nop 0
  ds_read_b128 a[20:23], v9 offset:2048
  ds_read_b128 a[24:27], v8 offset:6144
  v_mfma_f32_16x16x32_bf16 v[228:231], a[44:47], v[48:51], v[228:231]
  s_waitcnt lgkmcnt(6)
  v_exp_f32 v84, v84
  v_mfma_f32_16x16x32_bf16 v[48:51], a[0:3], a[48:51], v[32:35]
  s_waitcnt lgkmcnt(5)
  v_exp_f32 v85, v85
  v_mfma_f32_16x16x32_bf16 v[48:51], a[4:7], a[60:63], v[48:51]
  s_waitcnt lgkmcnt(4)
  v_pk_add_f32 v[254:255], v[254:255], v[84:85]
  v_mfma_f32_16x16x32_bf16 v[48:51], a[8:11], a[72:75], v[48:51]
  s_waitcnt lgkmcnt(3)
  ds_read_b128 a[28:31], v9 offset:6144
  v_cvt_pk_bf16_f32 v82, v84, v85
  v_mfma_f32_16x16x32_bf16 v[48:51], a[12:15], a[84:87], v[48:51]
  s_waitcnt lgkmcnt(3)
  v_exp_f32 v86, v86
  v_mfma_f32_16x16x32_bf16 v[48:51], a[16:19], a[96:99], v[48:51]
  s_waitcnt lgkmcnt(2)
  v_exp_f32 v87, v87
  v_mfma_f32_16x16x32_bf16 v[48:51], a[20:23], a[108:111], v[48:51]
  v_pk_add_f32 v[254:255], v[254:255], v[86:87]
  v_mfma_f32_16x16x32_bf16 v[56:59], a[0:3], a[52:55], v[36:39]
  s_add_u32 m0, s37, 0x18700
  ds_read_b128 a[32:35], v8 offset:7168
  v_cvt_pk_bf16_f32 v83, v86, v87
  v_mfma_f32_16x16x32_bf16 v[56:59], a[4:7], a[64:67], v[56:59]
  buffer_load_dwordx4 v14, s[16:19], s45 offen offset:256 nt lds
  v_mfma_f32_16x16x32_bf16 v[56:59], a[8:11], a[76:79], v[56:59]
  v_exp_f32 v88, v88
  v_mfma_f32_16x16x32_bf16 v[56:59], a[12:15], a[88:91], v[56:59]
  v_exp_f32 v89, v89
  v_mfma_f32_16x16x32_bf16 v[56:59], a[16:19], a[100:103], v[56:59]
  v_pk_add_f32 v[2:3], v[2:3], v[88:89]
  v_mfma_f32_16x16x32_bf16 v[56:59], a[20:23], a[112:115], v[56:59]
  ds_read_b128 a[36:39], v9 offset:7168
  v_cvt_pk_bf16_f32 v88, v88, v89
  v_mfma_f32_16x16x32_bf16 v[64:67], a[0:3], a[56:59], v[40:43]
  v_exp_f32 v90, v90
  v_mfma_f32_16x16x32_bf16 v[64:67], a[4:7], a[68:71], v[64:67]
  s_nop 0
  ds_read_b128 a[40:43], v8 offset:8192
  ds_read_b128 a[44:47], v9 offset:8192
  v_mfma_f32_16x16x32_bf16 v[64:67], a[8:11], a[80:83], v[64:67]
  v_exp_f32 v91, v91
  v_mfma_f32_16x16x32_bf16 v[64:67], a[12:15], a[92:95], v[64:67]
  v_pk_add_f32 v[2:3], v[2:3], v[90:91]
  v_mfma_f32_16x16x32_bf16 v[64:67], a[16:19], a[104:107], v[64:67]
  v_cvt_pk_bf16_f32 v89, v90, v91
  v_mfma_f32_16x16x32_bf16 v[64:67], a[20:23], a[116:119], v[64:67]
  s_waitcnt lgkmcnt(5)
  v_exp_f32 v92, v92
  v_mfma_f32_16x16x32_bf16 v[52:55], a[24:27], a[48:51], v[32:35]
  s_waitcnt lgkmcnt(4)
  s_mov_b32 exec_lo, 0xc0000000
  s_mov_b32 exec_hi, 0xff
  s_waitcnt vmcnt(11)
  buffer_load_dword v18, v1, s[20:23], 0 offen
  s_mov_b64 exec, -1
  v_mfma_f32_16x16x32_bf16 v[52:55], a[28:31], a[60:63], v[52:55]
  s_waitcnt lgkmcnt(3)
  v_exp_f32 v93, v93
  v_mfma_f32_16x16x32_bf16 v[52:55], a[32:35], a[72:75], v[52:55]
  s_waitcnt lgkmcnt(2)
  v_pk_add_f32 v[2:3], v[2:3], v[92:93]
  v_mfma_f32_16x16x32_bf16 v[52:55], a[36:39], a[84:87], v[52:55]
  s_waitcnt lgkmcnt(1)
  v_cvt_pk_bf16_f32 v90, v92, v93
  v_add_u32 v4, 0xffff1000, v4
  v_mfma_f32_16x16x32_bf16 v[52:55], a[40:43], a[96:99], v[52:55]
  s_waitcnt lgkmcnt(0)
  s_mov_b32 s44, 0x18000
  s_add_u32 m0, s37, 0
  v_add_u32 v5, 0xffff1000, v5
  v_mfma_f32_16x16x32_bf16 v[52:55], a[44:47], a[108:111], v[52:55]
  buffer_load_dwordx4 v13, s[12:15], s44 offen nt lds
  v_mfma_f32_16x16x32_bf16 v[60:63], a[24:27], a[52:55], v[36:39]
  v_exp_f32 v94, v94
  v_mfma_f32_16x16x32_bf16 v[60:63], a[28:31], a[64:67], v[60:63]
  v_add_u32 v6, 0xffff1000, v6
  v_add_u32 v7, 0xffff1000, v7
  v_mfma_f32_16x16x32_bf16 v[60:63], a[32:35], a[76:79], v[60:63]
  s_nop 0
  ds_read_b64_tr_b16 a[0:1], v4 offset:0
  ds_read_b64_tr_b16 a[2:3], v4 offset:6144
  v_mfma_f32_16x16x32_bf16 v[60:63], a[36:39], a[88:91], v[60:63]
  s_nop 0
  ds_read_b64_tr_b16 a[4:5], v5 offset:0
  ds_read_b64_tr_b16 a[6:7], v5 offset:6144
  v_mfma_f32_16x16x32_bf16 v[60:63], a[40:43], a[100:103], v[60:63]
  v_exp_f32 v95, v95
  v_mfma_f32_16x16x32_bf16 v[60:63], a[44:47], a[112:115], v[60:63]
  v_exp_f32 v48, v48
  v_mfma_f32_16x16x32_bf16 v[68:71], a[24:27], a[56:59], v[40:43]
  v_exp_f32 v49, v49
  v_mfma_f32_16x16x32_bf16 v[68:71], a[28:31], a[68:71], v[68:71]
  v_exp_f32 v50, v50
  v_mfma_f32_16x16x32_bf16 v[68:71], a[32:35], a[80:83], v[68:71]
  v_exp_f32 v51, v51
  v_mfma_f32_16x16x32_bf16 v[68:71], a[36:39], a[92:95], v[68:71]
  v_exp_f32 v52, v52
  v_mfma_f32_16x16x32_bf16 v[68:71], a[40:43], a[104:107], v[68:71]
  v_pk_add_f32 v[2:3], v[2:3], v[94:95]
  v_cvt_pk_bf16_f32 v91, v94, v95
  v_mfma_f32_16x16x32_bf16 v[68:71], a[44:47], a[116:119], v[68:71]
  s_waitcnt lgkmcnt(2)
  ds_read_b64_tr_b16 a[8:9], v6 offset:0
  ds_read_b64_tr_b16 a[10:11], v6 offset:6144
  v_mfma_f32_16x16x32_bf16 v[96:99], a[0:3], v[72:75], v[96:99]
  s_add_u32 m0, s37, 0x380
  v_pk_add_f32 v[252:253], v[252:253], v[48:49]
  v_mfma_f32_16x16x32_bf16 v[100:103], a[0:3], v[80:83], v[100:103]
  buffer_load_dwordx4 v13, s[12:15], s44 offen offset:128 nt lds
  v_mfma_f32_16x16x32_bf16 v[104:107], a[0:3], v[88:91], v[104:107]
  s_waitcnt lgkmcnt(2)
  ds_read_b64_tr_b16 a[12:13], v7 offset:0
  ds_read_b64_tr_b16 a[14:15], v7 offset:6144
  v_mfma_f32_16x16x32_bf16 v[116:119], a[4:7], v[88:91], v[116:119]
  ds_read_b64_tr_b16 a[16:17], v4 offset:1024
  v_cvt_pk_bf16_f32 v48, v48, v49
  v_mfma_f32_16x16x32_bf16 v[112:115], a[4:7], v[80:83], v[112:115]
  v_pk_add_f32 v[252:253], v[252:253], v[50:51]
  v_mfma_f32_16x16x32_bf16 v[108:111], a[4:7], v[72:75], v[108:111]
  s_waitcnt lgkmcnt(3)
  ds_read_b64_tr_b16 a[18:19], v4 offset:7168
  v_cvt_pk_bf16_f32 v49, v50, v51
  v_mfma_f32_16x16x32_bf16 v[120:123], a[8:11], v[72:75], v[120:123]
  v_exp_f32 v53, v53
  v_mfma_f32_16x16x32_bf16 v[124:127], a[8:11], v[80:83], v[124:127]
  v_pk_add_f32 v[252:253], v[252:253], v[52:53]
  v_mfma_f32_16x16x32_bf16 v[128:131], a[8:11], v[88:91], v[128:131]
  s_waitcnt lgkmcnt(2)
  ds_read_b64_tr_b16 a[20:21], v5 offset:1024
  ds_read_b64_tr_b16 a[22:23], v5 offset:7168
  v_mfma_f32_16x16x32_bf16 v[140:143], a[12:15], v[88:91], v[140:143]
  ds_read_b64_tr_b16 a[24:25], v6 offset:1024
  v_cvt_pk_bf16_f32 v50, v52, v53
  v_mfma_f32_16x16x32_bf16 v[136:139], a[12:15], v[80:83], v[136:139]
  v_exp_f32 v54, v54
  v_mfma_f32_16x16x32_bf16 v[132:135], a[12:15], v[72:75], v[132:135]
  s_waitcnt lgkmcnt(3)
  ds_read_b64_tr_b16 a[26:27], v6 offset:7168
  ds_read_b64_tr_b16 a[28:29], v7 offset:1024
  v_mfma_f32_16x16x32_bf16 v[144:147], a[16:19], v[72:75], v[144:147]
  s_add_u32 m0, s37, 0x700
  v_exp_f32 v55, v55
  v_mfma_f32_16x16x32_bf16 v[148:151], a[16:19], v[80:83], v[148:151]
  buffer_load_dwordx4 v13, s[12:15], s44 offen offset:256 nt lds
  v_mfma_f32_16x16x32_bf16 v[152:155], a[16:19], v[88:91], v[152:155]
  s_waitcnt lgkmcnt(3)
  ds_read_b64_tr_b16 a[30:31], v7 offset:7168
  ds_read_b64_tr_b16 a[32:33], v4 offset:2048
  v_mfma_f32_16x16x32_bf16 v[164:167], a[20:23], v[88:91], v[164:167]
  v_pk_add_f32 v[252:253], v[252:253], v[54:55]
  v_mfma_f32_16x16x32_bf16 v[160:163], a[20:23], v[80:83], v[160:163]
  ds_read_b64_tr_b16 a[34:35], v4 offset:8192
  v_cvt_pk_bf16_f32 v51, v54, v55
  v_mfma_f32_16x16x32_bf16 v[156:159], a[20:23], v[72:75], v[156:159]
  s_waitcnt lgkmcnt(4)
  v_exp_f32 v56, v56
  v_mfma_f32_16x16x32_bf16 v[168:171], a[24:27], v[72:75], v[168:171]
  v_exp_f32 v57, v57
  v_mfma_f32_16x16x32_bf16 v[172:175], a[24:27], v[80:83], v[172:175]
  v_pk_add_f32 v[254:255], v[254:255], v[56:57]
  v_mfma_f32_16x16x32_bf16 v[176:179], a[24:27], v[88:91], v[176:179]
  s_waitcnt lgkmcnt(2)
  ds_read_b64_tr_b16 a[36:37], v5 offset:2048
  ds_read_b64_tr_b16 a[38:39], v5 offset:8192
  v_mfma_f32_16x16x32_bf16 v[188:191], a[28:31], v[88:91], v[188:191]
  ds_read_b64_tr_b16 a[40:41], v6 offset:2048
  v_cvt_pk_bf16_f32 v56, v56, v57
  v_mfma_f32_16x16x32_bf16 v[184:187], a[28:31], v[80:83], v[184:187]
  s_barrier
  ds_read_b64_tr_b16 a[42:43], v6 offset:8192
  v_mfma_f32_16x16x32_bf16 v[180:183], a[28:31], v[72:75], v[180:183]
  s_waitcnt lgkmcnt(4)
  v_exp_f32 v58, v58
  v_mfma_f32_16x16x32_bf16 v[192:195], a[32:35], v[72:75], v[192:195]
  v_exp_f32 v59, v59
  v_mfma_f32_16x16x32_bf16 v[196:199], a[32:35], v[80:83], v[196:199]
  v_pk_add_f32 v[254:255], v[254:255], v[58:59]
  v_mfma_f32_16x16x32_bf16 v[200:203], a[32:35], v[88:91], v[200:203]
  s_waitcnt lgkmcnt(2)
  ds_read_b64_tr_b16 a[44:45], v7 offset:2048
  ds_read_b64_tr_b16 a[46:47], v7 offset:8192
  v_mfma_f32_16x16x32_bf16 v[212:215], a[36:39], v[88:91], v[212:215]
  s_mov_b32 s45, 0x15000
  s_add_u32 m0, s37, 0x1e000
  v_cvt_pk_bf16_f32 v57, v58, v59
  v_mfma_f32_16x16x32_bf16 v[208:211], a[36:39], v[80:83], v[208:211]
  v_add_u32 v8, 0xffff4000, v8
  v_add_u32 v9, 0xffff4000, v9
  v_mfma_f32_16x16x32_bf16 v[204:207], a[36:39], v[72:75], v[204:207]
  s_waitcnt lgkmcnt(2)
  ds_read_b128 a[0:3], v8 offset:0
  ds_read_b128 a[4:7], v9 offset:0
  v_mfma_f32_16x16x32_bf16 v[216:219], a[40:43], v[72:75], v[216:219]
  buffer_load_dwordx4 v14, s[16:19], s45 offen nt lds
  v_mfma_f32_16x16x32_bf16 v[220:223], a[40:43], v[80:83], v[220:223]
  s_nop 0
  ds_read_b128 a[8:11], v8 offset:1024
  ds_read_b128 a[12:15], v9 offset:1024
  v_mfma_f32_16x16x32_bf16 v[224:227], a[40:43], v[88:91], v[224:227]
  s_waitcnt lgkmcnt(4)
  v_exp_f32 v60, v60
  v_mfma_f32_16x16x32_bf16 v[236:239], a[44:47], v[88:91], v[236:239]
  s_nop 0
  ds_read_b128 a[16:19], v8 offset:2048
  ds_read_b128 a[20:23], v9 offset:2048
  v_mfma_f32_16x16x32_bf16 v[232:235], a[44:47], v[80:83], v[232:235]
  v_exp_f32 v61, v61
  v_mfma_f32_16x16x32_bf16 v[228:231], a[44:47], v[72:75], v[228:231]
  s_waitcnt lgkmcnt(5)
  v_pk_add_f32 v[254:255], v[254:255], v[60:61]
  v_mfma_f32_16x16x32_bf16 v[72:75], a[0:3], a[48:51], v[32:35]
  s_waitcnt lgkmcnt(4)
  buffer_load_dword v46, v44, s[60:63], 0 offen sc1
  v_mfma_f32_16x16x32_bf16 v[72:75], a[4:7], a[60:63], v[72:75]
  s_waitcnt lgkmcnt(3)
  ds_read_b128 a[24:27], v8 offset:6144
  v_cvt_pk_bf16_f32 v58, v60, v61
  v_mfma_f32_16x16x32_bf16 v[72:75], a[8:11], a[72:75], v[72:75]
  s_waitcnt lgkmcnt(3)
  v_exp_f32 v62, v62
  v_mfma_f32_16x16x32_bf16 v[72:75], a[12:15], a[84:87], v[72:75]
  s_waitcnt lgkmcnt(2)
  v_exp_f32 v63, v63
  v_mfma_f32_16x16x32_bf16 v[72:75], a[16:19], a[96:99], v[72:75]
  s_waitcnt lgkmcnt(1)
  s_add_u32 m0, s37, 0x1e380
  v_pk_add_f32 v[254:255], v[254:255], v[62:63]
  v_mfma_f32_16x16x32_bf16 v[72:75], a[20:23], a[108:111], v[72:75]
  buffer_load_dwordx4 v14, s[16:19], s45 offen offset:128 nt lds
  v_mfma_f32_16x16x32_bf16 v[80:83], a[0:3], a[52:55], v[36:39]
  ds_read_b128 a[28:31], v9 offset:6144
  v_cvt_pk_bf16_f32 v59, v62, v63
  v_mfma_f32_16x16x32_bf16 v[80:83], a[4:7], a[64:67], v[80:83]
  v_exp_f32 v64, v64
  v_mfma_f32_16x16x32_bf16 v[80:83], a[8:11], a[76:79], v[80:83]
  v_exp_f32 v65, v65
  v_mfma_f32_16x16x32_bf16 v[80:83], a[12:15], a[88:91], v[80:83]
  v_pk_add_f32 v[2:3], v[2:3], v[64:65]
  v_mfma_f32_16x16x32_bf16 v[80:83], a[16:19], a[100:103], v[80:83]
  ds_read_b128 a[32:35], v8 offset:7168
  v_cvt_pk_bf16_f32 v64, v64, v65
  v_mfma_f32_16x16x32_bf16 v[80:83], a[20:23], a[112:115], v[80:83]
  v_exp_f32 v66, v66
  v_mfma_f32_16x16x32_bf16 v[88:91], a[0:3], a[56:59], v[40:43]
  s_nop 0
  ds_read_b128 a[36:39], v9 offset:7168
  ds_read_b128 a[40:43], v8 offset:8192
  v_mfma_f32_16x16x32_bf16 v[88:91], a[4:7], a[68:71], v[88:91]
  ds_read_b128 a[44:47], v9 offset:8192
  v_mfma_f32_16x16x32_bf16 v[88:91], a[8:11], a[80:83], v[88:91]
  v_exp_f32 v67, v67
  v_mfma_f32_16x16x32_bf16 v[88:91], a[12:15], a[92:95], v[88:91]
  v_pk_add_f32 v[2:3], v[2:3], v[66:67]
  v_mfma_f32_16x16x32_bf16 v[88:91], a[16:19], a[104:107], v[88:91]
  s_mov_b32 exec_lo, 0x0
  s_mov_b32 exec_hi, 0x3ff00
  s_waitcnt vmcnt(12)
  buffer_load_dword v17, v1, s[20:23], 0 offen
  s_mov_b64 exec, -1
  v_mfma_f32_16x16x32_bf16 v[88:91], a[20:23], a[116:119], v[88:91]
  s_waitcnt lgkmcnt(5)
  s_add_u32 m0, s37, 0x1e700
  v_cvt_pk_bf16_f32 v65, v66, v67
  v_mfma_f32_16x16x32_bf16 v[76:79], a[24:27], a[48:51], v[32:35]
  s_waitcnt lgkmcnt(4)
  buffer_load_dwordx4 v14, s[16:19], s45 offen offset:256 nt lds
  v_mfma_f32_16x16x32_bf16 v[76:79], a[28:31], a[60:63], v[76:79]
  s_waitcnt lgkmcnt(3)
  v_exp_f32 v68, v68
  v_mfma_f32_16x16x32_bf16 v[76:79], a[32:35], a[72:75], v[76:79]
  s_waitcnt lgkmcnt(2)
  v_exp_f32 v69, v69
  v_mfma_f32_16x16x32_bf16 v[76:79], a[36:39], a[84:87], v[76:79]
  s_waitcnt lgkmcnt(1)
  v_pk_add_f32 v[2:3], v[2:3], v[68:69]
  v_mfma_f32_16x16x32_bf16 v[76:79], a[40:43], a[96:99], v[76:79]
  s_waitcnt lgkmcnt(0)
  v_cvt_pk_bf16_f32 v66, v68, v69
  v_add_u32 v4, 0xffff4000, v4
  v_mfma_f32_16x16x32_bf16 v[76:79], a[44:47], a[108:111], v[76:79]
  v_exp_f32 v70, v70
  v_mfma_f32_16x16x32_bf16 v[84:87], a[24:27], a[52:55], v[36:39]
  v_add_u32 v5, 0xffff4000, v5
  v_add_u32 v6, 0xffff4000, v6
  v_mfma_f32_16x16x32_bf16 v[84:87], a[28:31], a[64:67], v[84:87]
  v_add_u32 v7, 0xffff4000, v7
  v_mfma_f32_16x16x32_bf16 v[84:87], a[32:35], a[76:79], v[84:87]
  s_nop 0
  ds_read_b64_tr_b16 a[0:1], v4 offset:0
  ds_read_b64_tr_b16 a[2:3], v4 offset:6144
  v_mfma_f32_16x16x32_bf16 v[84:87], a[36:39], a[88:91], v[84:87]
  s_nop 0
  ds_read_b64_tr_b16 a[4:5], v5 offset:0
  ds_read_b64_tr_b16 a[6:7], v5 offset:6144
  v_mfma_f32_16x16x32_bf16 v[84:87], a[40:43], a[100:103], v[84:87]
  v_exp_f32 v71, v71
  v_mfma_f32_16x16x32_bf16 v[84:87], a[44:47], a[112:115], v[84:87]
  v_exp_f32 v72, v72
  v_mfma_f32_16x16x32_bf16 v[92:95], a[24:27], a[56:59], v[40:43]
  v_exp_f32 v73, v73
  v_mfma_f32_16x16x32_bf16 v[92:95], a[28:31], a[68:71], v[92:95]
  v_exp_f32 v74, v74
  v_mfma_f32_16x16x32_bf16 v[92:95], a[32:35], a[80:83], v[92:95]
  v_exp_f32 v75, v75
  v_mfma_f32_16x16x32_bf16 v[92:95], a[36:39], a[92:95], v[92:95]
  s_mov_b32 s44, 0x1b000
  v_exp_f32 v76, v76
  v_mfma_f32_16x16x32_bf16 v[92:95], a[40:43], a[104:107], v[92:95]
  v_pk_add_f32 v[2:3], v[2:3], v[70:71]
  v_cvt_pk_bf16_f32 v67, v70, v71
  v_mfma_f32_16x16x32_bf16 v[92:95], a[44:47], a[116:119], v[92:95]
  s_waitcnt lgkmcnt(2)
  ds_read_b64_tr_b16 a[8:9], v6 offset:0
  ds_read_b64_tr_b16 a[10:11], v6 offset:6144
  v_mfma_f32_16x16x32_bf16 v[96:99], a[0:3], v[48:51], v[96:99]
  s_add_u32 m0, s37, 0x3000
  v_pk_add_f32 v[252:253], v[252:253], v[72:73]
  v_mfma_f32_16x16x32_bf16 v[100:103], a[0:3], v[56:59], v[100:103]
  buffer_load_dwordx4 v13, s[12:15], s44 offen nt lds
  v_mfma_f32_16x16x32_bf16 v[104:107], a[0:3], v[64:67], v[104:107]
  s_waitcnt lgkmcnt(2)
  ds_read_b64_tr_b16 a[12:13], v7 offset:0
  ds_read_b64_tr_b16 a[14:15], v7 offset:6144
  v_mfma_f32_16x16x32_bf16 v[116:119], a[4:7], v[64:67], v[116:119]
  ds_read_b64_tr_b16 a[16:17], v4 offset:1024
  v_cvt_pk_bf16_f32 v72, v72, v73
  v_mfma_f32_16x16x32_bf16 v[112:115], a[4:7], v[56:59], v[112:115]
  v_pk_add_f32 v[252:253], v[252:253], v[74:75]
  v_mfma_f32_16x16x32_bf16 v[108:111], a[4:7], v[48:51], v[108:111]
  s_waitcnt lgkmcnt(3)
  ds_read_b64_tr_b16 a[18:19], v4 offset:7168
  v_cvt_pk_bf16_f32 v73, v74, v75
  v_mfma_f32_16x16x32_bf16 v[120:123], a[8:11], v[48:51], v[120:123]
  v_exp_f32 v77, v77
  v_mfma_f32_16x16x32_bf16 v[124:127], a[8:11], v[56:59], v[124:127]
  v_pk_add_f32 v[252:253], v[252:253], v[76:77]
  v_mfma_f32_16x16x32_bf16 v[128:131], a[8:11], v[64:67], v[128:131]
  s_waitcnt lgkmcnt(2)
  ds_read_b64_tr_b16 a[20:21], v5 offset:1024
  ds_read_b64_tr_b16 a[22:23], v5 offset:7168
  v_mfma_f32_16x16x32_bf16 v[140:143], a[12:15], v[64:67], v[140:143]
  ds_read_b64_tr_b16 a[24:25], v6 offset:1024
  v_cvt_pk_bf16_f32 v74, v76, v77
  v_mfma_f32_16x16x32_bf16 v[136:139], a[12:15], v[56:59], v[136:139]
  s_add_u32 m0, s37, 0x3380
  v_exp_f32 v78, v78
  v_mfma_f32_16x16x32_bf16 v[132:135], a[12:15], v[48:51], v[132:135]
  s_waitcnt lgkmcnt(3)
  ds_read_b64_tr_b16 a[26:27], v6 offset:7168
  ds_read_b64_tr_b16 a[28:29], v7 offset:1024
  v_mfma_f32_16x16x32_bf16 v[144:147], a[16:19], v[48:51], v[144:147]
  buffer_load_dwordx4 v13, s[12:15], s44 offen offset:128 nt lds
  v_mfma_f32_16x16x32_bf16 v[148:151], a[16:19], v[56:59], v[148:151]
  v_exp_f32 v79, v79
  v_mfma_f32_16x16x32_bf16 v[152:155], a[16:19], v[64:67], v[152:155]
  s_waitcnt lgkmcnt(3)
  ds_read_b64_tr_b16 a[30:31], v7 offset:7168
  ds_read_b64_tr_b16 a[32:33], v4 offset:2048
  v_mfma_f32_16x16x32_bf16 v[164:167], a[20:23], v[64:67], v[164:167]
  v_pk_add_f32 v[252:253], v[252:253], v[78:79]
  v_mfma_f32_16x16x32_bf16 v[160:163], a[20:23], v[56:59], v[160:163]
  ds_read_b64_tr_b16 a[34:35], v4 offset:8192
  v_cvt_pk_bf16_f32 v75, v78, v79
  v_mfma_f32_16x16x32_bf16 v[156:159], a[20:23], v[48:51], v[156:159]
  s_waitcnt lgkmcnt(4)
  v_exp_f32 v80, v80
  v_mfma_f32_16x16x32_bf16 v[168:171], a[24:27], v[48:51], v[168:171]
  v_exp_f32 v81, v81
  v_mfma_f32_16x16x32_bf16 v[172:175], a[24:27], v[56:59], v[172:175]
  v_pk_add_f32 v[254:255], v[254:255], v[80:81]
  v_mfma_f32_16x16x32_bf16 v[176:179], a[24:27], v[64:67], v[176:179]
  s_waitcnt lgkmcnt(2)
  ds_read_b64_tr_b16 a[36:37], v5 offset:2048
  ds_read_b64_tr_b16 a[38:39], v5 offset:8192
  v_mfma_f32_16x16x32_bf16 v[188:191], a[28:31], v[64:67], v[188:191]
  ds_read_b64_tr_b16 a[40:41], v6 offset:2048
  v_cvt_pk_bf16_f32 v80, v80, v81
  v_mfma_f32_16x16x32_bf16 v[184:187], a[28:31], v[56:59], v[184:187]
  s_barrier
  ds_read_b64_tr_b16 a[42:43], v6 offset:8192
  v_mfma_f32_16x16x32_bf16 v[180:183], a[28:31], v[48:51], v[180:183]
  s_waitcnt lgkmcnt(4)
  v_exp_f32 v82, v82
  v_mfma_f32_16x16x32_bf16 v[192:195], a[32:35], v[48:51], v[192:195]
  s_add_u32 m0, s37, 0x3700
  v_exp_f32 v83, v83
  v_mfma_f32_16x16x32_bf16 v[196:199], a[32:35], v[56:59], v[196:199]
  buffer_load_dwordx4 v13, s[12:15], s44 offen offset:256 nt lds
  v_mfma_f32_16x16x32_bf16 v[200:203], a[32:35], v[64:67], v[200:203]
  s_waitcnt lgkmcnt(2)
  ds_read_b64_tr_b16 a[44:45], v7 offset:2048
  ds_read_b64_tr_b16 a[46:47], v7 offset:8192
  v_mfma_f32_16x16x32_bf16 v[212:215], a[36:39], v[64:67], v[212:215]
  v_pk_add_f32 v[254:255], v[254:255], v[82:83]
  v_mfma_f32_16x16x32_bf16 v[208:211], a[36:39], v[56:59], v[208:211]
  ds_read_b128 a[0:3], v8 offset:24576
  v_cvt_pk_bf16_f32 v81, v82, v83
  v_mfma_f32_16x16x32_bf16 v[204:207], a[36:39], v[48:51], v[204:207]
  s_waitcnt lgkmcnt(3)
  v_exp_f32 v84, v84
  v_mfma_f32_16x16x32_bf16 v[216:219], a[40:43], v[48:51], v[216:219]
  s_nop 0
  ds_read_b128 a[4:7], v9 offset:24576
  ds_read_b128 a[8:11], v8 offset:25600
  v_mfma_f32_16x16x32_bf16 v[220:223], a[40:43], v[56:59], v[220:223]
  v_exp_f32 v85, v85
  v_mfma_f32_16x16x32_bf16 v[224:227], a[40:43], v[64:67], v[224:227]
  s_waitcnt lgkmcnt(3)
  ds_read_b128 a[12:15], v9 offset:25600
  ds_read_b128 a[16:19], v8 offset:26624
  v_mfma_f32_16x16x32_bf16 v[236:239], a[44:47], v[64:67], v[236:239]
  v_pk_add_f32 v[254:255], v[254:255], v[84:85]
  v_mfma_f32_16x16x32_bf16 v[232:235], a[44:47], v[56:59], v[232:235]
  ds_read_b128 a[20:23], v9 offset:26624
  v_cvt_pk_bf16_f32 v82, v84, v85
  v_mfma_f32_16x16x32_bf16 v[228:231], a[44:47], v[48:51], v[228:231]
  s_waitcnt lgkmcnt(5)
  v_exp_f32 v86, v86
  v_mfma_f32_16x16x32_bf16 v[48:51], a[0:3], a[48:51], v[32:35]
  s_waitcnt lgkmcnt(4)
  buffer_load_dword v47, v45, s[60:63], 0 offen sc1
  v_mfma_f32_16x16x32_bf16 v[48:51], a[4:7], a[60:63], v[48:51]
  s_waitcnt lgkmcnt(3)
  v_exp_f32 v87, v87
  v_mfma_f32_16x16x32_bf16 v[48:51], a[8:11], a[72:75], v[48:51]
  s_waitcnt lgkmcnt(2)
  v_pk_add_f32 v[254:255], v[254:255], v[86:87]
  v_mfma_f32_16x16x32_bf16 v[48:51], a[12:15], a[84:87], v[48:51]
L_hop5:
  s_cbranch_execz L_hop9
  s_waitcnt lgkmcnt(1)
  s_mov_b32 s45, 0x18000
  s_add_u32 m0, s37, 0x21000
  v_cvt_pk_bf16_f32 v83, v86, v87
  v_mfma_f32_16x16x32_bf16 v[48:51], a[16:19], a[96:99], v[48:51]
  s_waitcnt lgkmcnt(0)
  buffer_load_dwordx4 v14, s[16:19], s45 offen nt lds
  v_mfma_f32_16x16x32_bf16 v[48:51], a[20:23], a[108:111], v[48:51]
  v_exp_f32 v88, v88
  v_mfma_f32_16x16x32_bf16 v[56:59], a[0:3], a[52:55], v[36:39]
  v_exp_f32 v89, v89
  v_mfma_f32_16x16x32_bf16 v[56:59], a[4:7], a[64:67], v[56:59]
  v_pk_add_f32 v[2:3], v[2:3], v[88:89]
  v_mfma_f32_16x16x32_bf16 v[56:59], a[8:11], a[76:79], v[56:59]
  ds_read_b128 a[24:27], v8 offset:30720
  v_cvt_pk_bf16_f32 v88, v88, v89
  v_mfma_f32_16x16x32_bf16 v[56:59], a[12:15], a[88:91], v[56:59]
  s_nop 0
  ds_read_b128 a[28:31], v9 offset:30720
  ds_read_b128 a[32:35], v8 offset:31744
  v_mfma_f32_16x16x32_bf16 v[56:59], a[16:19], a[100:103], v[56:59]
  v_exp_f32 v90, v90
  v_mfma_f32_16x16x32_bf16 v[56:59], a[20:23], a[112:115], v[56:59]
  s_nop 0
  ds_read_b128 a[36:39], v9 offset:31744
  ds_read_b128 a[40:43], v8 offset:32768
  v_mfma_f32_16x16x32_bf16 v[64:67], a[0:3], a[56:59], v[40:43]
  ds_read_b128 a[44:47], v9 offset:32768
  v_mfma_f32_16x16x32_bf16 v[64:67], a[4:7], a[68:71], v[64:67]
  v_exp_f32 v91, v91
  v_mfma_f32_16x16x32_bf16 v[64:67], a[8:11], a[80:83], v[64:67]
  s_mov_b32 exec_lo, 0x0
  s_mov_b32 exec_hi, 0xffc0000
  s_waitcnt vmcnt(13)
  buffer_load_dword v18, v1, s[20:23], 0 offen
  s_mov_b64 exec, -1
  v_mfma_f32_16x16x32_bf16 v[64:67], a[12:15], a[92:95], v[64:67]
  v_pk_add_f32 v[2:3], v[2:3], v[90:91]
  v_mfma_f32_16x16x32_bf16 v[64:67], a[16:19], a[104:107], v[64:67]
  s_add_u32 m0, s37, 0x21380
  v_cvt_pk_bf16_f32 v89, v90, v91
  v_mfma_f32_16x16x32_bf16 v[64:67], a[20:23], a[116:119], v[64:67]
  s_waitcnt lgkmcnt(5)
  v_exp_f32 v92, v92
  v_mfma_f32_16x16x32_bf16 v[52:55], a[24:27], a[48:51], v[32:35]
  s_waitcnt lgkmcnt(4)
  buffer_load_dwordx4 v14, s[16:19], s45 offen offset:128 nt lds
  v_mfma_f32_16x16x32_bf16 v[52:55], a[28:31], a[60:63], v[52:55]
  s_waitcnt lgkmcnt(3)
  v_exp_f32 v93, v93
  v_mfma_f32_16x16x32_bf16 v[52:55], a[32:35], a[72:75], v[52:55]
  s_waitcnt lgkmcnt(2)
  v_pk_add_f32 v[2:3], v[2:3], v[92:93]
  v_mfma_f32_16x16x32_bf16 v[52:55], a[36:39], a[84:87], v[52:55]
  s_waitcnt lgkmcnt(1)
  v_cvt_pk_bf16_f32 v90, v92, v93
  v_add_u32 v4, 0x12000, v4
  v_mfma_f32_16x16x32_bf16 v[52:55], a[40:43], a[96:99], v[52:55]
  s_waitcnt lgkmcnt(0)
  v_exp_f32 v94, v94
  v_mfma_f32_16x16x32_bf16 v[52:55], a[44:47], a[108:111], v[52:55]
  v_add_u32 v5, 0x12000, v5
  v_add_u32 v6, 0x12000, v6
  v_mfma_f32_16x16x32_bf16 v[60:63], a[24:27], a[52:55], v[36:39]
  v_add_u32 v7, 0x12000, v7
  v_mfma_f32_16x16x32_bf16 v[60:63], a[28:31], a[64:67], v[60:63]
  s_nop 0
  ds_read_b64_tr_b16 a[0:1], v4 offset:0
  ds_read_b64_tr_b16 a[2:3], v4 offset:6144
  v_mfma_f32_16x16x32_bf16 v[60:63], a[32:35], a[76:79], v[60:63]
  s_nop 0
  ds_read_b64_tr_b16 a[4:5], v5 offset:0
  ds_read_b64_tr_b16 a[6:7], v5 offset:6144
  v_mfma_f32_16x16x32_bf16 v[60:63], a[36:39], a[88:91], v[60:63]
  v_exp_f32 v95, v95
  v_mfma_f32_16x16x32_bf16 v[60:63], a[40:43], a[100:103], v[60:63]
  v_exp_f32 v48, v48
  v_mfma_f32_16x16x32_bf16 v[60:63], a[44:47], a[112:115], v[60:63]
  s_add_u32 m0, s37, 0x21700
  v_exp_f32 v49, v49
  v_mfma_f32_16x16x32_bf16 v[68:71], a[24:27], a[56:59], v[40:43]
  buffer_load_dwordx4 v14, s[16:19], s45 offen offset:256 nt lds
  v_mfma_f32_16x16x32_bf16 v[68:71], a[28:31], a[68:71], v[68:71]
  v_exp_f32 v50, v50
  v_mfma_f32_16x16x32_bf16 v[68:71], a[32:35], a[80:83], v[68:71]
  v_exp_f32 v51, v51
  v_mfma_f32_16x16x32_bf16 v[68:71], a[36:39], a[92:95], v[68:71]
  v_exp_f32 v52, v52
  v_mfma_f32_16x16x32_bf16 v[68:71], a[40:43], a[104:107], v[68:71]
  v_pk_add_f32 v[2:3], v[2:3], v[94:95]
  v_cvt_pk_bf16_f32 v91, v94, v95
  v_mfma_f32_16x16x32_bf16 v[68:71], a[44:47], a[116:119], v[68:71]
  s_waitcnt lgkmcnt(2)
  ds_read_b64_tr_b16 a[8:9], v6 offset:0
  ds_read_b64_tr_b16 a[10:11], v6 offset:6144
  v_mfma_f32_16x16x32_bf16 v[96:99], a[0:3], v[72:75], v[96:99]
  v_pk_add_f32 v[252:253], v[252:253], v[48:49]
  v_mfma_f32_16x16x32_bf16 v[100:103], a[0:3], v[80:83], v[100:103]
  ds_read_b64_tr_b16 a[12:13], v7 offset:0
  v_cvt_pk_bf16_f32 v48, v48, v49
  v_mfma_f32_16x16x32_bf16 v[104:107], a[0:3], v[88:91], v[104:107]
  s_waitcnt lgkmcnt(3)
  ds_read_b64_tr_b16 a[14:15], v7 offset:6144
  ds_read_b64_tr_b16 a[16:17], v4 offset:1024
  v_mfma_f32_16x16x32_bf16 v[116:119], a[4:7], v[88:91], v[116:119]
  v_pk_add_f32 v[252:253], v[252:253], v[50:51]
  v_mfma_f32_16x16x32_bf16 v[112:115], a[4:7], v[80:83], v[112:115]
  ds_read_b64_tr_b16 a[18:19], v4 offset:7168
  v_cvt_pk_bf16_f32 v49, v50, v51
  v_mfma_f32_16x16x32_bf16 v[108:111], a[4:7], v[72:75], v[108:111]
  s_waitcnt lgkmcnt(4)
  v_exp_f32 v53, v53
  v_mfma_f32_16x16x32_bf16 v[120:123], a[8:11], v[72:75], v[120:123]
  v_pk_add_f32 v[252:253], v[252:253], v[52:53]
  v_mfma_f32_16x16x32_bf16 v[124:127], a[8:11], v[80:83], v[124:127]
  ds_read_b64_tr_b16 a[20:21], v5 offset:1024
  v_cvt_pk_bf16_f32 v50, v52, v53
  v_mfma_f32_16x16x32_bf16 v[128:131], a[8:11], v[88:91], v[128:131]
  s_waitcnt lgkmcnt(3)
  s_mov_b32 s44, 0x1e000
  ds_read_b64_tr_b16 a[22:23], v5 offset:7168
  v_mfma_f32_16x16x32_bf16 v[140:143], a[12:15], v[88:91], v[140:143]
  s_add_u32 m0, s37, 0x12000
  v_exp_f32 v54, v54
  v_mfma_f32_16x16x32_bf16 v[136:139], a[12:15], v[80:83], v[136:139]
  buffer_load_dwordx4 v13, s[12:15], s44 offen nt lds
  v_mfma_f32_16x16x32_bf16 v[132:135], a[12:15], v[72:75], v[132:135]
  s_waitcnt lgkmcnt(2)
  ds_read_b64_tr_b16 a[24:25], v6 offset:1024
  ds_read_b64_tr_b16 a[26:27], v6 offset:7168
  v_mfma_f32_16x16x32_bf16 v[144:147], a[16:19], v[72:75], v[144:147]
  v_exp_f32 v55, v55
  v_mfma_f32_16x16x32_bf16 v[148:151], a[16:19], v[80:83], v[148:151]
  v_pk_add_f32 v[252:253], v[252:253], v[54:55]
  v_mfma_f32_16x16x32_bf16 v[152:155], a[16:19], v[88:91], v[152:155]
  s_waitcnt lgkmcnt(2)
  ds_read_b64_tr_b16 a[28:29], v7 offset:1024
  ds_read_b64_tr_b16 a[30:31], v7 offset:7168
  v_mfma_f32_16x16x32_bf16 v[164:167], a[20:23], v[88:91], v[164:167]
  ds_read_b64_tr_b16 a[32:33], v4 offset:2048
  v_cvt_pk_bf16_f32 v51, v54, v55
  v_mfma_f32_16x16x32_bf16 v[160:163], a[20:23], v[80:83], v[160:163]
  v_exp_f32 v56, v56
  v_mfma_f32_16x16x32_bf16 v[156:159], a[20:23], v[72:75], v[156:159]
  s_waitcnt lgkmcnt(3)
  ds_read_b64_tr_b16 a[34:35], v4 offset:8192
  ds_read_b64_tr_b16 a[36:37], v5 offset:2048
  v_mfma_f32_16x16x32_bf16 v[168:171], a[24:27], v[72:75], v[168:171]
  v_exp_f32 v57, v57
  v_mfma_f32_16x16x32_bf16 v[172:175], a[24:27], v[80:83], v[172:175]
  v_pk_add_f32 v[254:255], v[254:255], v[56:57]
  v_mfma_f32_16x16x32_bf16 v[176:179], a[24:27], v[88:91], v[176:179]
  s_waitcnt lgkmcnt(3)
  ds_read_b64_tr_b16 a[38:39], v5 offset:8192
  v_cvt_pk_bf16_f32 v56, v56, v57
  v_mfma_f32_16x16x32_bf16 v[188:191], a[28:31], v[88:91], v[188:191]
  s_add_u32 m0, s37, 0x12380
  v_exp_f32 v58, v58
  v_mfma_f32_16x16x32_bf16 v[184:187], a[28:31], v[80:83], v[184:187]
  s_barrier
  ds_read_b64_tr_b16 a[40:41], v6 offset:2048
  v_mfma_f32_16x16x32_bf16 v[180:183], a[28:31], v[72:75], v[180:183]
  s_waitcnt lgkmcnt(3)
  ds_read_b64_tr_b16 a[42:43], v6 offset:8192
  ds_read_b64_tr_b16 a[44:45], v7 offset:2048
  v_mfma_f32_16x16x32_bf16 v[192:195], a[32:35], v[72:75], v[192:195]
  buffer_load_dwordx4 v13, s[12:15], s44 offen offset:128 nt lds
  v_mfma_f32_16x16x32_bf16 v[196:199], a[32:35], v[80:83], v[196:199]
  v_exp_f32 v59, v59
  v_mfma_f32_16x16x32_bf16 v[200:203], a[32:35], v[88:91], v[200:203]
  s_waitcnt lgkmcnt(3)
  ds_read_b64_tr_b16 a[46:47], v7 offset:8192
  ds_read_b128 a[0:3], v8 offset:36864
  v_mfma_f32_16x16x32_bf16 v[212:215], a[36:39], v[88:91], v[212:215]
  v_pk_add_f32 v[254:255], v[254:255], v[58:59]
  v_mfma_f32_16x16x32_bf16 v[208:211], a[36:39], v[80:83], v[208:211]
  ds_read_b128 a[4:7], v9 offset:36864
  v_cvt_pk_bf16_f32 v57, v58, v59
  v_mfma_f32_16x16x32_bf16 v[204:207], a[36:39], v[72:75], v[204:207]
  s_waitcnt lgkmcnt(4)
  v_exp_f32 v60, v60
  v_mfma_f32_16x16x32_bf16 v[216:219], a[40:43], v[72:75], v[216:219]
  v_exp_f32 v61, v61
  v_mfma_f32_16x16x32_bf16 v[220:223], a[40:43], v[80:83], v[220:223]
  s_nop 0
  ds_read_b128 a[8:11], v8 offset:37888
  ds_read_b128 a[12:15], v9 offset:37888
  v_mfma_f32_16x16x32_bf16 v[224:227], a[40:43], v[88:91], v[224:227]
  s_waitcnt lgkmcnt(4)
  v_pk_add_f32 v[254:255], v[254:255], v[60:61]
  v_mfma_f32_16x16x32_bf16 v[236:239], a[44:47], v[88:91], v[236:239]
  ds_read_b128 a[16:19], v8 offset:38912
  v_cvt_pk_bf16_f32 v58, v60, v61
  v_mfma_f32_16x16x32_bf16 v[232:235], a[44:47], v[80:83], v[232:235]
  s_add_u32 m0, s37, 0x12700
  ds_read_b128 a[20:23], v9 offset:38912
  ds_read_b128 a[24:27], v8 offset:43008
  v_mfma_f32_16x16x32_bf16 v[228:231], a[44:47], v[72:75], v[228:231]
  s_waitcnt lgkmcnt(6)
  v_exp_f32 v62, v62
  v_mfma_f32_16x16x32_bf16 v[72:75], a[0:3], a[48:51], v[32:35]
  s_waitcnt lgkmcnt(5)
  buffer_load_dwordx4 v13, s[12:15], s44 offen offset:256 nt lds
  v_mfma_f32_16x16x32_bf16 v[72:75], a[4:7], a[60:63], v[72:75]
  s_waitcnt lgkmcnt(4)
  v_exp_f32 v63, v63
  v_mfma_f32_16x16x32_bf16 v[72:75], a[8:11], a[72:75], v[72:75]
  s_waitcnt lgkmcnt(3)
  v_pk_add_f32 v[254:255], v[254:255], v[62:63]
  v_mfma_f32_16x16x32_bf16 v[72:75], a[12:15], a[84:87], v[72:75]
  s_waitcnt lgkmcnt(2)
  ds_read_b128 a[28:31], v9 offset:43008
  v_cvt_pk_bf16_f32 v59, v62, v63
  v_mfma_f32_16x16x32_bf16 v[72:75], a[16:19], a[96:99], v[72:75]
  s_waitcnt lgkmcnt(2)
  v_exp_f32 v64, v64
  v_mfma_f32_16x16x32_bf16 v[72:75], a[20:23], a[108:111], v[72:75]
  v_exp_f32 v65, v65
  v_mfma_f32_16x16x32_bf16 v[80:83], a[0:3], a[52:55], v[36:39]
  v_pk_add_f32 v[2:3], v[2:3], v[64:65]
  v_mfma_f32_16x16x32_bf16 v[80:83], a[4:7], a[64:67], v[80:83]
  ds_read_b128 a[32:35], v8 offset:44032
  v_cvt_pk_bf16_f32 v64, v64, v65
  v_mfma_f32_16x16x32_bf16 v[80:83], a[8:11], a[76:79], v[80:83]
  v_exp_f32 v66, v66
  v_mfma_f32_16x16x32_bf16 v[80:83], a[12:15], a[88:91], v[80:83]
  s_nop 0
  ds_read_b128 a[36:39], v9 offset:44032
  ds_read_b128 a[40:43], v8 offset:45056
  v_mfma_f32_16x16x32_bf16 v[80:83], a[16:19], a[100:103], v[80:83]
  ds_read_b128 a[44:47], v9 offset:45056
  v_mfma_f32_16x16x32_bf16 v[80:83], a[20:23], a[112:115], v[80:83]
  v_exp_f32 v67, v67
  v_mfma_f32_16x16x32_bf16 v[88:91], a[0:3], a[56:59], v[40:43]
  v_pk_add_f32 v[2:3], v[2:3], v[66:67]
  v_mfma_f32_16x16x32_bf16 v[88:91], a[4:7], a[68:71], v[88:91]
  v_cvt_pk_bf16_f32 v65, v66, v67
  v_mfma_f32_16x16x32_bf16 v[88:91], a[8:11], a[80:83], v[88:91]
  s_mov_b32 s45, 0x1b000
  s_add_u32 m0, s37, 0x24000
  v_mfma_f32_16x16x32_bf16 v[88:91], a[12:15], a[92:95], v[88:91]
  buffer_load_dwordx4 v14, s[16:19], s45 offen nt lds
  v_mfma_f32_16x16x32_bf16 v[88:91], a[16:19], a[104:107], v[88:91]
  v_exp_f32 v68, v68
  v_mfma_f32_16x16x32_bf16 v[88:91], a[20:23], a[116:119], v[88:91]
  s_waitcnt lgkmcnt(5)
  v_exp_f32 v69, v69
  v_mfma_f32_16x16x32_bf16 v[76:79], a[24:27], a[48:51], v[32:35]
  s_waitcnt lgkmcnt(4)
  v_pk_add_f32 v[2:3], v[2:3], v[68:69]
  v_mfma_f32_16x16x32_bf16 v[76:79], a[28:31], a[60:63], v[76:79]
  s_waitcnt lgkmcnt(3)
  v_cvt_pk_bf16_f32 v66, v68, v69
  v_mfma_f32_16x16x32_bf16 v[76:79], a[32:35], a[72:75], v[76:79]
  s_waitcnt lgkmcnt(2)
  v_exp_f32 v70, v70
  v_mfma_f32_16x16x32_bf16 v[76:79], a[36:39], a[84:87], v[76:79]
  s_waitcnt lgkmcnt(1)
  v_add_u32 v4, 0xffffd000, v4
  v_add_u32 v5, 0xffffd000, v5
  v_mfma_f32_16x16x32_bf16 v[76:79], a[40:43], a[96:99], v[76:79]
  s_waitcnt lgkmcnt(0)
  v_add_u32 v6, 0xffffd000, v6
  v_add_u32 v7, 0xffffd000, v7
  v_mfma_f32_16x16x32_bf16 v[76:79], a[44:47], a[108:111], v[76:79]
  s_nop 0
  ds_read_b64_tr_b16 a[0:1], v4 offset:0
  ds_read_b64_tr_b16 a[2:3], v4 offset:6144
  v_mfma_f32_16x16x32_bf16 v[84:87], a[24:27], a[52:55], v[36:39]
  v_exp_f32 v71, v71
  v_mfma_f32_16x16x32_bf16 v[84:87], a[28:31], a[64:67], v[84:87]
  v_exp_f32 v72, v72
  v_mfma_f32_16x16x32_bf16 v[84:87], a[32:35], a[76:79], v[84:87]
  v_exp_f32 v73, v73
  v_mfma_f32_16x16x32_bf16 v[84:87], a[36:39], a[88:91], v[84:87]
  s_add_u32 m0, s37, 0x24380
  v_exp_f32 v74, v74
  v_mfma_f32_16x16x32_bf16 v[84:87], a[40:43], a[100:103], v[84:87]
  buffer_load_dwordx4 v14, s[16:19], s45 offen offset:128 nt lds
  v_mfma_f32_16x16x32_bf16 v[84:87], a[44:47], a[112:115], v[84:87]
  v_exp_f32 v75, v75
  v_mfma_f32_16x16x32_bf16 v[92:95], a[24:27], a[56:59], v[40:43]
  v_exp_f32 v76, v76
  v_mfma_f32_16x16x32_bf16 v[92:95], a[28:31], a[68:71], v[92:95]
  v_exp_f32 v77, v77
  v_mfma_f32_16x16x32_bf16 v[92:95], a[32:35], a[80:83], v[92:95]
  s_nop 0
  ds_read_b64_tr_b16 a[4:5], v5 offset:0
  ds_read_b64_tr_b16 a[6:7], v5 offset:6144
  v_mfma_f32_16x16x32_bf16 v[92:95], a[36:39], a[92:95], v[92:95]
  v_pk_add_f32 v[2:3], v[2:3], v[70:71]
  v_mfma_f32_16x16x32_bf16 v[92:95], a[40:43], a[104:107], v[92:95]
  ds_read_b64_tr_b16 a[8:9], v6 offset:0
  v_cvt_pk_bf16_f32 v67, v70, v71
  v_mfma_f32_16x16x32_bf16 v[92:95], a[44:47], a[116:119], v[92:95]
  s_waitcnt lgkmcnt(3)
  ds_read_b64_tr_b16 a[10:11], v6 offset:6144
  ds_read_b64_tr_b16 a[12:13], v7 offset:0
  v_mfma_f32_16x16x32_bf16 v[96:99], a[0:3], v[48:51], v[96:99]
  v_pk_add_f32 v[252:253], v[252:253], v[72:73]
  v_mfma_f32_16x16x32_bf16 v[100:103], a[0:3], v[56:59], v[100:103]
  ds_read_b64_tr_b16 a[14:15], v7 offset:6144
  v_cvt_pk_bf16_f32 v72, v72, v73
  v_mfma_f32_16x16x32_bf16 v[104:107], a[0:3], v[64:67], v[104:107]
  s_waitcnt lgkmcnt(4)
  v_pk_add_f32 v[252:253], v[252:253], v[74:75]
  v_mfma_f32_16x16x32_bf16 v[116:119], a[4:7], v[64:67], v[116:119]
  ds_read_b64_tr_b16 a[16:17], v4 offset:1024
  v_cvt_pk_bf16_f32 v73, v74, v75
  v_mfma_f32_16x16x32_bf16 v[112:115], a[4:7], v[56:59], v[112:115]
  s_add_u32 m0, s37, 0x24700
  v_pk_add_f32 v[252:253], v[252:253], v[76:77]
  v_mfma_f32_16x16x32_bf16 v[108:111], a[4:7], v[48:51], v[108:111]
  s_waitcnt lgkmcnt(3)
  ds_read_b64_tr_b16 a[18:19], v4 offset:7168
  v_cvt_pk_bf16_f32 v74, v76, v77
  v_mfma_f32_16x16x32_bf16 v[120:123], a[8:11], v[48:51], v[120:123]
  buffer_load_dwordx4 v14, s[16:19], s45 offen offset:256 nt lds
  v_mfma_f32_16x16x32_bf16 v[124:127], a[8:11], v[56:59], v[124:127]
  v_exp_f32 v78, v78
  v_mfma_f32_16x16x32_bf16 v[128:131], a[8:11], v[64:67], v[128:131]
  s_waitcnt lgkmcnt(2)
  ds_read_b64_tr_b16 a[20:21], v5 offset:1024
  ds_read_b64_tr_b16 a[22:23], v5 offset:7168
  v_mfma_f32_16x16x32_bf16 v[140:143], a[12:15], v[64:67], v[140:143]
  v_exp_f32 v79, v79
  v_mfma_f32_16x16x32_bf16 v[136:139], a[12:15], v[56:59], v[136:139]
  v_pk_add_f32 v[252:253], v[252:253], v[78:79]
  v_mfma_f32_16x16x32_bf16 v[132:135], a[12:15], v[48:51], v[132:135]
  s_waitcnt lgkmcnt(2)
  ds_read_b64_tr_b16 a[24:25], v6 offset:1024
  ds_read_b64_tr_b16 a[26:27], v6 offset:7168
  v_mfma_f32_16x16x32_bf16 v[144:147], a[16:19], v[48:51], v[144:147]
  ds_read_b64_tr_b16 a[28:29], v7 offset:1024
  v_cvt_pk_bf16_f32 v75, v78, v79
  v_mfma_f32_16x16x32_bf16 v[148:151], a[16:19], v[56:59], v[148:151]
  v_exp_f32 v80, v80
  v_mfma_f32_16x16x32_bf16 v[152:155], a[16:19], v[64:67], v[152:155]
  s_waitcnt lgkmcnt(3)
  ds_read_b64_tr_b16 a[30:31], v7 offset:7168
  ds_read_b64_tr_b16 a[32:33], v4 offset:2048
  v_mfma_f32_16x16x32_bf16 v[164:167], a[20:23], v[64:67], v[164:167]
  v_exp_f32 v81, v81
  v_mfma_f32_16x16x32_bf16 v[160:163], a[20:23], v[56:59], v[160:163]
  v_pk_add_f32 v[254:255], v[254:255], v[80:81]
  v_mfma_f32_16x16x32_bf16 v[156:159], a[20:23], v[48:51], v[156:159]
  s_waitcnt lgkmcnt(3)
  ds_read_b64_tr_b16 a[34:35], v4 offset:8192
  v_cvt_pk_bf16_f32 v80, v80, v81
  v_mfma_f32_16x16x32_bf16 v[168:171], a[24:27], v[48:51], v[168:171]
  v_exp_f32 v82, v82
  v_mfma_f32_16x16x32_bf16 v[172:175], a[24:27], v[56:59], v[172:175]
  v_exp_f32 v83, v83
  v_mfma_f32_16x16x32_bf16 v[176:179], a[24:27], v[64:67], v[176:179]
  s_waitcnt lgkmcnt(2)
  ds_read_b64_tr_b16 a[36:37], v5 offset:2048
  ds_read_b64_tr_b16 a[38:39], v5 offset:8192
  v_mfma_f32_16x16x32_bf16 v[188:191], a[28:31], v[64:67], v[188:191]
  s_mov_b32 s44, 0x21000
  v_pk_add_f32 v[254:255], v[254:255], v[82:83]
  v_mfma_f32_16x16x32_bf16 v[184:187], a[28:31], v[56:59], v[184:187]
  s_waitcnt vmcnt(14)
  s_barrier
  v_cvt_pk_bf16_f32 v81, v82, v83
  v_mfma_f32_16x16x32_bf16 v[180:183], a[28:31], v[48:51], v[180:183]
  s_waitcnt lgkmcnt(2)
  ds_read_b64_tr_b16 a[40:41], v6 offset:2048
  ds_read_b64_tr_b16 a[42:43], v6 offset:8192
  v_mfma_f32_16x16x32_bf16 v[192:195], a[32:35], v[48:51], v[192:195]
  s_add_u32 m0, s37, 0x6000
  v_exp_f32 v84, v84
  v_mfma_f32_16x16x32_bf16 v[196:199], a[32:35], v[56:59], v[196:199]
  buffer_load_dwordx4 v13, s[12:15], s44 offen nt lds
  v_mfma_f32_16x16x32_bf16 v[200:203], a[32:35], v[64:67], v[200:203]
  s_waitcnt lgkmcnt(2)
  ds_read_b64_tr_b16 a[44:45], v7 offset:2048
  ds_read_b64_tr_b16 a[46:47], v7 offset:8192
  v_mfma_f32_16x16x32_bf16 v[212:215], a[36:39], v[64:67], v[212:215]
  v_exp_f32 v85, v85
  v_mfma_f32_16x16x32_bf16 v[208:211], a[36:39], v[56:59], v[208:211]
  v_add_u32 v8, 0xffffa000, v8
  v_add_u32 v9, 0xffffa000, v9
  v_mfma_f32_16x16x32_bf16 v[204:207], a[36:39], v[48:51], v[204:207]
  s_waitcnt lgkmcnt(2)
  ds_read_b128 a[0:3], v8 offset:0
  ds_read_b128 a[4:7], v9 offset:0
  v_mfma_f32_16x16x32_bf16 v[216:219], a[40:43], v[48:51], v[216:219]
  v_pk_add_f32 v[254:255], v[254:255], v[84:85]
  v_mfma_f32_16x16x32_bf16 v[220:223], a[40:43], v[56:59], v[220:223]
  ds_read_b128 a[8:11], v8 offset:1024
  v_cvt_pk_bf16_f32 v82, v84, v85
  v_mfma_f32_16x16x32_bf16 v[224:227], a[40:43], v[64:67], v[224:227]
  s_waitcnt lgkmcnt(3)
  ds_read_b128 a[12:15], v9 offset:1024
  ds_read_b128 a[16:19], v8 offset:2048
  v_mfma_f32_16x16x32_bf16 v[236:239], a[44:47], v[64:67], v[236:239]
  s_add_u32 m0, s37, 0x6380
  v_exp_f32 v86, v86
  v_mfma_f32_16x16x32_bf16 v[232:235], a[44:47], v[56:59], v[232:235]
  s_nop 0
  ds_read_b128 a[20:23], v9 offset:2048
  ds_read_b128 a[24:27], v8 offset:6144
  v_mfma_f32_16x16x32_bf16 v[228:231], a[44:47], v[48:51], v[228:231]
  s_waitcnt lgkmcnt(6)
  v_exp_f32 v87, v87
  v_mfma_f32_16x16x32_bf16 v[48:51], a[0:3], a[48:51], v[32:35]
  s_waitcnt lgkmcnt(5)
  buffer_load_dwordx4 v13, s[12:15], s44 offen offset:128 nt lds
  v_mfma_f32_16x16x32_bf16 v[48:51], a[4:7], a[60:63], v[48:51]
  s_waitcnt lgkmcnt(4)
  v_pk_add_f32 v[254:255], v[254:255], v[86:87]
  v_mfma_f32_16x16x32_bf16 v[48:51], a[8:11], a[72:75], v[48:51]
  s_waitcnt lgkmcnt(3)
  ds_read_b128 a[28:31], v9 offset:6144
  v_cvt_pk_bf16_f32 v83, v86, v87
  v_mfma_f32_16x16x32_bf16 v[48:51], a[12:15], a[84:87], v[48:51]
  s_waitcnt lgkmcnt(3)
  v_exp_f32 v88, v88
  v_mfma_f32_16x16x32_bf16 v[48:51], a[16:19], a[96:99], v[48:51]
  s_waitcnt lgkmcnt(2)
  v_exp_f32 v89, v89
  v_mfma_f32_16x16x32_bf16 v[48:51], a[20:23], a[108:111], v[48:51]
  v_pk_add_f32 v[2:3], v[2:3], v[88:89]
  v_mfma_f32_16x16x32_bf16 v[56:59], a[0:3], a[52:55], v[36:39]
  ds_read_b128 a[32:35], v8 offset:7168
  v_cvt_pk_bf16_f32 v88, v88, v89
  v_mfma_f32_16x16x32_bf16 v[56:59], a[4:7], a[64:67], v[56:59]
  v_exp_f32 v90, v90
  v_mfma_f32_16x16x32_bf16 v[56:59], a[8:11], a[76:79], v[56:59]
  s_nop 0
  ds_read_b128 a[36:39], v9 offset:7168
  ds_read_b128 a[40:43], v8 offset:8192
  v_mfma_f32_16x16x32_bf16 v[56:59], a[12:15], a[88:91], v[56:59]
  ds_read_b128 a[44:47], v9 offset:8192
  v_mfma_f32_16x16x32_bf16 v[56:59], a[16:19], a[100:103], v[56:59]
  s_add_u32 m0, s37, 0x6700
  v_exp_f32 v91, v91
  v_mfma_f32_16x16x32_bf16 v[56:59], a[20:23], a[112:115], v[56:59]
  buffer_load_dwordx4 v13, s[12:15], s44 offen offset:256 nt lds
  v_mfma_f32_16x16x32_bf16 v[64:67], a[0:3], a[56:59], v[40:43]
  v_pk_add_f32 v[2:3], v[2:3], v[90:91]
  v_mfma_f32_16x16x32_bf16 v[64:67], a[4:7], a[68:71], v[64:67]
  v_cvt_pk_bf16_f32 v89, v90, v91
  v_mfma_f32_16x16x32_bf16 v[64:67], a[8:11], a[80:83], v[64:67]
  v_exp_f32 v92, v92
  v_mfma_f32_16x16x32_bf16 v[64:67], a[12:15], a[92:95], v[64:67]
  v_exp_f32 v93, v93
  v_mfma_f32_16x16x32_bf16 v[64:67], a[16:19], a[104:107], v[64:67]
  v_pk_add_f32 v[2:3], v[2:3], v[92:93]
  v_mfma_f32_16x16x32_bf16 v[64:67], a[20:23], a[116:119], v[64:67]
  s_waitcnt lgkmcnt(5)
  v_cvt_pk_bf16_f32 v90, v92, v93
  v_mfma_f32_16x16x32_bf16 v[52:55], a[24:27], a[48:51], v[32:35]
  s_waitcnt lgkmcnt(4)
  v_exp_f32 v94, v94
  v_mfma_f32_16x16x32_bf16 v[52:55], a[28:31], a[60:63], v[52:55]
  s_waitcnt lgkmcnt(3)
  v_exp_f32 v95, v95
  v_mfma_f32_16x16x32_bf16 v[52:55], a[32:35], a[72:75], v[52:55]
  s_waitcnt lgkmcnt(2)
  v_exp_f32 v48, v48
  v_mfma_f32_16x16x32_bf16 v[52:55], a[36:39], a[84:87], v[52:55]
  s_waitcnt lgkmcnt(1)
  v_exp_f32 v49, v49
  v_mfma_f32_16x16x32_bf16 v[52:55], a[40:43], a[96:99], v[52:55]
  s_waitcnt lgkmcnt(0)
  v_exp_f32 v50, v50
  v_mfma_f32_16x16x32_bf16 v[52:55], a[44:47], a[108:111], v[52:55]
  v_exp_f32 v51, v51
  v_mfma_f32_16x16x32_bf16 v[60:63], a[24:27], a[52:55], v[36:39]
  s_nop 0
  ds_read_b64_tr_b16 a[0:1], v4 offset:24576
  ds_read_b64_tr_b16 a[2:3], v4 offset:30720
  v_mfma_f32_16x16x32_bf16 v[60:63], a[28:31], a[64:67], v[60:63]
  s_mov_b32 s45, 0x1e000
  v_exp_f32 v52, v52
  v_mfma_f32_16x16x32_bf16 v[60:63], a[32:35], a[76:79], v[60:63]
  s_add_u32 m0, s37, 0x15000
  v_exp_f32 v53, v53
  v_mfma_f32_16x16x32_bf16 v[60:63], a[36:39], a[88:91], v[60:63]
  buffer_load_dwordx4 v14, s[16:19], s45 offen nt lds
  v_mfma_f32_16x16x32_bf16 v[60:63], a[40:43], a[100:103], v[60:63]
  s_nop 0
  ds_read_b64_tr_b16 a[4:5], v5 offset:24576
  ds_read_b64_tr_b16 a[6:7], v5 offset:30720
  v_mfma_f32_16x16x32_bf16 v[60:63], a[44:47], a[112:115], v[60:63]
  v_pk_add_f32 v[2:3], v[2:3], v[94:95]
  v_mfma_f32_16x16x32_bf16 v[68:71], a[24:27], a[56:59], v[40:43]
  v_exp_f32 v54, v54
  v_mfma_f32_16x16x32_bf16 v[68:71], a[28:31], a[68:71], v[68:71]
  ds_read_b64_tr_b16 a[8:9], v6 offset:24576
  v_cvt_pk_bf16_f32 v91, v94, v95
  v_mfma_f32_16x16x32_bf16 v[68:71], a[32:35], a[80:83], v[68:71]
  v_pk_add_f32 v[252:253], v[252:253], v[48:49]
  v_mfma_f32_16x16x32_bf16 v[68:71], a[36:39], a[92:95], v[68:71]
  ds_read_b64_tr_b16 a[10:11], v6 offset:30720
  v_cvt_pk_bf16_f32 v48, v48, v49
  v_mfma_f32_16x16x32_bf16 v[68:71], a[40:43], a[104:107], v[68:71]
  v_pk_add_f32 v[252:253], v[252:253], v[50:51]
  v_mfma_f32_16x16x32_bf16 v[68:71], a[44:47], a[116:119], v[68:71]
  s_waitcnt lgkmcnt(4)
  ds_read_b64_tr_b16 a[12:13], v7 offset:24576
  v_cvt_pk_bf16_f32 v49, v50, v51
  v_mfma_f32_16x16x32_bf16 v[96:99], a[0:3], v[72:75], v[96:99]
  v_pk_add_f32 v[252:253], v[252:253], v[52:53]
  v_mfma_f32_16x16x32_bf16 v[100:103], a[0:3], v[80:83], v[100:103]
  ds_read_b64_tr_b16 a[14:15], v7 offset:30720
  v_cvt_pk_bf16_f32 v50, v52, v53
  v_mfma_f32_16x16x32_bf16 v[104:107], a[0:3], v[88:91], v[104:107]
  s_waitcnt lgkmcnt(4)
  v_exp_f32 v55, v55
  v_mfma_f32_16x16x32_bf16 v[116:119], a[4:7], v[88:91], v[116:119]
  s_add_u32 m0, s37, 0x15380
  v_pk_add_f32 v[252:253], v[252:253], v[54:55]
  v_mfma_f32_16x16x32_bf16 v[112:115], a[4:7], v[80:83], v[112:115]
  buffer_load_dwordx4 v14, s[16:19], s45 offen offset:128 nt lds
  v_mfma_f32_16x16x32_bf16 v[108:111], a[4:7], v[72:75], v[108:111]
  s_waitcnt lgkmcnt(2)
  ds_read_b64_tr_b16 a[16:17], v4 offset:25600
  ds_read_b64_tr_b16 a[18:19], v4 offset:31744
  v_mfma_f32_16x16x32_bf16 v[120:123], a[8:11], v[72:75], v[120:123]
  s_add_u32 s47, s68, 0
  s_add_u32 m0, s37, 0x9000
  v_cvt_pk_bf16_f32 v51, v54, v55
  v_mfma_f32_16x16x32_bf16 v[124:127], a[8:11], v[80:83], v[124:127]
  buffer_load_dwordx4 v15, s[20:23], s47 offen lds
  v_mfma_f32_16x16x32_bf16 v[128:131], a[8:11], v[88:91], v[128:131]
  s_waitcnt lgkmcnt(2)
  ds_read_b64_tr_b16 a[20:21], v5 offset:25600
  ds_read_b64_tr_b16 a[22:23], v5 offset:31744
  v_mfma_f32_16x16x32_bf16 v[140:143], a[12:15], v[88:91], v[140:143]
  v_exp_f32 v56, v56
  v_mfma_f32_16x16x32_bf16 v[136:139], a[12:15], v[80:83], v[136:139]
  s_nop 0
  ds_read_b64_tr_b16 a[24:25], v6 offset:25600
  ds_read_b64_tr_b16 a[26:27], v6 offset:31744
  v_mfma_f32_16x16x32_bf16 v[132:135], a[12:15], v[72:75], v[132:135]
  s_waitcnt lgkmcnt(4)
  v_exp_f32 v57, v57
  v_mfma_f32_16x16x32_bf16 v[144:147], a[16:19], v[72:75], v[144:147]
  v_pk_add_f32 v[254:255], v[254:255], v[56:57]
  v_mfma_f32_16x16x32_bf16 v[148:151], a[16:19], v[80:83], v[148:151]
  ds_read_b64_tr_b16 a[28:29], v7 offset:25600
  v_cvt_pk_bf16_f32 v56, v56, v57
  v_mfma_f32_16x16x32_bf16 v[152:155], a[16:19], v[88:91], v[152:155]
  s_waitcnt lgkmcnt(3)
  ds_read_b64_tr_b16 a[30:31], v7 offset:31744
  ds_read_b64_tr_b16 a[32:33], v4 offset:26624
  v_mfma_f32_16x16x32_bf16 v[164:167], a[20:23], v[88:91], v[164:167]
  s_add_u32 m0, s37, 0x15700
  v_exp_f32 v58, v58
  v_mfma_f32_16x16x32_bf16 v[160:163], a[20:23], v[80:83], v[160:163]
  buffer_load_dwordx4 v14, s[16:19], s45 offen offset:256 nt lds
  v_mfma_f32_16x16x32_bf16 v[156:159], a[20:23], v[72:75], v[156:159]
  s_waitcnt lgkmcnt(3)
  ds_read_b64_tr_b16 a[34:35], v4 offset:32768
  ds_read_b64_tr_b16 a[36:37], v5 offset:26624
  v_mfma_f32_16x16x32_bf16 v[168:171], a[24:27], v[72:75], v[168:171]
  v_exp_f32 v59, v59
  v_mfma_f32_16x16x32_bf16 v[172:175], a[24:27], v[80:83], v[172:175]
  s_nop 0
  ds_read_b64_tr_b16 a[38:39], v5 offset:32768
  ds_read_b64_tr_b16 a[40:41], v6 offset:26624
  v_mfma_f32_16x16x32_bf16 v[176:179], a[24:27], v[88:91], v[176:179]
  s_waitcnt lgkmcnt(5)
  v_pk_add_f32 v[254:255], v[254:255], v[58:59]
  v_mfma_f32_16x16x32_bf16 v[188:191], a[28:31], v[88:91], v[188:191]
  s_add_u32 m0, s37, 0x9380
  ds_read_b64_tr_b16 a[42:43], v6 offset:32768
  v_cvt_pk_bf16_f32 v57, v58, v59
  v_mfma_f32_16x16x32_bf16 v[184:187], a[28:31], v[80:83], v[184:187]
  s_waitcnt vmcnt(13)
  s_barrier
  ds_read_b64_tr_b16 a[44:45], v7 offset:26624
  v_mfma_f32_16x16x32_bf16 v[180:183], a[28:31], v[72:75], v[180:183]
  s_waitcnt lgkmcnt(5)
  v_exp_f32 v60, v60
  v_mfma_f32_16x16x32_bf16 v[192:195], a[32:35], v[72:75], v[192:195]
  buffer_load_dwordx4 v15, s[20:23], s47 offen offset:128 lds
  v_mfma_f32_16x16x32_bf16 v[196:199], a[32:35], v[80:83], v[196:199]
  s_nop 0
  ds_read_b64_tr_b16 a[46:47], v7 offset:32768
  ds_read_b128 a[0:3], v8 offset:12288
  v_mfma_f32_16x16x32_bf16 v[200:203], a[32:35], v[88:91], v[200:203]
  s_waitcnt lgkmcnt(5)
  v_exp_f32 v61, v61
  v_mfma_f32_16x16x32_bf16 v[212:215], a[36:39], v[88:91], v[212:215]
  v_pk_add_f32 v[254:255], v[254:255], v[60:61]
  v_mfma_f32_16x16x32_bf16 v[208:211], a[36:39], v[80:83], v[208:211]
  ds_read_b128 a[4:7], v9 offset:12288
  v_cvt_pk_bf16_f32 v58, v60, v61
L_hop6:
  s_cbranch_execz L_hop10
  v_mfma_f32_16x16x32_bf16 v[204:207], a[36:39], v[72:75], v[204:207]
  s_waitcnt lgkmcnt(4)
  ds_read_b128 a[8:11], v8 offset:13312
  ds_read_b128 a[12:15], v9 offset:13312
  v_mfma_f32_16x16x32_bf16 v[216:219], a[40:43], v[72:75], v[216:219]
  v_exp_f32 v62, v62
  v_mfma_f32_16x16x32_bf16 v[220:223], a[40:43], v[80:83], v[220:223]
  s_mov_b32 s44, 0x24000
  s_add_u32 m0, s37, 0xc000
  ds_read_b128 a[16:19], v8 offset:14336
  v_mfma_f32_16x16x32_bf16 v[224:227], a[40:43], v[88:91], v[224:227]
  s_waitcnt lgkmcnt(5)
  ds_read_b128 a[20:23], v9 offset:14336
  v_mfma_f32_16x16x32_bf16 v[236:239], a[44:47], v[88:91], v[236:239]
  buffer_load_dwordx4 v13, s[12:15], s44 offen nt lds
  v_mfma_f32_16x16x32_bf16 v[232:235], a[44:47], v[80:83], v[232:235]
  v_exp_f32 v63, v63
  v_mfma_f32_16x16x32_bf16 v[228:231], a[44:47], v[72:75], v[228:231]
  s_waitcnt lgkmcnt(5)
  v_pk_add_f32 v[254:255], v[254:255], v[62:63]
  v_mfma_f32_16x16x32_bf16 v[72:75], a[0:3], a[48:51], v[32:35]
  s_waitcnt lgkmcnt(4)
  ds_read_b128 a[24:27], v8 offset:18432
  v_cvt_pk_bf16_f32 v59, v62, v63
  v_mfma_f32_16x16x32_bf16 v[72:75], a[4:7], a[60:63], v[72:75]
  s_waitcnt lgkmcnt(4)
  s_add_u32 m0, s37, 0x9700
  v_exp_f32 v64, v64
  v_mfma_f32_16x16x32_bf16 v[72:75], a[8:11], a[72:75], v[72:75]
  s_waitcnt lgkmcnt(3)
  v_exp_f32 v65, v65
  v_mfma_f32_16x16x32_bf16 v[72:75], a[12:15], a[84:87], v[72:75]
  s_waitcnt lgkmcnt(2)
  buffer_load_dwordx4 v16, s[20:23], s47 offen offset:256 lds
  v_mfma_f32_16x16x32_bf16 v[72:75], a[16:19], a[96:99], v[72:75]
  s_waitcnt lgkmcnt(1)
  v_pk_add_f32 v[2:3], v[2:3], v[64:65]
  v_mfma_f32_16x16x32_bf16 v[72:75], a[20:23], a[108:111], v[72:75]
  ds_read_b128 a[28:31], v9 offset:18432
  v_cvt_pk_bf16_f32 v64, v64, v65
  v_mfma_f32_16x16x32_bf16 v[80:83], a[0:3], a[52:55], v[36:39]
  v_exp_f32 v66, v66
  v_mfma_f32_16x16x32_bf16 v[80:83], a[4:7], a[64:67], v[80:83]
  s_nop 0
  ds_read_b128 a[32:35], v8 offset:19456
  ds_read_b128 a[36:39], v9 offset:19456
  v_mfma_f32_16x16x32_bf16 v[80:83], a[8:11], a[76:79], v[80:83]
  s_add_u32 m0, s37, 0xc380
  ds_read_b128 a[40:43], v8 offset:20480
  ds_read_b128 a[44:47], v9 offset:20480
  v_mfma_f32_16x16x32_bf16 v[80:83], a[12:15], a[88:91], v[80:83]
  buffer_load_dwordx4 v13, s[12:15], s44 offen offset:128 nt lds
  v_mfma_f32_16x16x32_bf16 v[80:83], a[16:19], a[100:103], v[80:83]
  v_exp_f32 v67, v67
  v_mfma_f32_16x16x32_bf16 v[80:83], a[20:23], a[112:115], v[80:83]
  v_pk_add_f32 v[2:3], v[2:3], v[66:67]
  v_mfma_f32_16x16x32_bf16 v[88:91], a[0:3], a[56:59], v[40:43]
  v_cvt_pk_bf16_f32 v65, v66, v67
  v_mfma_f32_16x16x32_bf16 v[88:91], a[4:7], a[68:71], v[88:91]
  v_exp_f32 v68, v68
  v_mfma_f32_16x16x32_bf16 v[88:91], a[8:11], a[80:83], v[88:91]
  v_exp_f32 v69, v69
  v_mfma_f32_16x16x32_bf16 v[88:91], a[12:15], a[92:95], v[88:91]
  v_pk_add_f32 v[2:3], v[2:3], v[68:69]
  v_mfma_f32_16x16x32_bf16 v[88:91], a[16:19], a[104:107], v[88:91]
  v_cvt_pk_bf16_f32 v66, v68, v69
  v_mfma_f32_16x16x32_bf16 v[88:91], a[20:23], a[116:119], v[88:91]
  s_waitcnt lgkmcnt(5)
  v_exp_f32 v70, v70
  v_mfma_f32_16x16x32_bf16 v[76:79], a[24:27], a[48:51], v[32:35]
  s_waitcnt lgkmcnt(4)
  v_exp_f32 v71, v71
  v_mfma_f32_16x16x32_bf16 v[76:79], a[28:31], a[60:63], v[76:79]
  s_waitcnt lgkmcnt(3)
  s_add_u32 s46, s68, 0xa000
  v_exp_f32 v72, v72
  v_mfma_f32_16x16x32_bf16 v[76:79], a[32:35], a[72:75], v[76:79]
  s_waitcnt lgkmcnt(2)
  v_exp_f32 v73, v73
  v_mfma_f32_16x16x32_bf16 v[76:79], a[36:39], a[84:87], v[76:79]
  s_waitcnt lgkmcnt(1)
  s_add_u32 m0, s37, 0xf000
  v_exp_f32 v74, v74
  v_mfma_f32_16x16x32_bf16 v[76:79], a[40:43], a[96:99], v[76:79]
  s_waitcnt lgkmcnt(0)
  buffer_load_dwordx4 v15, s[20:23], s46 offen lds
  v_mfma_f32_16x16x32_bf16 v[76:79], a[44:47], a[108:111], v[76:79]
  s_add_u32 m0, s37, 0xc700
  v_exp_f32 v75, v75
  v_mfma_f32_16x16x32_bf16 v[84:87], a[24:27], a[52:55], v[36:39]
  buffer_load_dwordx4 v13, s[12:15], s44 offen offset:256 nt lds
  v_mfma_f32_16x16x32_bf16 v[84:87], a[28:31], a[64:67], v[84:87]
  v_exp_f32 v76, v76
  v_mfma_f32_16x16x32_bf16 v[84:87], a[32:35], a[76:79], v[84:87]
  s_nop 0
  ds_read_b64_tr_b16 a[0:1], v4 offset:36864
  ds_read_b64_tr_b16 a[2:3], v4 offset:43008
  v_mfma_f32_16x16x32_bf16 v[84:87], a[36:39], a[88:91], v[84:87]
  v_exp_f32 v77, v77
  v_mfma_f32_16x16x32_bf16 v[84:87], a[40:43], a[100:103], v[84:87]
  s_nop 0
  ds_read_b64_tr_b16 a[4:5], v5 offset:36864
  ds_read_b64_tr_b16 a[6:7], v5 offset:43008
  v_mfma_f32_16x16x32_bf16 v[84:87], a[44:47], a[112:115], v[84:87]
  v_pk_add_f32 v[2:3], v[2:3], v[70:71]
  v_mfma_f32_16x16x32_bf16 v[92:95], a[24:27], a[56:59], v[40:43]
  v_exp_f32 v78, v78
  v_mfma_f32_16x16x32_bf16 v[92:95], a[28:31], a[68:71], v[92:95]
  ds_read_b64_tr_b16 a[8:9], v6 offset:36864
  v_cvt_pk_bf16_f32 v67, v70, v71
  v_mfma_f32_16x16x32_bf16 v[92:95], a[32:35], a[80:83], v[92:95]
  v_pk_add_f32 v[252:253], v[252:253], v[72:73]
  v_mfma_f32_16x16x32_bf16 v[92:95], a[36:39], a[92:95], v[92:95]
  ds_read_b64_tr_b16 a[10:11], v6 offset:43008
  v_cvt_pk_bf16_f32 v72, v72, v73
  v_mfma_f32_16x16x32_bf16 v[92:95], a[40:43], a[104:107], v[92:95]
  v_pk_add_f32 v[252:253], v[252:253], v[74:75]
  v_mfma_f32_16x16x32_bf16 v[92:95], a[44:47], a[116:119], v[92:95]
  s_waitcnt lgkmcnt(4)
  ds_read_b64_tr_b16 a[12:13], v7 offset:36864
  v_cvt_pk_bf16_f32 v73, v74, v75
  v_mfma_f32_16x16x32_bf16 v[96:99], a[0:3], v[48:51], v[96:99]
  s_add_u32 m0, s37, 0xf380
  v_pk_add_f32 v[252:253], v[252:253], v[76:77]
  v_mfma_f32_16x16x32_bf16 v[100:103], a[0:3], v[56:59], v[100:103]
  buffer_load_dwordx4 v15, s[20:23], s46 offen offset:128 lds
  v_mfma_f32_16x16x32_bf16 v[104:107], a[0:3], v[64:67], v[104:107]
  s_waitcnt lgkmcnt(3)
  ds_read_b64_tr_b16 a[14:15], v7 offset:43008
  v_cvt_pk_bf16_f32 v74, v76, v77
  v_mfma_f32_16x16x32_bf16 v[116:119], a[4:7], v[64:67], v[116:119]
  s_mov_b32 s45, 0x21000
  v_exp_f32 v79, v79
  v_mfma_f32_16x16x32_bf16 v[112:115], a[4:7], v[56:59], v[112:115]
  s_add_u32 m0, s37, 0x1b000
  v_pk_add_f32 v[252:253], v[252:253], v[78:79]
  v_mfma_f32_16x16x32_bf16 v[108:111], a[4:7], v[48:51], v[108:111]
  s_waitcnt lgkmcnt(2)
  ds_read_b64_tr_b16 a[16:17], v4 offset:37888
  ds_read_b64_tr_b16 a[18:19], v4 offset:44032
  v_mfma_f32_16x16x32_bf16 v[120:123], a[8:11], v[48:51], v[120:123]
  buffer_load_dwordx4 v14, s[16:19], s45 offen nt lds
  v_mfma_f32_16x16x32_bf16 v[124:127], a[8:11], v[56:59], v[124:127]
  ds_read_b64_tr_b16 a[20:21], v5 offset:37888
  v_cvt_pk_bf16_f32 v75, v78, v79
  v_mfma_f32_16x16x32_bf16 v[128:131], a[8:11], v[64:67], v[128:131]
  s_waitcnt lgkmcnt(3)
  ds_read_b64_tr_b16 a[22:23], v5 offset:44032
  ds_read_b64_tr_b16 a[24:25], v6 offset:37888
  v_mfma_f32_16x16x32_bf16 v[140:143], a[12:15], v[64:67], v[140:143]
  v_exp_f32 v80, v80
  v_mfma_f32_16x16x32_bf16 v[136:139], a[12:15], v[56:59], v[136:139]
  s_nop 0
  ds_read_b64_tr_b16 a[26:27], v6 offset:44032
  ds_read_b64_tr_b16 a[28:29], v7 offset:37888
  v_mfma_f32_16x16x32_bf16 v[132:135], a[12:15], v[48:51], v[132:135]
  s_waitcnt lgkmcnt(5)
  v_exp_f32 v81, v81
  v_mfma_f32_16x16x32_bf16 v[144:147], a[16:19], v[48:51], v[144:147]
  v_pk_add_f32 v[254:255], v[254:255], v[80:81]
  v_mfma_f32_16x16x32_bf16 v[148:151], a[16:19], v[56:59], v[148:151]
  ds_read_b64_tr_b16 a[30:31], v7 offset:44032
  v_cvt_pk_bf16_f32 v80, v80, v81
  v_mfma_f32_16x16x32_bf16 v[152:155], a[16:19], v[64:67], v[152:155]
  s_waitcnt lgkmcnt(4)
  v_exp_f32 v82, v82
  v_mfma_f32_16x16x32_bf16 v[164:167], a[20:23], v[64:67], v[164:167]
  s_add_u32 m0, s37, 0x1b380
  ds_read_b64_tr_b16 a[32:33], v4 offset:38912
  ds_read_b64_tr_b16 a[34:35], v4 offset:45056
  v_mfma_f32_16x16x32_bf16 v[160:163], a[20:23], v[56:59], v[160:163]
  buffer_load_dwordx4 v14, s[16:19], s45 offen offset:128 nt lds
  v_mfma_f32_16x16x32_bf16 v[156:159], a[20:23], v[48:51], v[156:159]
  s_waitcnt lgkmcnt(4)
  v_exp_f32 v83, v83
  v_mfma_f32_16x16x32_bf16 v[168:171], a[24:27], v[48:51], v[168:171]
  s_add_u32 m0, s37, 0xf700
  ds_read_b64_tr_b16 a[36:37], v5 offset:38912
  ds_read_b64_tr_b16 a[38:39], v5 offset:45056
  v_mfma_f32_16x16x32_bf16 v[172:175], a[24:27], v[56:59], v[172:175]
  buffer_load_dwordx4 v16, s[20:23], s46 offen offset:256 lds
  v_mfma_f32_16x16x32_bf16 v[176:179], a[24:27], v[64:67], v[176:179]
  s_waitcnt lgkmcnt(4)
  v_pk_add_f32 v[254:255], v[254:255], v[82:83]
  v_mfma_f32_16x16x32_bf16 v[188:191], a[28:31], v[64:67], v[188:191]
  ds_read_b64_tr_b16 a[40:41], v6 offset:38912
  v_cvt_pk_bf16_f32 v81, v82, v83
  v_mfma_f32_16x16x32_bf16 v[184:187], a[28:31], v[56:59], v[184:187]
  s_waitcnt vmcnt(17)
  s_barrier
  ds_read_b64_tr_b16 a[42:43], v6 offset:45056
  v_mfma_f32_16x16x32_bf16 v[180:183], a[28:31], v[48:51], v[180:183]
  s_waitcnt lgkmcnt(4)
  v_exp_f32 v84, v84
  v_mfma_f32_16x16x32_bf16 v[192:195], a[32:35], v[48:51], v[192:195]
  s_nop 0
  ds_read_b64_tr_b16 a[44:45], v7 offset:38912
  ds_read_b64_tr_b16 a[46:47], v7 offset:45056
  v_mfma_f32_16x16x32_bf16 v[196:199], a[32:35], v[56:59], v[196:199]
  v_exp_f32 v85, v85
  v_mfma_f32_16x16x32_bf16 v[200:203], a[32:35], v[64:67], v[200:203]
  s_waitcnt lgkmcnt(4)
  v_pk_add_f32 v[254:255], v[254:255], v[84:85]
  v_mfma_f32_16x16x32_bf16 v[212:215], a[36:39], v[64:67], v[212:215]
  s_add_u32 m0, s37, 0x1b700
  v_cvt_pk_bf16_f32 v82, v84, v85
  v_add_u32 v8, 0x12000, v8
  v_mfma_f32_16x16x32_bf16 v[208:211], a[36:39], v[56:59], v[208:211]
  v_add_u32 v9, 0x12000, v9
  v_mfma_f32_16x16x32_bf16 v[204:207], a[36:39], v[48:51], v[204:207]
  s_waitcnt lgkmcnt(2)
  ds_read_b128 a[0:3], v8 offset:0
  ds_read_b128 a[4:7], v9 offset:0
  v_mfma_f32_16x16x32_bf16 v[216:219], a[40:43], v[48:51], v[216:219]
  buffer_load_dwordx4 v14, s[16:19], s45 offen offset:256 nt lds
  v_mfma_f32_16x16x32_bf16 v[220:223], a[40:43], v[56:59], v[220:223]
  s_nop 0
  ds_read_b128 a[8:11], v8 offset:1024
  ds_read_b128 a[12:15], v9 offset:1024
  v_mfma_f32_16x16x32_bf16 v[224:227], a[40:43], v[64:67], v[224:227]
  s_waitcnt lgkmcnt(4)
  v_exp_f32 v86, v86
  v_mfma_f32_16x16x32_bf16 v[236:239], a[44:47], v[64:67], v[236:239]
  s_nop 0
  ds_read_b128 a[16:19], v8 offset:2048
  ds_read_b128 a[20:23], v9 offset:2048
  v_mfma_f32_16x16x32_bf16 v[232:235], a[44:47], v[56:59], v[232:235]
  v_exp_f32 v87, v87
  v_mfma_f32_16x16x32_bf16 v[228:231], a[44:47], v[48:51], v[228:231]
  s_waitcnt lgkmcnt(5)
  v_pk_add_f32 v[254:255], v[254:255], v[86:87]
  v_mfma_f32_16x16x32_bf16 v[48:51], a[0:3], a[48:51], v[32:35]
  s_waitcnt lgkmcnt(4)
  s_add_u32 s47, s68, 0x14000
  s_add_u32 m0, s37, 0
  v_cvt_pk_bf16_f32 v83, v86, v87
  v_mfma_f32_16x16x32_bf16 v[48:51], a[4:7], a[60:63], v[48:51]
  s_waitcnt lgkmcnt(3)
  buffer_load_dwordx4 v15, s[20:23], s47 offen lds
  v_mfma_f32_16x16x32_bf16 v[48:51], a[8:11], a[72:75], v[48:51]
  s_waitcnt lgkmcnt(2)
  v_exp_f32 v88, v88
  v_mfma_f32_16x16x32_bf16 v[48:51], a[12:15], a[84:87], v[48:51]
  s_waitcnt lgkmcnt(1)
  v_exp_f32 v89, v89
  v_mfma_f32_16x16x32_bf16 v[48:51], a[16:19], a[96:99], v[48:51]
  s_waitcnt lgkmcnt(0)
  v_pk_add_f32 v[2:3], v[2:3], v[88:89]
  v_mfma_f32_16x16x32_bf16 v[48:51], a[20:23], a[108:111], v[48:51]
  ds_read_b128 a[24:27], v8 offset:6144
  v_cvt_pk_bf16_f32 v88, v88, v89
  v_mfma_f32_16x16x32_bf16 v[56:59], a[0:3], a[52:55], v[36:39]
  s_nop 0
  ds_read_b128 a[28:31], v9 offset:6144
  ds_read_b128 a[32:35], v8 offset:7168
  v_mfma_f32_16x16x32_bf16 v[56:59], a[4:7], a[64:67], v[56:59]
  s_mov_b32 s44, 0x27000
  s_add_u32 m0, s37, 0x18000
  ds_read_b128 a[36:39], v9 offset:7168
  v_mfma_f32_16x16x32_bf16 v[56:59], a[8:11], a[76:79], v[56:59]
  buffer_load_dwordx4 v13, s[12:15], s44 offen nt lds
  v_mfma_f32_16x16x32_bf16 v[56:59], a[12:15], a[88:91], v[56:59]
  v_exp_f32 v90, v90
  v_mfma_f32_16x16x32_bf16 v[56:59], a[16:19], a[100:103], v[56:59]
  s_nop 0
  ds_read_b128 a[40:43], v8 offset:8192
  ds_read_b128 a[44:47], v9 offset:8192
  v_mfma_f32_16x16x32_bf16 v[56:59], a[20:23], a[112:115], v[56:59]
  v_exp_f32 v91, v91
  v_mfma_f32_16x16x32_bf16 v[64:67], a[0:3], a[56:59], v[40:43]
  v_pk_add_f32 v[2:3], v[2:3], v[90:91]
  v_mfma_f32_16x16x32_bf16 v[64:67], a[4:7], a[68:71], v[64:67]
  v_cvt_pk_bf16_f32 v89, v90, v91
  v_mfma_f32_16x16x32_bf16 v[64:67], a[8:11], a[80:83], v[64:67]
  v_exp_f32 v92, v92
  v_mfma_f32_16x16x32_bf16 v[64:67], a[12:15], a[92:95], v[64:67]
  v_exp_f32 v93, v93
  v_mfma_f32_16x16x32_bf16 v[64:67], a[16:19], a[104:107], v[64:67]
  v_pk_add_f32 v[2:3], v[2:3], v[92:93]
  v_mfma_f32_16x16x32_bf16 v[64:67], a[20:23], a[116:119], v[64:67]
  s_waitcnt lgkmcnt(5)
  s_add_u32 m0, s37, 0x380
  v_cvt_pk_bf16_f32 v90, v92, v93
  v_mfma_f32_16x16x32_bf16 v[52:55], a[24:27], a[48:51], v[32:35]
  s_waitcnt lgkmcnt(4)
  buffer_load_dwordx4 v15, s[20:23], s47 offen offset:128 lds
  v_mfma_f32_16x16x32_bf16 v[52:55], a[28:31], a[60:63], v[52:55]
  s_waitcnt lgkmcnt(3)
  v_exp_f32 v94, v94
  v_mfma_f32_16x16x32_bf16 v[52:55], a[32:35], a[72:75], v[52:55]
  s_waitcnt lgkmcnt(2)
  s_add_u32 m0, s37, 0x18380
  v_mfma_f32_16x16x32_bf16 v[52:55], a[36:39], a[84:87], v[52:55]
  s_waitcnt lgkmcnt(1)
  buffer_load_dwordx4 v13, s[12:15], s44 offen offset:128 nt lds
  v_mfma_f32_16x16x32_bf16 v[52:55], a[40:43], a[96:99], v[52:55]
  s_waitcnt lgkmcnt(0)
  v_exp_f32 v95, v95
  v_mfma_f32_16x16x32_bf16 v[52:55], a[44:47], a[108:111], v[52:55]
  v_exp_f32 v48, v48
  v_mfma_f32_16x16x32_bf16 v[60:63], a[24:27], a[52:55], v[36:39]
  v_exp_f32 v49, v49
  v_mfma_f32_16x16x32_bf16 v[60:63], a[28:31], a[64:67], v[60:63]
  v_exp_f32 v50, v50
  v_mfma_f32_16x16x32_bf16 v[60:63], a[32:35], a[76:79], v[60:63]
  v_exp_f32 v51, v51
  v_mfma_f32_16x16x32_bf16 v[60:63], a[36:39], a[88:91], v[60:63]
  v_exp_f32 v52, v52
  v_mfma_f32_16x16x32_bf16 v[60:63], a[40:43], a[100:103], v[60:63]
  s_nop 0
  ds_read_b64_tr_b16 a[0:1], v4 offset:49152
  ds_read_b64_tr_b16 a[2:3], v4 offset:55296
  v_mfma_f32_16x16x32_bf16 v[60:63], a[44:47], a[112:115], v[60:63]
  v_exp_f32 v53, v53
  v_mfma_f32_16x16x32_bf16 v[68:71], a[24:27], a[56:59], v[40:43]
  s_nop 0
  ds_read_b64_tr_b16 a[4:5], v5 offset:49152
  ds_read_b64_tr_b16 a[6:7], v5 offset:55296
  v_mfma_f32_16x16x32_bf16 v[68:71], a[28:31], a[68:71], v[68:71]
  v_pk_add_f32 v[2:3], v[2:3], v[94:95]
  v_mfma_f32_16x16x32_bf16 v[68:71], a[32:35], a[80:83], v[68:71]
  v_exp_f32 v54, v54
  v_mfma_f32_16x16x32_bf16 v[68:71], a[36:39], a[92:95], v[68:71]
  s_add_u32 m0, s37, 0x18700
  ds_read_b64_tr_b16 a[8:9], v6 offset:49152
  v_cvt_pk_bf16_f32 v91, v94, v95
  v_mfma_f32_16x16x32_bf16 v[68:71], a[40:43], a[104:107], v[68:71]
  buffer_load_dwordx4 v13, s[12:15], s44 offen offset:256 nt lds
  v_mfma_f32_16x16x32_bf16 v[68:71], a[44:47], a[116:119], v[68:71]
  s_waitcnt lgkmcnt(3)
  s_add_u32 m0, s37, 0x700
  ds_read_b64_tr_b16 a[10:11], v6 offset:55296
  v_mfma_f32_16x16x32_bf16 v[96:99], a[0:3], v[72:75], v[96:99]
  buffer_load_dwordx4 v16, s[20:23], s47 offen offset:256 lds
  v_mfma_f32_16x16x32_bf16 v[100:103], a[0:3], v[80:83], v[100:103]
  v_pk_add_f32 v[252:253], v[252:253], v[48:49]
  v_mfma_f32_16x16x32_bf16 v[104:107], a[0:3], v[88:91], v[104:107]
  s_waitcnt lgkmcnt(2)
  ds_read_b64_tr_b16 a[12:13], v7 offset:49152
  ds_read_b64_tr_b16 a[14:15], v7 offset:55296
  v_mfma_f32_16x16x32_bf16 v[116:119], a[4:7], v[88:91], v[116:119]
  ds_read_b64_tr_b16 a[16:17], v4 offset:50176
  v_cvt_pk_bf16_f32 v48, v48, v49
  v_mfma_f32_16x16x32_bf16 v[112:115], a[4:7], v[80:83], v[112:115]
  v_pk_add_f32 v[252:253], v[252:253], v[50:51]
  v_mfma_f32_16x16x32_bf16 v[108:111], a[4:7], v[72:75], v[108:111]
  s_waitcnt lgkmcnt(3)
  ds_read_b64_tr_b16 a[18:19], v4 offset:56320
  v_cvt_pk_bf16_f32 v49, v50, v51
  v_mfma_f32_16x16x32_bf16 v[120:123], a[8:11], v[72:75], v[120:123]
  v_pk_add_f32 v[252:253], v[252:253], v[52:53]
  v_mfma_f32_16x16x32_bf16 v[124:127], a[8:11], v[80:83], v[124:127]
  ds_read_b64_tr_b16 a[20:21], v5 offset:50176
  v_cvt_pk_bf16_f32 v50, v52, v53
  v_mfma_f32_16x16x32_bf16 v[128:131], a[8:11], v[88:91], v[128:131]
  s_waitcnt lgkmcnt(3)
  ds_read_b64_tr_b16 a[22:23], v5 offset:56320
  ds_read_b64_tr_b16 a[24:25], v6 offset:50176
  v_mfma_f32_16x16x32_bf16 v[140:143], a[12:15], v[88:91], v[140:143]
  v_exp_f32 v55, v55
  v_mfma_f32_16x16x32_bf16 v[136:139], a[12:15], v[80:83], v[136:139]
  v_pk_add_f32 v[252:253], v[252:253], v[54:55]
  v_mfma_f32_16x16x32_bf16 v[132:135], a[12:15], v[72:75], v[132:135]
  s_waitcnt lgkmcnt(3)
  ds_read_b64_tr_b16 a[26:27], v6 offset:56320
  v_cvt_pk_bf16_f32 v51, v54, v55
  v_mfma_f32_16x16x32_bf16 v[144:147], a[16:19], v[72:75], v[144:147]
  s_mov_b32 s45, 0x24000
  v_exp_f32 v56, v56
  v_mfma_f32_16x16x32_bf16 v[148:151], a[16:19], v[80:83], v[148:151]
  s_add_u32 m0, s37, 0x3000
  v_exp_f32 v57, v57
  v_mfma_f32_16x16x32_bf16 v[152:155], a[16:19], v[88:91], v[152:155]
  s_waitcnt lgkmcnt(2)
  ds_read_b64_tr_b16 a[28:29], v7 offset:50176
  ds_read_b64_tr_b16 a[30:31], v7 offset:56320
  v_mfma_f32_16x16x32_bf16 v[164:167], a[20:23], v[88:91], v[164:167]
  buffer_load_dwordx4 v14, s[16:19], s45 offen nt lds
  v_mfma_f32_16x16x32_bf16 v[160:163], a[20:23], v[80:83], v[160:163]
  s_add_u32 s46, s68, 0x1e000
  v_pk_add_f32 v[254:255], v[254:255], v[56:57]
  v_mfma_f32_16x16x32_bf16 v[156:159], a[20:23], v[72:75], v[156:159]
  s_waitcnt lgkmcnt(2)
  ds_read_b64_tr_b16 a[32:33], v4 offset:51200
  ds_read_b64_tr_b16 a[34:35], v4 offset:57344
  v_mfma_f32_16x16x32_bf16 v[168:171], a[24:27], v[72:75], v[168:171]
  s_add_u32 m0, s37, 0x1e000
  ds_read_b64_tr_b16 a[36:37], v5 offset:51200
  v_cvt_pk_bf16_f32 v56, v56, v57
  v_mfma_f32_16x16x32_bf16 v[172:175], a[24:27], v[80:83], v[172:175]
  buffer_load_dwordx4 v15, s[20:23], s46 offen lds
  v_mfma_f32_16x16x32_bf16 v[176:179], a[24:27], v[88:91], v[176:179]
  s_waitcnt lgkmcnt(3)
  ds_read_b64_tr_b16 a[38:39], v5 offset:57344
  ds_read_b64_tr_b16 a[40:41], v6 offset:51200
  v_mfma_f32_16x16x32_bf16 v[188:191], a[28:31], v[88:91], v[188:191]
  v_exp_f32 v58, v58
  v_mfma_f32_16x16x32_bf16 v[184:187], a[28:31], v[80:83], v[184:187]
  s_waitcnt vmcnt(19)
  s_barrier
  ds_read_b64_tr_b16 a[42:43], v6 offset:57344
  v_mfma_f32_16x16x32_bf16 v[180:183], a[28:31], v[72:75], v[180:183]
  s_waitcnt lgkmcnt(4)
  v_exp_f32 v59, v59
  v_mfma_f32_16x16x32_bf16 v[192:195], a[32:35], v[72:75], v[192:195]
  v_pk_add_f32 v[254:255], v[254:255], v[58:59]
  v_mfma_f32_16x16x32_bf16 v[196:199], a[32:35], v[80:83], v[196:199]
  s_add_u32 m0, s37, 0x3380
  ds_read_b64_tr_b16 a[44:45], v7 offset:51200
  v_cvt_pk_bf16_f32 v57, v58, v59
  v_mfma_f32_16x16x32_bf16 v[200:203], a[32:35], v[88:91], v[200:203]
  s_waitcnt lgkmcnt(3)
  ds_read_b64_tr_b16 a[46:47], v7 offset:57344
  v_add_u32 v8, 0xffff4000, v8
  v_mfma_f32_16x16x32_bf16 v[212:215], a[36:39], v[88:91], v[212:215]
  buffer_load_dwordx4 v14, s[16:19], s45 offen offset:128 nt lds
  v_mfma_f32_16x16x32_bf16 v[208:211], a[36:39], v[80:83], v[208:211]
  v_add_u32 v9, 0xffff4000, v9
  v_mfma_f32_16x16x32_bf16 v[204:207], a[36:39], v[72:75], v[204:207]
  s_waitcnt lgkmcnt(2)
  ds_read_b128 a[0:3], v8 offset:0
  ds_read_b128 a[4:7], v9 offset:0
  v_mfma_f32_16x16x32_bf16 v[216:219], a[40:43], v[72:75], v[216:219]
  v_exp_f32 v60, v60
  v_mfma_f32_16x16x32_bf16 v[220:223], a[40:43], v[80:83], v[220:223]
  s_nop 0
  ds_read_b128 a[8:11], v8 offset:1024
  ds_read_b128 a[12:15], v9 offset:1024
  v_mfma_f32_16x16x32_bf16 v[224:227], a[40:43], v[88:91], v[224:227]
  s_waitcnt lgkmcnt(4)
  v_exp_f32 v61, v61
  v_mfma_f32_16x16x32_bf16 v[236:239], a[44:47], v[88:91], v[236:239]
  s_add_u32 m0, s37, 0x1e380
  ds_read_b128 a[16:19], v8 offset:2048
  ds_read_b128 a[20:23], v9 offset:2048
  v_mfma_f32_16x16x32_bf16 v[232:235], a[44:47], v[80:83], v[232:235]
  buffer_load_dwordx4 v15, s[20:23], s46 offen offset:128 lds
  v_mfma_f32_16x16x32_bf16 v[228:231], a[44:47], v[72:75], v[228:231]
  s_waitcnt lgkmcnt(5)
  v_pk_add_f32 v[254:255], v[254:255], v[60:61]
  v_mfma_f32_16x16x32_bf16 v[72:75], a[0:3], a[48:51], v[32:35]
  s_waitcnt lgkmcnt(4)
  ds_read_b128 a[24:27], v8 offset:6144
  v_cvt_pk_bf16_f32 v58, v60, v61
  v_mfma_f32_16x16x32_bf16 v[72:75], a[4:7], a[60:63], v[72:75]
  s_waitcnt lgkmcnt(4)
  v_exp_f32 v62, v62
  v_mfma_f32_16x16x32_bf16 v[72:75], a[8:11], a[72:75], v[72:75]
  s_waitcnt lgkmcnt(3)
  v_exp_f32 v63, v63
  v_mfma_f32_16x16x32_bf16 v[72:75], a[12:15], a[84:87], v[72:75]
  s_waitcnt lgkmcnt(2)
  s_add_u32 m0, s37, 0x3700
  v_pk_add_f32 v[254:255], v[254:255], v[62:63]
  v_mfma_f32_16x16x32_bf16 v[72:75], a[16:19], a[96:99], v[72:75]
  s_waitcnt lgkmcnt(1)
  buffer_load_dwordx4 v14, s[16:19], s45 offen offset:256 nt lds
  v_mfma_f32_16x16x32_bf16 v[72:75], a[20:23], a[108:111], v[72:75]
  ds_read_b128 a[28:31], v9 offset:6144
  v_cvt_pk_bf16_f32 v59, v62, v63
  v_mfma_f32_16x16x32_bf16 v[80:83], a[0:3], a[52:55], v[36:39]
  v_exp_f32 v64, v64
  v_mfma_f32_16x16x32_bf16 v[80:83], a[4:7], a[64:67], v[80:83]
  v_exp_f32 v65, v65
  v_mfma_f32_16x16x32_bf16 v[80:83], a[8:11], a[76:79], v[80:83]
  v_pk_add_f32 v[2:3], v[2:3], v[64:65]
  v_mfma_f32_16x16x32_bf16 v[80:83], a[12:15], a[88:91], v[80:83]
  ds_read_b128 a[32:35], v8 offset:7168
  v_cvt_pk_bf16_f32 v64, v64, v65
  v_mfma_f32_16x16x32_bf16 v[80:83], a[16:19], a[100:103], v[80:83]
  v_exp_f32 v66, v66
  v_mfma_f32_16x16x32_bf16 v[80:83], a[20:23], a[112:115], v[80:83]
  s_nop 0
  ds_read_b128 a[36:39], v9 offset:7168
  ds_read_b128 a[40:43], v8 offset:8192
  v_mfma_f32_16x16x32_bf16 v[88:91], a[0:3], a[56:59], v[40:43]
  ds_read_b128 a[44:47], v9 offset:8192
  v_mfma_f32_16x16x32_bf16 v[88:91], a[4:7], a[68:71], v[88:91]
  v_exp_f32 v67, v67
  v_mfma_f32_16x16x32_bf16 v[88:91], a[8:11], a[80:83], v[88:91]
  s_add_u32 m0, s37, 0x1e700
  v_pk_add_f32 v[2:3], v[2:3], v[66:67]
  v_mfma_f32_16x16x32_bf16 v[88:91], a[12:15], a[92:95], v[88:91]
  buffer_load_dwordx4 v16, s[20:23], s46 offen offset:256 lds
  v_mfma_f32_16x16x32_bf16 v[88:91], a[16:19], a[104:107], v[88:91]
  v_cvt_pk_bf16_f32 v65, v66, v67
  v_mfma_f32_16x16x32_bf16 v[88:91], a[20:23], a[116:119], v[88:91]
  s_waitcnt lgkmcnt(5)
  v_exp_f32 v68, v68
  v_mfma_f32_16x16x32_bf16 v[76:79], a[24:27], a[48:51], v[32:35]
  s_waitcnt lgkmcnt(4)
  s_mov_b32 s44, 0x2a000
  s_add_u32 m0, s37, 0x12000
  v_mfma_f32_16x16x32_bf16 v[76:79], a[28:31], a[60:63], v[76:79]
  s_waitcnt lgkmcnt(3)
  buffer_load_dwordx4 v13, s[12:15], s44 offen nt lds
  v_mfma_f32_16x16x32_bf16 v[76:79], a[32:35], a[72:75], v[76:79]
  s_waitcnt lgkmcnt(2)
  v_exp_f32 v69, v69
  v_mfma_f32_16x16x32_bf16 v[76:79], a[36:39], a[84:87], v[76:79]
  s_waitcnt lgkmcnt(1)
  v_pk_add_f32 v[2:3], v[2:3], v[68:69]
  v_mfma_f32_16x16x32_bf16 v[76:79], a[40:43], a[96:99], v[76:79]
  s_waitcnt lgkmcnt(0)
  v_cvt_pk_bf16_f32 v66, v68, v69
  v_add_u32 v4, 0xffffd000, v4
  v_mfma_f32_16x16x32_bf16 v[76:79], a[44:47], a[108:111], v[76:79]
  v_exp_f32 v70, v70
  v_mfma_f32_16x16x32_bf16 v[84:87], a[24:27], a[52:55], v[36:39]
  v_add_u32 v5, 0xffffd000, v5
  v_add_u32 v6, 0xffffd000, v6
  v_mfma_f32_16x16x32_bf16 v[84:87], a[28:31], a[64:67], v[84:87]
  v_add_u32 v7, 0xffffd000, v7
  v_mfma_f32_16x16x32_bf16 v[84:87], a[32:35], a[76:79], v[84:87]
  s_nop 0
  ds_read_b64_tr_b16 a[0:1], v4 offset:0
  ds_read_b64_tr_b16 a[2:3], v4 offset:6144
  v_mfma_f32_16x16x32_bf16 v[84:87], a[36:39], a[88:91], v[84:87]
  s_nop 0
  ds_read_b64_tr_b16 a[4:5], v5 offset:0
  ds_read_b64_tr_b16 a[6:7], v5 offset:6144
  v_mfma_f32_16x16x32_bf16 v[84:87], a[40:43], a[100:103], v[84:87]
  v_exp_f32 v71, v71
  v_mfma_f32_16x16x32_bf16 v[84:87], a[44:47], a[112:115], v[84:87]
  v_exp_f32 v72, v72
  v_mfma_f32_16x16x32_bf16 v[92:95], a[24:27], a[56:59], v[40:43]
  v_exp_f32 v73, v73
  v_mfma_f32_16x16x32_bf16 v[92:95], a[28:31], a[68:71], v[92:95]
  s_add_u32 m0, s37, 0x12380
  v_exp_f32 v74, v74
  v_mfma_f32_16x16x32_bf16 v[92:95], a[32:35], a[80:83], v[92:95]
  buffer_load_dwordx4 v13, s[12:15], s44 offen offset:128 nt lds
  v_mfma_f32_16x16x32_bf16 v[92:95], a[36:39], a[92:95], v[92:95]
  s_add_u32 s47, s68, 0x28000
  v_exp_f32 v75, v75
  v_mfma_f32_16x16x32_bf16 v[92:95], a[40:43], a[104:107], v[92:95]
  v_pk_add_f32 v[2:3], v[2:3], v[70:71]
  v_cvt_pk_bf16_f32 v67, v70, v71
  v_mfma_f32_16x16x32_bf16 v[92:95], a[44:47], a[116:119], v[92:95]
  s_waitcnt lgkmcnt(2)
  ds_read_b64_tr_b16 a[8:9], v6 offset:0
  ds_read_b64_tr_b16 a[10:11], v6 offset:6144
  v_mfma_f32_16x16x32_bf16 v[96:99], a[0:3], v[48:51], v[96:99]
  s_add_u32 m0, s37, 0x21000
  v_pk_add_f32 v[252:253], v[252:253], v[72:73]
  v_mfma_f32_16x16x32_bf16 v[100:103], a[0:3], v[56:59], v[100:103]
  buffer_load_dwordx4 v15, s[20:23], s47 offen lds
  v_mfma_f32_16x16x32_bf16 v[104:107], a[0:3], v[64:67], v[104:107]
  s_waitcnt lgkmcnt(2)
  ds_read_b64_tr_b16 a[12:13], v7 offset:0
  ds_read_b64_tr_b16 a[14:15], v7 offset:6144
  v_mfma_f32_16x16x32_bf16 v[116:119], a[4:7], v[64:67], v[116:119]
  ds_read_b64_tr_b16 a[16:17], v4 offset:1024
  v_cvt_pk_bf16_f32 v72, v72, v73
  v_mfma_f32_16x16x32_bf16 v[112:115], a[4:7], v[56:59], v[112:115]
  v_pk_add_f32 v[252:253], v[252:253], v[74:75]
  v_mfma_f32_16x16x32_bf16 v[108:111], a[4:7], v[48:51], v[108:111]
  s_waitcnt lgkmcnt(3)
  ds_read_b64_tr_b16 a[18:19], v4 offset:7168
  v_cvt_pk_bf16_f32 v73, v74, v75
  v_mfma_f32_16x16x32_bf16 v[120:123], a[8:11], v[48:51], v[120:123]
  v_exp_f32 v76, v76
  v_mfma_f32_16x16x32_bf16 v[124:127], a[8:11], v[56:59], v[124:127]
  v_exp_f32 v77, v77
  v_mfma_f32_16x16x32_bf16 v[128:131], a[8:11], v[64:67], v[128:131]
  s_waitcnt lgkmcnt(2)
  ds_read_b64_tr_b16 a[20:21], v5 offset:1024
  ds_read_b64_tr_b16 a[22:23], v5 offset:7168
  v_mfma_f32_16x16x32_bf16 v[140:143], a[12:15], v[64:67], v[140:143]
  s_add_u32 m0, s37, 0x12700
  v_pk_add_f32 v[252:253], v[252:253], v[76:77]
  v_mfma_f32_16x16x32_bf16 v[136:139], a[12:15], v[56:59], v[136:139]
  buffer_load_dwordx4 v13, s[12:15], s44 offen offset:256 nt lds
  v_mfma_f32_16x16x32_bf16 v[132:135], a[12:15], v[48:51], v[132:135]
  s_waitcnt lgkmcnt(2)
  ds_read_b64_tr_b16 a[24:25], v6 offset:1024
  ds_read_b64_tr_b16 a[26:27], v6 offset:7168
  v_mfma_f32_16x16x32_bf16 v[144:147], a[16:19], v[48:51], v[144:147]
  ds_read_b64_tr_b16 a[28:29], v7 offset:1024
  v_cvt_pk_bf16_f32 v74, v76, v77
  v_mfma_f32_16x16x32_bf16 v[148:151], a[16:19], v[56:59], v[148:151]
  v_exp_f32 v78, v78
  v_mfma_f32_16x16x32_bf16 v[152:155], a[16:19], v[64:67], v[152:155]
  s_waitcnt lgkmcnt(3)
  s_add_u32 m0, s37, 0x21380
  ds_read_b64_tr_b16 a[30:31], v7 offset:7168
  v_mfma_f32_16x16x32_bf16 v[164:167], a[20:23], v[64:67], v[164:167]
  buffer_load_dwordx4 v15, s[20:23], s47 offen offset:128 lds
L_hop7:
  s_cbranch_execz L_hop11
  v_mfma_f32_16x16x32_bf16 v[160:163], a[20:23], v[56:59], v[160:163]
  v_exp_f32 v79, v79
  v_mfma_f32_16x16x32_bf16 v[156:159], a[20:23], v[48:51], v[156:159]
  s_waitcnt lgkmcnt(2)
  ds_read_b64_tr_b16 a[32:33], v4 offset:2048
  ds_read_b64_tr_b16 a[34:35], v4 offset:8192
  v_mfma_f32_16x16x32_bf16 v[168:171], a[24:27], v[48:51], v[168:171]
  v_pk_add_f32 v[252:253], v[252:253], v[78:79]
  v_mfma_f32_16x16x32_bf16 v[172:175], a[24:27], v[56:59], v[172:175]
  ds_read_b64_tr_b16 a[36:37], v5 offset:2048
  v_cvt_pk_bf16_f32 v75, v78, v79
  v_mfma_f32_16x16x32_bf16 v[176:179], a[24:27], v[64:67], v[176:179]
  s_waitcnt lgkmcnt(3)
  ds_read_b64_tr_b16 a[38:39], v5 offset:8192
  ds_read_b64_tr_b16 a[40:41], v6 offset:2048
  v_mfma_f32_16x16x32_bf16 v[188:191], a[28:31], v[64:67], v[188:191]
  v_exp_f32 v80, v80
  v_mfma_f32_16x16x32_bf16 v[184:187], a[28:31], v[56:59], v[184:187]
  s_waitcnt vmcnt(17)
  s_barrier
  ds_read_b64_tr_b16 a[42:43], v6 offset:8192
  v_mfma_f32_16x16x32_bf16 v[180:183], a[28:31], v[48:51], v[180:183]
  s_waitcnt lgkmcnt(4)
  v_exp_f32 v81, v81
  v_mfma_f32_16x16x32_bf16 v[192:195], a[32:35], v[48:51], v[192:195]
  s_mov_b32 s45, 0x27000
  v_pk_add_f32 v[254:255], v[254:255], v[80:81]
  v_mfma_f32_16x16x32_bf16 v[196:199], a[32:35], v[56:59], v[196:199]
  s_add_u32 m0, s37, 0x6000
  ds_read_b64_tr_b16 a[44:45], v7 offset:2048
  v_cvt_pk_bf16_f32 v80, v80, v81
  v_mfma_f32_16x16x32_bf16 v[200:203], a[32:35], v[64:67], v[200:203]
  s_waitcnt lgkmcnt(3)
  ds_read_b64_tr_b16 a[46:47], v7 offset:8192
  ds_read_b128 a[0:3], v8 offset:24576
  v_mfma_f32_16x16x32_bf16 v[212:215], a[36:39], v[64:67], v[212:215]
  buffer_load_dwordx4 v14, s[16:19], s45 offen nt lds
  v_mfma_f32_16x16x32_bf16 v[208:211], a[36:39], v[56:59], v[208:211]
  v_exp_f32 v82, v82
  v_mfma_f32_16x16x32_bf16 v[204:207], a[36:39], v[48:51], v[204:207]
  s_waitcnt lgkmcnt(3)
  v_exp_f32 v83, v83
  v_mfma_f32_16x16x32_bf16 v[216:219], a[40:43], v[48:51], v[216:219]
  s_nop 0
  ds_read_b128 a[4:7], v9 offset:24576
  ds_read_b128 a[8:11], v8 offset:25600
  v_mfma_f32_16x16x32_bf16 v[220:223], a[40:43], v[56:59], v[220:223]
  s_add_u32 m0, s37, 0x21700
  v_pk_add_f32 v[254:255], v[254:255], v[82:83]
  v_mfma_f32_16x16x32_bf16 v[224:227], a[40:43], v[64:67], v[224:227]
  s_waitcnt lgkmcnt(3)
  ds_read_b128 a[12:15], v9 offset:25600
  v_cvt_pk_bf16_f32 v81, v82, v83
  v_mfma_f32_16x16x32_bf16 v[236:239], a[44:47], v[64:67], v[236:239]
  s_nop 0
  ds_read_b128 a[16:19], v8 offset:26624
  ds_read_b128 a[20:23], v9 offset:26624
  v_mfma_f32_16x16x32_bf16 v[232:235], a[44:47], v[56:59], v[232:235]
  buffer_load_dwordx4 v16, s[20:23], s47 offen offset:256 lds
  v_mfma_f32_16x16x32_bf16 v[228:231], a[44:47], v[48:51], v[228:231]
  s_waitcnt lgkmcnt(5)
  v_exp_f32 v84, v84
  v_mfma_f32_16x16x32_bf16 v[48:51], a[0:3], a[48:51], v[32:35]
  s_waitcnt lgkmcnt(4)
  v_exp_f32 v85, v85
  v_mfma_f32_16x16x32_bf16 v[48:51], a[4:7], a[60:63], v[48:51]
  s_waitcnt lgkmcnt(3)
  s_add_u32 m0, s37, 0x6380
  v_pk_add_f32 v[254:255], v[254:255], v[84:85]
  v_mfma_f32_16x16x32_bf16 v[48:51], a[8:11], a[72:75], v[48:51]
  s_waitcnt lgkmcnt(2)
  ds_read_b128 a[24:27], v8 offset:30720
  v_cvt_pk_bf16_f32 v82, v84, v85
  v_mfma_f32_16x16x32_bf16 v[48:51], a[12:15], a[84:87], v[48:51]
  s_waitcnt lgkmcnt(2)
  buffer_load_dwordx4 v14, s[16:19], s45 offen offset:128 nt lds
  v_mfma_f32_16x16x32_bf16 v[48:51], a[16:19], a[96:99], v[48:51]
  s_waitcnt lgkmcnt(1)
  v_exp_f32 v86, v86
  v_mfma_f32_16x16x32_bf16 v[48:51], a[20:23], a[108:111], v[48:51]
  v_exp_f32 v87, v87
  v_mfma_f32_16x16x32_bf16 v[56:59], a[0:3], a[52:55], v[36:39]
  v_pk_add_f32 v[254:255], v[254:255], v[86:87]
  v_mfma_f32_16x16x32_bf16 v[56:59], a[4:7], a[64:67], v[56:59]
  ds_read_b128 a[28:31], v9 offset:30720
  v_cvt_pk_bf16_f32 v83, v86, v87
  v_mfma_f32_16x16x32_bf16 v[56:59], a[8:11], a[76:79], v[56:59]
  v_exp_f32 v88, v88
  v_mfma_f32_16x16x32_bf16 v[56:59], a[12:15], a[88:91], v[56:59]
  v_exp_f32 v89, v89
  v_mfma_f32_16x16x32_bf16 v[56:59], a[16:19], a[100:103], v[56:59]
  v_pk_add_f32 v[2:3], v[2:3], v[88:89]
  v_mfma_f32_16x16x32_bf16 v[56:59], a[20:23], a[112:115], v[56:59]
  ds_read_b128 a[32:35], v8 offset:31744
  v_cvt_pk_bf16_f32 v88, v88, v89
  v_mfma_f32_16x16x32_bf16 v[64:67], a[0:3], a[56:59], v[40:43]
  v_exp_f32 v90, v90
  v_mfma_f32_16x16x32_bf16 v[64:67], a[4:7], a[68:71], v[64:67]
  s_add_u32 s46, s68, 0x32000
  ds_read_b128 a[36:39], v9 offset:31744
  ds_read_b128 a[40:43], v8 offset:32768
  v_mfma_f32_16x16x32_bf16 v[64:67], a[8:11], a[80:83], v[64:67]
  s_add_u32 m0, s37, 0x24000
  ds_read_b128 a[44:47], v9 offset:32768
  v_readlane_b32 s100, v46, s41
  v_mfma_f32_16x16x32_bf16 v[64:67], a[12:15], a[92:95], v[64:67]
  buffer_load_dwordx4 v15, s[20:23], s46 offen lds
  v_mfma_f32_16x16x32_bf16 v[64:67], a[16:19], a[104:107], v[64:67]
  s_add_u32 m0, s37, 0x6700
  v_exp_f32 v91, v91
  v_mfma_f32_16x16x32_bf16 v[64:67], a[20:23], a[116:119], v[64:67]
  s_waitcnt lgkmcnt(5)
  v_pk_add_f32 v[2:3], v[2:3], v[90:91]
  v_mfma_f32_16x16x32_bf16 v[52:55], a[24:27], a[48:51], v[32:35]
  s_waitcnt lgkmcnt(4)
  buffer_load_dwordx4 v14, s[16:19], s45 offen offset:256 nt lds
  v_mfma_f32_16x16x32_bf16 v[52:55], a[28:31], a[60:63], v[52:55]
  s_waitcnt lgkmcnt(3)
  v_cvt_pk_bf16_f32 v89, v90, v91
  v_mfma_f32_16x16x32_bf16 v[52:55], a[32:35], a[72:75], v[52:55]
  s_waitcnt lgkmcnt(2)
  v_exp_f32 v92, v92
  v_mfma_f32_16x16x32_bf16 v[52:55], a[36:39], a[84:87], v[52:55]
  s_waitcnt lgkmcnt(1)
  v_exp_f32 v93, v93
  v_mfma_f32_16x16x32_bf16 v[52:55], a[40:43], a[96:99], v[52:55]
  s_waitcnt lgkmcnt(0)
  v_pk_add_f32 v[2:3], v[2:3], v[92:93]
  v_mfma_f32_16x16x32_bf16 v[52:55], a[44:47], a[108:111], v[52:55]
  ds_read_b64_tr_b16 a[0:1], v4 offset:24576
  v_cvt_pk_bf16_f32 v90, v92, v93
  v_mfma_f32_16x16x32_bf16 v[60:63], a[24:27], a[52:55], v[36:39]
  v_exp_f32 v94, v94
  v_mfma_f32_16x16x32_bf16 v[60:63], a[28:31], a[64:67], v[60:63]
  ds_read_b64_tr_b16 a[2:3], v4 offset:30720
  v_mfma_f32_16x16x32_bf16 v[60:63], a[32:35], a[76:79], v[60:63]
  s_nop 0
  ds_read_b64_tr_b16 a[4:5], v5 offset:24576
  ds_read_b64_tr_b16 a[6:7], v5 offset:30720
  v_mfma_f32_16x16x32_bf16 v[60:63], a[36:39], a[88:91], v[60:63]
  v_exp_f32 v95, v95
  v_mfma_f32_16x16x32_bf16 v[60:63], a[40:43], a[100:103], v[60:63]
  v_exp_f32 v48, v48
  v_mfma_f32_16x16x32_bf16 v[60:63], a[44:47], a[112:115], v[60:63]
  v_exp_f32 v49, v49
  v_mfma_f32_16x16x32_bf16 v[68:71], a[24:27], a[56:59], v[40:43]
  v_and_b32 v12, 3, v0
  v_cmp_eq_u32 vcc, s41, v12
  v_subrev_u32 v12, 16, v46
  s_nop 0
  v_cndmask_b32 v46, v46, v12, vcc
  v_readlane_b32 s101, v47, s40
  v_mfma_f32_16x16x32_bf16 v[68:71], a[28:31], a[68:71], v[68:71]
  s_add_u32 m0, s37, 0x24380
  v_exp_f32 v50, v50
  v_mfma_f32_16x16x32_bf16 v[68:71], a[32:35], a[80:83], v[68:71]
  buffer_load_dwordx4 v15, s[20:23], s46 offen offset:128 lds
  v_mfma_f32_16x16x32_bf16 v[68:71], a[36:39], a[92:95], v[68:71]
  v_exp_f32 v51, v51
  v_mfma_f32_16x16x32_bf16 v[68:71], a[40:43], a[104:107], v[68:71]
  v_pk_add_f32 v[2:3], v[2:3], v[94:95]
  v_cvt_pk_bf16_f32 v91, v94, v95
  v_mfma_f32_16x16x32_bf16 v[68:71], a[44:47], a[116:119], v[68:71]
  s_waitcnt lgkmcnt(2)
  ds_read_b64_tr_b16 a[8:9], v6 offset:24576
  ds_read_b64_tr_b16 a[10:11], v6 offset:30720
  v_mfma_f32_16x16x32_bf16 v[96:99], a[0:3], v[72:75], v[96:99]
  v_pk_add_f32 v[252:253], v[252:253], v[48:49]
  v_mfma_f32_16x16x32_bf16 v[100:103], a[0:3], v[80:83], v[100:103]
  ds_read_b64_tr_b16 a[12:13], v7 offset:24576
  v_cvt_pk_bf16_f32 v48, v48, v49
  v_mfma_f32_16x16x32_bf16 v[104:107], a[0:3], v[88:91], v[104:107]
  s_waitcnt lgkmcnt(3)
  ds_read_b64_tr_b16 a[14:15], v7 offset:30720
  ds_read_b64_tr_b16 a[16:17], v4 offset:25600
  v_mfma_f32_16x16x32_bf16 v[116:119], a[4:7], v[88:91], v[116:119]
  v_pk_add_f32 v[252:253], v[252:253], v[50:51]
  v_mfma_f32_16x16x32_bf16 v[112:115], a[4:7], v[80:83], v[112:115]
  ds_read_b64_tr_b16 a[18:19], v4 offset:31744
  v_cvt_pk_bf16_f32 v49, v50, v51
  v_mfma_f32_16x16x32_bf16 v[108:111], a[4:7], v[72:75], v[108:111]
  s_waitcnt lgkmcnt(4)
  v_exp_f32 v52, v52
  v_mfma_f32_16x16x32_bf16 v[120:123], a[8:11], v[72:75], v[120:123]
  v_exp_f32 v53, v53
  v_mfma_f32_16x16x32_bf16 v[124:127], a[8:11], v[80:83], v[124:127]
  v_pk_add_f32 v[252:253], v[252:253], v[52:53]
  v_mfma_f32_16x16x32_bf16 v[128:131], a[8:11], v[88:91], v[128:131]
  s_waitcnt lgkmcnt(2)
  ds_read_b64_tr_b16 a[20:21], v5 offset:25600
  ds_read_b64_tr_b16 a[22:23], v5 offset:31744
  v_mfma_f32_16x16x32_bf16 v[140:143], a[12:15], v[88:91], v[140:143]
  ds_read_b64_tr_b16 a[24:25], v6 offset:25600
  v_cvt_pk_bf16_f32 v50, v52, v53
  v_mfma_f32_16x16x32_bf16 v[136:139], a[12:15], v[80:83], v[136:139]
  v_exp_f32 v54, v54
  v_mfma_f32_16x16x32_bf16 v[132:135], a[12:15], v[72:75], v[132:135]
  s_waitcnt lgkmcnt(3)
  s_add_u32 m0, s37, 0x24700
  ds_read_b64_tr_b16 a[26:27], v6 offset:31744
  v_mfma_f32_16x16x32_bf16 v[144:147], a[16:19], v[72:75], v[144:147]
  buffer_load_dwordx4 v16, s[20:23], s46 offen offset:256 lds
  v_mfma_f32_16x16x32_bf16 v[148:151], a[16:19], v[80:83], v[148:151]
  v_exp_f32 v55, v55
  v_mfma_f32_16x16x32_bf16 v[152:155], a[16:19], v[88:91], v[152:155]
  s_waitcnt lgkmcnt(2)
  ds_read_b64_tr_b16 a[28:29], v7 offset:25600
  ds_read_b64_tr_b16 a[30:31], v7 offset:31744
  v_mfma_f32_16x16x32_bf16 v[164:167], a[20:23], v[88:91], v[164:167]
  v_pk_add_f32 v[252:253], v[252:253], v[54:55]
  v_mfma_f32_16x16x32_bf16 v[160:163], a[20:23], v[80:83], v[160:163]
  ds_read_b64_tr_b16 a[32:33], v4 offset:26624
  v_cvt_pk_bf16_f32 v51, v54, v55
  v_mfma_f32_16x16x32_bf16 v[156:159], a[20:23], v[72:75], v[156:159]
  s_waitcnt lgkmcnt(3)
  ds_read_b64_tr_b16 a[34:35], v4 offset:32768
  ds_read_b64_tr_b16 a[36:37], v5 offset:26624
  v_mfma_f32_16x16x32_bf16 v[168:171], a[24:27], v[72:75], v[168:171]
  v_exp_f32 v56, v56
  v_mfma_f32_16x16x32_bf16 v[172:175], a[24:27], v[80:83], v[172:175]
  v_exp_f32 v57, v57
  v_mfma_f32_16x16x32_bf16 v[176:179], a[24:27], v[88:91], v[176:179]
  s_waitcnt lgkmcnt(3)
  ds_read_b64_tr_b16 a[38:39], v5 offset:32768
  ds_read_b64_tr_b16 a[40:41], v6 offset:26624
  v_mfma_f32_16x16x32_bf16 v[188:191], a[28:31], v[88:91], v[188:191]
  v_pk_add_f32 v[254:255], v[254:255], v[56:57]
  v_mfma_f32_16x16x32_bf16 v[184:187], a[28:31], v[80:83], v[184:187]
  s_waitcnt vmcnt(13)
  s_barrier
  v_cvt_pk_bf16_f32 v56, v56, v57
  v_mfma_f32_16x16x32_bf16 v[180:183], a[28:31], v[72:75], v[180:183]
  s_waitcnt lgkmcnt(3)
  s_mov_b32 s44, 0x2d000
  ds_read_b64_tr_b16 a[42:43], v6 offset:32768
  v_mfma_f32_16x16x32_bf16 v[192:195], a[32:35], v[72:75], v[192:195]
  s_add_u32 m0, s37, 0xc000
  v_exp_f32 v58, v58
  v_mfma_f32_16x16x32_bf16 v[196:199], a[32:35], v[80:83], v[196:199]
  buffer_load_dwordx4 v13, s[12:15], s44 offen nt lds
  v_mfma_f32_16x16x32_bf16 v[200:203], a[32:35], v[88:91], v[200:203]
  s_waitcnt lgkmcnt(2)
  ds_read_b64_tr_b16 a[44:45], v7 offset:26624
  ds_read_b64_tr_b16 a[46:47], v7 offset:32768
  v_mfma_f32_16x16x32_bf16 v[212:215], a[36:39], v[88:91], v[212:215]
  s_add_u32 m0, s37, 0xc380
  v_exp_f32 v59, v59
  v_mfma_f32_16x16x32_bf16 v[208:211], a[36:39], v[80:83], v[208:211]
  v_add_u32 v8, 0x12000, v8
  v_add_u32 v9, 0x12000, v9
  v_mfma_f32_16x16x32_bf16 v[204:207], a[36:39], v[72:75], v[204:207]
  s_waitcnt lgkmcnt(2)
  ds_read_b128 a[0:3], v8 offset:0
  ds_read_b128 a[4:7], v9 offset:0
  v_mfma_f32_16x16x32_bf16 v[216:219], a[40:43], v[72:75], v[216:219]
  buffer_load_dwordx4 v13, s[12:15], s44 offen offset:128 nt lds
  v_mfma_f32_16x16x32_bf16 v[220:223], a[40:43], v[80:83], v[220:223]
  s_add_u32 m0, s37, 0xc700
  ds_read_b128 a[8:11], v8 offset:1024
  ds_read_b128 a[12:15], v9 offset:1024
  v_mfma_f32_16x16x32_bf16 v[224:227], a[40:43], v[88:91], v[224:227]
  s_waitcnt lgkmcnt(4)
  v_pk_add_f32 v[254:255], v[254:255], v[58:59]
  v_mfma_f32_16x16x32_bf16 v[236:239], a[44:47], v[88:91], v[236:239]
  ds_read_b128 a[16:19], v8 offset:2048
  v_cvt_pk_bf16_f32 v57, v58, v59
  v_mfma_f32_16x16x32_bf16 v[232:235], a[44:47], v[80:83], v[232:235]
  s_nop 0
  ds_read_b128 a[20:23], v9 offset:2048
  ds_read_b128 a[24:27], v8 offset:6144
  v_mfma_f32_16x16x32_bf16 v[228:231], a[44:47], v[72:75], v[228:231]
  s_waitcnt lgkmcnt(6)
  v_exp_f32 v60, v60
  v_mfma_f32_16x16x32_bf16 v[72:75], a[0:3], a[48:51], v[32:35]
  s_waitcnt lgkmcnt(5)
  buffer_load_dwordx4 v13, s[12:15], s44 offen offset:256 nt lds
  v_mfma_f32_16x16x32_bf16 v[72:75], a[4:7], a[60:63], v[72:75]
  s_waitcnt lgkmcnt(4)
  s_add_u32 s47, s69, 0
  v_exp_f32 v61, v61
  v_mfma_f32_16x16x32_bf16 v[72:75], a[8:11], a[72:75], v[72:75]
  s_waitcnt lgkmcnt(3)
  v_pk_add_f32 v[254:255], v[254:255], v[60:61]
  v_mfma_f32_16x16x32_bf16 v[72:75], a[12:15], a[84:87], v[72:75]
  s_waitcnt lgkmcnt(2)
  s_add_u32 m0, s37, 0x15000
  ds_read_b128 a[28:31], v9 offset:6144
  v_cvt_pk_bf16_f32 v58, v60, v61
  v_mfma_f32_16x16x32_bf16 v[72:75], a[16:19], a[96:99], v[72:75]
  s_waitcnt lgkmcnt(2)
  buffer_load_dwordx4 v15, s[20:23], s47 offen lds
  v_mfma_f32_16x16x32_bf16 v[72:75], a[20:23], a[108:111], v[72:75]
  v_exp_f32 v62, v62
  v_mfma_f32_16x16x32_bf16 v[80:83], a[0:3], a[52:55], v[36:39]
  v_exp_f32 v63, v63
  v_mfma_f32_16x16x32_bf16 v[80:83], a[4:7], a[64:67], v[80:83]
  v_pk_add_f32 v[254:255], v[254:255], v[62:63]
  v_mfma_f32_16x16x32_bf16 v[80:83], a[8:11], a[76:79], v[80:83]
  ds_read_b128 a[32:35], v8 offset:7168
  v_cvt_pk_bf16_f32 v59, v62, v63
  v_mfma_f32_16x16x32_bf16 v[80:83], a[12:15], a[88:91], v[80:83]
  v_exp_f32 v64, v64
  v_mfma_f32_16x16x32_bf16 v[80:83], a[16:19], a[100:103], v[80:83]
  v_exp_f32 v65, v65
  v_mfma_f32_16x16x32_bf16 v[80:83], a[20:23], a[112:115], v[80:83]
  s_add_u32 m0, s37, 0x15380
  v_pk_add_f32 v[2:3], v[2:3], v[64:65]
  v_mfma_f32_16x16x32_bf16 v[88:91], a[0:3], a[56:59], v[40:43]
  buffer_load_dwordx4 v15, s[20:23], s47 offen offset:128 lds
  v_mfma_f32_16x16x32_bf16 v[88:91], a[4:7], a[68:71], v[88:91]
  ds_read_b128 a[36:39], v9 offset:7168
  v_cvt_pk_bf16_f32 v64, v64, v65
  v_mfma_f32_16x16x32_bf16 v[88:91], a[8:11], a[80:83], v[88:91]
  v_exp_f32 v66, v66
  v_mfma_f32_16x16x32_bf16 v[88:91], a[12:15], a[92:95], v[88:91]
  s_nop 0
  ds_read_b128 a[40:43], v8 offset:8192
  ds_read_b128 a[44:47], v9 offset:8192
  v_mfma_f32_16x16x32_bf16 v[88:91], a[16:19], a[104:107], v[88:91]
  v_exp_f32 v67, v67
  v_mfma_f32_16x16x32_bf16 v[88:91], a[20:23], a[116:119], v[88:91]
  s_waitcnt lgkmcnt(5)
  v_pk_add_f32 v[2:3], v[2:3], v[66:67]
  v_mfma_f32_16x16x32_bf16 v[76:79], a[24:27], a[48:51], v[32:35]
  s_waitcnt lgkmcnt(4)
  v_cvt_pk_bf16_f32 v65, v66, v67
  v_mfma_f32_16x16x32_bf16 v[76:79], a[28:31], a[60:63], v[76:79]
  s_waitcnt lgkmcnt(3)
  v_exp_f32 v68, v68
  v_mfma_f32_16x16x32_bf16 v[76:79], a[32:35], a[72:75], v[76:79]
  s_waitcnt lgkmcnt(2)
  v_exp_f32 v69, v69
  v_mfma_f32_16x16x32_bf16 v[76:79], a[36:39], a[84:87], v[76:79]
  s_waitcnt lgkmcnt(1)
  v_pk_add_f32 v[2:3], v[2:3], v[68:69]
  v_mfma_f32_16x16x32_bf16 v[76:79], a[40:43], a[96:99], v[76:79]
  s_waitcnt lgkmcnt(0)
  v_cvt_pk_bf16_f32 v66, v68, v69
  v_add_u32 v4, 0xfffee000, v4
  v_mfma_f32_16x16x32_bf16 v[76:79], a[44:47], a[108:111], v[76:79]
  v_exp_f32 v70, v70
  v_mfma_f32_16x16x32_bf16 v[84:87], a[24:27], a[52:55], v[36:39]
  v_add_u32 v5, 0xfffee000, v5
  v_add_u32 v6, 0xfffee000, v6
  v_mfma_f32_16x16x32_bf16 v[84:87], a[28:31], a[64:67], v[84:87]
  v_add_u32 v7, 0xfffee000, v7
  v_mfma_f32_16x16x32_bf16 v[84:87], a[32:35], a[76:79], v[84:87]
  s_nop 0
  ds_read_b64_tr_b16 a[0:1], v4 offset:0
  ds_read_b64_tr_b16 a[2:3], v4 offset:6144
  v_mfma_f32_16x16x32_bf16 v[84:87], a[36:39], a[88:91], v[84:87]
  s_nop 0
  ds_read_b64_tr_b16 a[4:5], v5 offset:0
  ds_read_b64_tr_b16 a[6:7], v5 offset:6144
  v_mfma_f32_16x16x32_bf16 v[84:87], a[40:43], a[100:103], v[84:87]
  s_add_u32 m0, s37, 0x15700
  v_exp_f32 v71, v71
  v_mfma_f32_16x16x32_bf16 v[84:87], a[44:47], a[112:115], v[84:87]
  buffer_load_dwordx4 v16, s[20:23], s47 offen offset:256 lds
  v_mfma_f32_16x16x32_bf16 v[92:95], a[24:27], a[56:59], v[40:43]
  v_and_b32 v12, 7, v0
  v_cmp_eq_u32 vcc, s40, v12
  v_subrev_u32 v12, 16, v47
  s_nop 0
  v_cndmask_b32 v47, v47, v12, vcc
  v_mfma_f32_16x16x32_bf16 v[92:95], a[28:31], a[68:71], v[92:95]
  v_exp_f32 v72, v72
  v_mfma_f32_16x16x32_bf16 v[92:95], a[32:35], a[80:83], v[92:95]
  v_exp_f32 v73, v73
  v_mfma_f32_16x16x32_bf16 v[92:95], a[36:39], a[92:95], v[92:95]
  v_exp_f32 v74, v74
  v_mfma_f32_16x16x32_bf16 v[92:95], a[40:43], a[104:107], v[92:95]
  v_pk_add_f32 v[2:3], v[2:3], v[70:71]
  v_cvt_pk_bf16_f32 v67, v70, v71
  v_mfma_f32_16x16x32_bf16 v[92:95], a[44:47], a[116:119], v[92:95]
  s_waitcnt lgkmcnt(2)
  ds_read_b64_tr_b16 a[8:9], v6 offset:0
  ds_read_b64_tr_b16 a[10:11], v6 offset:6144
  v_mfma_f32_16x16x32_bf16 v[96:99], a[0:3], v[48:51], v[96:99]
  v_pk_add_f32 v[252:253], v[252:253], v[72:73]
  v_mfma_f32_16x16x32_bf16 v[100:103], a[0:3], v[56:59], v[100:103]
  ds_read_b64_tr_b16 a[12:13], v7 offset:0
  v_cvt_pk_bf16_f32 v72, v72, v73
  v_mfma_f32_16x16x32_bf16 v[104:107], a[0:3], v[64:67], v[104:107]
  s_waitcnt lgkmcnt(3)
  ds_read_b64_tr_b16 a[14:15], v7 offset:6144
  ds_read_b64_tr_b16 a[16:17], v4 offset:1024
  v_mfma_f32_16x16x32_bf16 v[116:119], a[4:7], v[64:67], v[116:119]
  v_exp_f32 v75, v75
  v_mfma_f32_16x16x32_bf16 v[112:115], a[4:7], v[56:59], v[112:115]
  v_pk_add_f32 v[252:253], v[252:253], v[74:75]
  v_mfma_f32_16x16x32_bf16 v[108:111], a[4:7], v[48:51], v[108:111]
  s_waitcnt lgkmcnt(3)
  ds_read_b64_tr_b16 a[18:19], v4 offset:7168
  v_cvt_pk_bf16_f32 v73, v74, v75
  v_mfma_f32_16x16x32_bf16 v[120:123], a[8:11], v[48:51], v[120:123]
  v_exp_f32 v76, v76
  v_mfma_f32_16x16x32_bf16 v[124:127], a[8:11], v[56:59], v[124:127]
  v_exp_f32 v77, v77
  v_mfma_f32_16x16x32_bf16 v[128:131], a[8:11], v[64:67], v[128:131]
  s_waitcnt lgkmcnt(2)
  ds_read_b64_tr_b16 a[20:21], v5 offset:1024
  ds_read_b64_tr_b16 a[22:23], v5 offset:7168
  v_mfma_f32_16x16x32_bf16 v[140:143], a[12:15], v[64:67], v[140:143]
  v_pk_add_f32 v[252:253], v[252:253], v[76:77]
  v_mfma_f32_16x16x32_bf16 v[136:139], a[12:15], v[56:59], v[136:139]
  ds_read_b64_tr_b16 a[24:25], v6 offset:1024
  v_cvt_pk_bf16_f32 v74, v76, v77
  v_mfma_f32_16x16x32_bf16 v[132:135], a[12:15], v[48:51], v[132:135]
  s_waitcnt lgkmcnt(3)
  ds_read_b64_tr_b16 a[26:27], v6 offset:7168
  ds_read_b64_tr_b16 a[28:29], v7 offset:1024
  v_mfma_f32_16x16x32_bf16 v[144:147], a[16:19], v[48:51], v[144:147]
  v_exp_f32 v78, v78
  v_mfma_f32_16x16x32_bf16 v[148:151], a[16:19], v[56:59], v[148:151]
  v_exp_f32 v79, v79
  v_mfma_f32_16x16x32_bf16 v[152:155], a[16:19], v[64:67], v[152:155]
  s_waitcnt lgkmcnt(3)
  ds_read_b64_tr_b16 a[30:31], v7 offset:7168
  ds_read_b64_tr_b16 a[32:33], v4 offset:2048
  v_mfma_f32_16x16x32_bf16 v[164:167], a[20:23], v[64:67], v[164:167]
  v_pk_add_f32 v[252:253], v[252:253], v[78:79]
  v_mfma_f32_16x16x32_bf16 v[160:163], a[20:23], v[56:59], v[160:163]
  ds_read_b64_tr_b16 a[34:35], v4 offset:8192
  v_cvt_pk_bf16_f32 v75, v78, v79
  v_mfma_f32_16x16x32_bf16 v[156:159], a[20:23], v[48:51], v[156:159]
  s_waitcnt lgkmcnt(4)
  v_exp_f32 v80, v80
  v_mfma_f32_16x16x32_bf16 v[168:171], a[24:27], v[48:51], v[168:171]
  v_exp_f32 v81, v81
  v_mfma_f32_16x16x32_bf16 v[172:175], a[24:27], v[56:59], v[172:175]
  v_pk_add_f32 v[254:255], v[254:255], v[80:81]
  v_mfma_f32_16x16x32_bf16 v[176:179], a[24:27], v[64:67], v[176:179]
  s_waitcnt lgkmcnt(2)
  ds_read_b64_tr_b16 a[36:37], v5 offset:2048
  ds_read_b64_tr_b16 a[38:39], v5 offset:8192
  v_mfma_f32_16x16x32_bf16 v[188:191], a[28:31], v[64:67], v[188:191]
  ds_read_b64_tr_b16 a[40:41], v6 offset:2048
  v_cvt_pk_bf16_f32 v80, v80, v81
  v_mfma_f32_16x16x32_bf16 v[184:187], a[28:31], v[56:59], v[184:187]
  s_waitcnt vmcnt(8)
  s_barrier
  ds_read_b64_tr_b16 a[42:43], v6 offset:8192
  v_mfma_f32_16x16x32_bf16 v[180:183], a[28:31], v[48:51], v[180:183]
  s_waitcnt lgkmcnt(4)
  v_exp_f32 v82, v82
  v_mfma_f32_16x16x32_bf16 v[192:195], a[32:35], v[48:51], v[192:195]
  s_mov_b32 s45, 0x2a000
  v_exp_f32 v83, v83
  v_mfma_f32_16x16x32_bf16 v[196:199], a[32:35], v[56:59], v[196:199]
  s_add_u32 m0, s37, 0x18000
  v_pk_add_f32 v[254:255], v[254:255], v[82:83]
  v_mfma_f32_16x16x32_bf16 v[200:203], a[32:35], v[64:67], v[200:203]
  s_waitcnt lgkmcnt(2)
  ds_read_b64_tr_b16 a[44:45], v7 offset:2048
  ds_read_b64_tr_b16 a[46:47], v7 offset:8192
  v_mfma_f32_16x16x32_bf16 v[212:215], a[36:39], v[64:67], v[212:215]
  buffer_load_dwordx4 v14, s[16:19], s45 offen nt lds
  v_mfma_f32_16x16x32_bf16 v[208:211], a[36:39], v[56:59], v[208:211]
  s_add_u32 m0, s37, 0x18380
  v_add_u32 v8, 0xffffa000, v8
  v_add_u32 v9, 0xffffa000, v9
  v_mfma_f32_16x16x32_bf16 v[204:207], a[36:39], v[48:51], v[204:207]
  s_waitcnt lgkmcnt(2)
  ds_read_b128 a[0:3], v8 offset:0
  v_cvt_pk_bf16_f32 v81, v82, v83
  v_mfma_f32_16x16x32_bf16 v[216:219], a[40:43], v[48:51], v[216:219]
  s_nop 0
  ds_read_b128 a[4:7], v9 offset:0
  ds_read_b128 a[8:11], v8 offset:1024
  v_mfma_f32_16x16x32_bf16 v[220:223], a[40:43], v[56:59], v[220:223]
  buffer_load_dwordx4 v14, s[16:19], s45 offen offset:128 nt lds
  v_mfma_f32_16x16x32_bf16 v[224:227], a[40:43], v[64:67], v[224:227]
  s_waitcnt lgkmcnt(3)
  s_add_u32 m0, s37, 0x18700
  ds_read_b128 a[12:15], v9 offset:1024
  v_mfma_f32_16x16x32_bf16 v[236:239], a[44:47], v[64:67], v[236:239]
  s_nop 0
  ds_read_b128 a[16:19], v8 offset:2048
  ds_read_b128 a[20:23], v9 offset:2048
  v_mfma_f32_16x16x32_bf16 v[232:235], a[44:47], v[56:59], v[232:235]
  buffer_load_dwordx4 v14, s[16:19], s45 offen offset:256 nt lds
  v_mfma_f32_16x16x32_bf16 v[228:231], a[44:47], v[48:51], v[228:231]
  s_waitcnt lgkmcnt(5)
  v_exp_f32 v84, v84
  v_mfma_f32_16x16x32_bf16 v[48:51], a[0:3], a[48:51], v[32:35]
  s_waitcnt lgkmcnt(4)
  s_mov_b32 s44, 0x2d000
  v_exp_f32 v85, v85
  v_mfma_f32_16x16x32_bf16 v[48:51], a[4:7], a[60:63], v[48:51]
  s_waitcnt lgkmcnt(3)
  s_add_u32 m0, s37, 0x1b000
  v_pk_add_f32 v[254:255], v[254:255], v[84:85]
  v_mfma_f32_16x16x32_bf16 v[48:51], a[8:11], a[72:75], v[48:51]
  s_waitcnt lgkmcnt(2)
  ds_read_b128 a[24:27], v8 offset:6144
  v_cvt_pk_bf16_f32 v82, v84, v85
  v_mfma_f32_16x16x32_bf16 v[48:51], a[12:15], a[84:87], v[48:51]
  s_waitcnt lgkmcnt(2)
  buffer_load_dwordx4 v14, s[16:19], s44 offen nt lds
  v_mfma_f32_16x16x32_bf16 v[48:51], a[16:19], a[96:99], v[48:51]
  s_waitcnt lgkmcnt(1)
  s_add_u32 m0, s37, 0x1b380
  v_exp_f32 v86, v86
  v_mfma_f32_16x16x32_bf16 v[48:51], a[20:23], a[108:111], v[48:51]
  buffer_load_dwordx4 v14, s[16:19], s44 offen offset:128 nt lds
  v_mfma_f32_16x16x32_bf16 v[56:59], a[0:3], a[52:55], v[36:39]
  s_add_u32 m0, s37, 0x1b700
  v_exp_f32 v87, v87
  v_mfma_f32_16x16x32_bf16 v[56:59], a[4:7], a[64:67], v[56:59]
  buffer_load_dwordx4 v14, s[16:19], s44 offen offset:256 nt lds
  v_mfma_f32_16x16x32_bf16 v[56:59], a[8:11], a[76:79], v[56:59]
  v_pk_add_f32 v[254:255], v[254:255], v[86:87]
  v_mfma_f32_16x16x32_bf16 v[56:59], a[12:15], a[88:91], v[56:59]
  ds_read_b128 a[28:31], v9 offset:6144
  v_cvt_pk_bf16_f32 v83, v86, v87
  v_mfma_f32_16x16x32_bf16 v[56:59], a[16:19], a[100:103], v[56:59]
  v_exp_f32 v88, v88
  v_mfma_f32_16x16x32_bf16 v[56:59], a[20:23], a[112:115], v[56:59]
  v_exp_f32 v89, v89
  v_mfma_f32_16x16x32_bf16 v[64:67], a[0:3], a[56:59], v[40:43]
  v_pk_add_f32 v[2:3], v[2:3], v[88:89]
  v_mfma_f32_16x16x32_bf16 v[64:67], a[4:7], a[68:71], v[64:67]
  ds_read_b128 a[32:35], v8 offset:7168
  v_cvt_pk_bf16_f32 v88, v88, v89
  v_mfma_f32_16x16x32_bf16 v[64:67], a[8:11], a[80:83], v[64:67]
  s_nop 0
  ds_read_b128 a[36:39], v9 offset:7168
  ds_read_b128 a[40:43], v8 offset:8192
  v_mfma_f32_16x16x32_bf16 v[64:67], a[12:15], a[92:95], v[64:67]
  v_exp_f32 v90, v90
  v_mfma_f32_16x16x32_bf16 v[64:67], a[16:19], a[104:107], v[64:67]
  ds_read_b128 a[44:47], v9 offset:8192
  v_mfma_f32_16x16x32_bf16 v[64:67], a[20:23], a[116:119], v[64:67]
  s_waitcnt lgkmcnt(5)
  v_exp_f32 v91, v91
  v_mfma_f32_16x16x32_bf16 v[52:55], a[24:27], a[48:51], v[32:35]
  s_waitcnt lgkmcnt(4)
  v_pk_add_f32 v[2:3], v[2:3], v[90:91]
  v_mfma_f32_16x16x32_bf16 v[52:55], a[28:31], a[60:63], v[52:55]
  s_waitcnt lgkmcnt(3)
  v_cvt_pk_bf16_f32 v89, v90, v91
  v_mfma_f32_16x16x32_bf16 v[52:55], a[32:35], a[72:75], v[52:55]
  s_waitcnt lgkmcnt(2)
  v_exp_f32 v92, v92
  v_mfma_f32_16x16x32_bf16 v[52:55], a[36:39], a[84:87], v[52:55]
  s_waitcnt lgkmcnt(1)
  v_exp_f32 v93, v93
  v_mfma_f32_16x16x32_bf16 v[52:55], a[40:43], a[96:99], v[52:55]
  s_waitcnt lgkmcnt(0)
  v_pk_add_f32 v[2:3], v[2:3], v[92:93]
  v_mfma_f32_16x16x32_bf16 v[52:55], a[44:47], a[108:111], v[52:55]
  ds_read_b64_tr_b16 a[0:1], v4 offset:12288
  v_cvt_pk_bf16_f32 v90, v92, v93
  v_mfma_f32_16x16x32_bf16 v[60:63], a[24:27], a[52:55], v[36:39]
  v_exp_f32 v94, v94
  v_mfma_f32_16x16x32_bf16 v[60:63], a[28:31], a[64:67], v[60:63]
  ds_read_b64_tr_b16 a[2:3], v4 offset:18432
  v_mfma_f32_16x16x32_bf16 v[60:63], a[32:35], a[76:79], v[60:63]
  s_nop 0
  ds_read_b64_tr_b16 a[4:5], v5 offset:12288
  ds_read_b64_tr_b16 a[6:7], v5 offset:18432
  v_mfma_f32_16x16x32_bf16 v[60:63], a[36:39], a[88:91], v[60:63]
  v_exp_f32 v95, v95
  v_mfma_f32_16x16x32_bf16 v[60:63], a[40:43], a[100:103], v[60:63]
  v_exp_f32 v48, v48
  v_mfma_f32_16x16x32_bf16 v[60:63], a[44:47], a[112:115], v[60:63]
  v_exp_f32 v49, v49
  v_mfma_f32_16x16x32_bf16 v[68:71], a[24:27], a[56:59], v[40:43]
  v_exp_f32 v50, v50
  v_mfma_f32_16x16x32_bf16 v[68:71], a[28:31], a[68:71], v[68:71]
  v_exp_f32 v51, v51
  v_mfma_f32_16x16x32_bf16 v[68:71], a[32:35], a[80:83], v[68:71]
  v_exp_f32 v52, v52
  v_mfma_f32_16x16x32_bf16 v[68:71], a[36:39], a[92:95], v[68:71]
  v_exp_f32 v53, v53
  v_mfma_f32_16x16x32_bf16 v[68:71], a[40:43], a[104:107], v[68:71]
  v_pk_add_f32 v[2:3], v[2:3], v[94:95]
  v_cvt_pk_bf16_f32 v91, v94, v95
  v_mfma_f32_16x16x32_bf16 v[68:71], a[44:47], a[116:119], v[68:71]
  s_waitcnt lgkmcnt(2)
  ds_read_b64_tr_b16 a[8:9], v6 offset:12288
  ds_read_b64_tr_b16 a[10:11], v6 offset:18432
  v_mfma_f32_16x16x32_bf16 v[96:99], a[0:3], v[72:75], v[96:99]
  v_pk_add_f32 v[252:253], v[252:253], v[48:49]
  v_mfma_f32_16x16x32_bf16 v[100:103], a[0:3], v[80:83], v[100:103]
  ds_read_b64_tr_b16 a[12:13], v7 offset:12288
  v_cvt_pk_bf16_f32 v48, v48, v49
  v_mfma_f32_16x16x32_bf16 v[104:107], a[0:3], v[88:91], v[104:107]
  s_waitcnt lgkmcnt(3)
  ds_read_b64_tr_b16 a[14:15], v7 offset:18432
  ds_read_b64_tr_b16 a[16:17], v4 offset:13312
  v_mfma_f32_16x16x32_bf16 v[116:119], a[4:7], v[88:91], v[116:119]
  v_pk_add_f32 v[252:253], v[252:253], v[50:51]
  v_mfma_f32_16x16x32_bf16 v[112:115], a[4:7], v[80:83], v[112:115]
L_hop8:
  s_cbranch_execz L_hop12
  ds_read_b64_tr_b16 a[18:19], v4 offset:19456
  v_cvt_pk_bf16_f32 v49, v50, v51
  v_mfma_f32_16x16x32_bf16 v[108:111], a[4:7], v[72:75], v[108:111]
  s_waitcnt lgkmcnt(4)
  v_pk_add_f32 v[252:253], v[252:253], v[52:53]
  v_mfma_f32_16x16x32_bf16 v[120:123], a[8:11], v[72:75], v[120:123]
  ds_read_b64_tr_b16 a[20:21], v5 offset:13312
  v_cvt_pk_bf16_f32 v50, v52, v53
  v_mfma_f32_16x16x32_bf16 v[124:127], a[8:11], v[80:83], v[124:127]
  v_exp_f32 v54, v54
  v_mfma_f32_16x16x32_bf16 v[128:131], a[8:11], v[88:91], v[128:131]
  s_waitcnt lgkmcnt(3)
  ds_read_b64_tr_b16 a[22:23], v5 offset:19456
  ds_read_b64_tr_b16 a[24:25], v6 offset:13312
  v_mfma_f32_16x16x32_bf16 v[140:143], a[12:15], v[88:91], v[140:143]
  v_exp_f32 v55, v55
  v_mfma_f32_16x16x32_bf16 v[136:139], a[12:15], v[80:83], v[136:139]
  v_pk_add_f32 v[252:253], v[252:253], v[54:55]
  v_mfma_f32_16x16x32_bf16 v[132:135], a[12:15], v[72:75], v[132:135]
  s_waitcnt lgkmcnt(3)
  ds_read_b64_tr_b16 a[26:27], v6 offset:19456
  v_cvt_pk_bf16_f32 v51, v54, v55
  v_mfma_f32_16x16x32_bf16 v[144:147], a[16:19], v[72:75], v[144:147]
  v_exp_f32 v56, v56
  v_mfma_f32_16x16x32_bf16 v[148:151], a[16:19], v[80:83], v[148:151]
  v_exp_f32 v57, v57
  v_mfma_f32_16x16x32_bf16 v[152:155], a[16:19], v[88:91], v[152:155]
  s_waitcnt lgkmcnt(2)
  ds_read_b64_tr_b16 a[28:29], v7 offset:13312
  ds_read_b64_tr_b16 a[30:31], v7 offset:19456
  v_mfma_f32_16x16x32_bf16 v[164:167], a[20:23], v[88:91], v[164:167]
  v_pk_add_f32 v[254:255], v[254:255], v[56:57]
  v_mfma_f32_16x16x32_bf16 v[160:163], a[20:23], v[80:83], v[160:163]
  ds_read_b64_tr_b16 a[32:33], v4 offset:14336
  v_cvt_pk_bf16_f32 v56, v56, v57
  v_mfma_f32_16x16x32_bf16 v[156:159], a[20:23], v[72:75], v[156:159]
  s_waitcnt lgkmcnt(3)
  ds_read_b64_tr_b16 a[34:35], v4 offset:20480
  ds_read_b64_tr_b16 a[36:37], v5 offset:14336
  v_mfma_f32_16x16x32_bf16 v[168:171], a[24:27], v[72:75], v[168:171]
  v_exp_f32 v58, v58
  v_mfma_f32_16x16x32_bf16 v[172:175], a[24:27], v[80:83], v[172:175]
  v_exp_f32 v59, v59
  v_mfma_f32_16x16x32_bf16 v[176:179], a[24:27], v[88:91], v[176:179]
  s_waitcnt lgkmcnt(3)
  ds_read_b64_tr_b16 a[38:39], v5 offset:20480
  ds_read_b64_tr_b16 a[40:41], v6 offset:14336
  v_mfma_f32_16x16x32_bf16 v[188:191], a[28:31], v[88:91], v[188:191]
  v_pk_add_f32 v[254:255], v[254:255], v[58:59]
  v_mfma_f32_16x16x32_bf16 v[184:187], a[28:31], v[80:83], v[184:187]
  s_waitcnt vmcnt(3)
  s_barrier
  v_cvt_pk_bf16_f32 v57, v58, v59
  v_mfma_f32_16x16x32_bf16 v[180:183], a[28:31], v[72:75], v[180:183]
  s_waitcnt lgkmcnt(3)
  s_add_u32 s46, s69, 0xa000
  ds_read_b64_tr_b16 a[42:43], v6 offset:20480
  v_mfma_f32_16x16x32_bf16 v[192:195], a[32:35], v[72:75], v[192:195]
  s_add_u32 m0, s37, 0x3000
  v_exp_f32 v60, v60
  v_mfma_f32_16x16x32_bf16 v[196:199], a[32:35], v[80:83], v[196:199]
  buffer_load_dwordx4 v15, s[20:23], s46 offen lds
  v_mfma_f32_16x16x32_bf16 v[200:203], a[32:35], v[88:91], v[200:203]
  s_waitcnt lgkmcnt(2)
  ds_read_b64_tr_b16 a[44:45], v7 offset:14336
  ds_read_b64_tr_b16 a[46:47], v7 offset:20480
  v_mfma_f32_16x16x32_bf16 v[212:215], a[36:39], v[88:91], v[212:215]
  s_add_u32 m0, s37, 0x3380
  v_exp_f32 v61, v61
  v_mfma_f32_16x16x32_bf16 v[208:211], a[36:39], v[80:83], v[208:211]
  v_add_u32 v8, 0xffffa000, v8
  v_add_u32 v9, 0xffffa000, v9
  v_mfma_f32_16x16x32_bf16 v[204:207], a[36:39], v[72:75], v[204:207]
  s_waitcnt lgkmcnt(2)
  ds_read_b128 a[0:3], v8 offset:0
  ds_read_b128 a[4:7], v9 offset:0
  v_mfma_f32_16x16x32_bf16 v[216:219], a[40:43], v[72:75], v[216:219]
  buffer_load_dwordx4 v15, s[20:23], s46 offen offset:128 lds
  v_mfma_f32_16x16x32_bf16 v[220:223], a[40:43], v[80:83], v[220:223]
  s_add_u32 m0, s37, 0x3700
  ds_read_b128 a[8:11], v8 offset:1024
  ds_read_b128 a[12:15], v9 offset:1024
  v_mfma_f32_16x16x32_bf16 v[224:227], a[40:43], v[88:91], v[224:227]
  s_waitcnt lgkmcnt(4)
  v_pk_add_f32 v[254:255], v[254:255], v[60:61]
  v_mfma_f32_16x16x32_bf16 v[236:239], a[44:47], v[88:91], v[236:239]
  ds_read_b128 a[16:19], v8 offset:2048
  v_cvt_pk_bf16_f32 v58, v60, v61
  v_mfma_f32_16x16x32_bf16 v[232:235], a[44:47], v[80:83], v[232:235]
  s_nop 0
  ds_read_b128 a[20:23], v9 offset:2048
  ds_read_b128 a[24:27], v8 offset:6144
  v_mfma_f32_16x16x32_bf16 v[228:231], a[44:47], v[72:75], v[228:231]
  s_waitcnt lgkmcnt(6)
  v_exp_f32 v62, v62
  v_mfma_f32_16x16x32_bf16 v[72:75], a[0:3], a[48:51], v[32:35]
  s_waitcnt lgkmcnt(5)
  buffer_load_dwordx4 v16, s[20:23], s46 offen offset:256 lds
  v_mfma_f32_16x16x32_bf16 v[72:75], a[4:7], a[60:63], v[72:75]
  s_waitcnt lgkmcnt(4)
  s_add_u32 s47, s70, 0
  v_exp_f32 v63, v63
  v_mfma_f32_16x16x32_bf16 v[72:75], a[8:11], a[72:75], v[72:75]
  s_waitcnt lgkmcnt(3)
  v_pk_add_f32 v[254:255], v[254:255], v[62:63]
  v_mfma_f32_16x16x32_bf16 v[72:75], a[12:15], a[84:87], v[72:75]
  s_waitcnt lgkmcnt(2)
  s_add_u32 m0, s37, 0x12000
  ds_read_b128 a[28:31], v9 offset:6144
  v_cvt_pk_bf16_f32 v59, v62, v63
  v_mfma_f32_16x16x32_bf16 v[72:75], a[16:19], a[96:99], v[72:75]
  s_waitcnt lgkmcnt(2)
  buffer_load_dwordx4 v15, s[20:23], s47 offen lds
  v_mfma_f32_16x16x32_bf16 v[72:75], a[20:23], a[108:111], v[72:75]
  s_add_u32 m0, s37, 0x12380
  v_exp_f32 v64, v64
  v_mfma_f32_16x16x32_bf16 v[80:83], a[0:3], a[52:55], v[36:39]
  buffer_load_dwordx4 v15, s[20:23], s47 offen offset:128 lds
  v_mfma_f32_16x16x32_bf16 v[80:83], a[4:7], a[64:67], v[80:83]
  s_add_u32 m0, s37, 0x12700
  v_exp_f32 v65, v65
  v_mfma_f32_16x16x32_bf16 v[80:83], a[8:11], a[76:79], v[80:83]
  buffer_load_dwordx4 v16, s[20:23], s47 offen offset:256 lds
  v_mfma_f32_16x16x32_bf16 v[80:83], a[12:15], a[88:91], v[80:83]
  v_pk_add_f32 v[2:3], v[2:3], v[64:65]
  v_mfma_f32_16x16x32_bf16 v[80:83], a[16:19], a[100:103], v[80:83]
  ds_read_b128 a[32:35], v8 offset:7168
  v_cvt_pk_bf16_f32 v64, v64, v65
  v_mfma_f32_16x16x32_bf16 v[80:83], a[20:23], a[112:115], v[80:83]
  v_exp_f32 v66, v66
  v_mfma_f32_16x16x32_bf16 v[88:91], a[0:3], a[56:59], v[40:43]
  s_nop 0
  ds_read_b128 a[36:39], v9 offset:7168
  ds_read_b128 a[40:43], v8 offset:8192
  v_mfma_f32_16x16x32_bf16 v[88:91], a[4:7], a[68:71], v[88:91]
  ds_read_b128 a[44:47], v9 offset:8192
  v_mfma_f32_16x16x32_bf16 v[88:91], a[8:11], a[80:83], v[88:91]
  v_exp_f32 v67, v67
  v_mfma_f32_16x16x32_bf16 v[88:91], a[12:15], a[92:95], v[88:91]
  v_pk_add_f32 v[2:3], v[2:3], v[66:67]
  v_mfma_f32_16x16x32_bf16 v[88:91], a[16:19], a[104:107], v[88:91]
  v_cvt_pk_bf16_f32 v65, v66, v67
  v_mfma_f32_16x16x32_bf16 v[88:91], a[20:23], a[116:119], v[88:91]
  s_waitcnt lgkmcnt(5)
  v_exp_f32 v68, v68
  v_mfma_f32_16x16x32_bf16 v[76:79], a[24:27], a[48:51], v[32:35]
  s_waitcnt lgkmcnt(4)
  v_exp_f32 v69, v69
  v_mfma_f32_16x16x32_bf16 v[76:79], a[28:31], a[60:63], v[76:79]
  s_waitcnt lgkmcnt(3)
  v_pk_add_f32 v[2:3], v[2:3], v[68:69]
  v_mfma_f32_16x16x32_bf16 v[76:79], a[32:35], a[72:75], v[76:79]
  s_waitcnt lgkmcnt(2)
  v_cvt_pk_bf16_f32 v66, v68, v69
  v_add_u32 v4, 0x15000, v4
  v_mfma_f32_16x16x32_bf16 v[76:79], a[36:39], a[84:87], v[76:79]
  s_waitcnt lgkmcnt(1)
  v_exp_f32 v70, v70
  v_mfma_f32_16x16x32_bf16 v[76:79], a[40:43], a[96:99], v[76:79]
  s_waitcnt lgkmcnt(0)
  v_add_u32 v5, 0x15000, v5
  v_add_u32 v6, 0x15000, v6
  v_mfma_f32_16x16x32_bf16 v[76:79], a[44:47], a[108:111], v[76:79]
  v_add_u32 v7, 0x15000, v7
  v_mfma_f32_16x16x32_bf16 v[84:87], a[24:27], a[52:55], v[36:39]
  s_nop 0
  ds_read_b64_tr_b16 a[0:1], v4 offset:0
  ds_read_b64_tr_b16 a[2:3], v4 offset:6144
  v_mfma_f32_16x16x32_bf16 v[84:87], a[28:31], a[64:67], v[84:87]
  v_exp_f32 v71, v71
  v_mfma_f32_16x16x32_bf16 v[84:87], a[32:35], a[76:79], v[84:87]
  v_exp_f32 v72, v72
  v_mfma_f32_16x16x32_bf16 v[84:87], a[36:39], a[88:91], v[84:87]
  v_exp_f32 v73, v73
  v_mfma_f32_16x16x32_bf16 v[84:87], a[40:43], a[100:103], v[84:87]
  v_exp_f32 v74, v74
  v_mfma_f32_16x16x32_bf16 v[84:87], a[44:47], a[112:115], v[84:87]
  v_exp_f32 v75, v75
  v_mfma_f32_16x16x32_bf16 v[92:95], a[24:27], a[56:59], v[40:43]
  v_exp_f32 v76, v76
  v_mfma_f32_16x16x32_bf16 v[92:95], a[28:31], a[68:71], v[92:95]
  v_exp_f32 v77, v77
  v_mfma_f32_16x16x32_bf16 v[92:95], a[32:35], a[80:83], v[92:95]
  s_nop 0
  ds_read_b64_tr_b16 a[4:5], v5 offset:0
  ds_read_b64_tr_b16 a[6:7], v5 offset:6144
  v_mfma_f32_16x16x32_bf16 v[92:95], a[36:39], a[92:95], v[92:95]
  v_exp_f32 v78, v78
  v_mfma_f32_16x16x32_bf16 v[92:95], a[40:43], a[104:107], v[92:95]
  v_pk_add_f32 v[2:3], v[2:3], v[70:71]
  v_cvt_pk_bf16_f32 v67, v70, v71
  v_mfma_f32_16x16x32_bf16 v[92:95], a[44:47], a[116:119], v[92:95]
  s_waitcnt lgkmcnt(2)
  ds_read_b64_tr_b16 a[8:9], v6 offset:0
  ds_read_b64_tr_b16 a[10:11], v6 offset:6144
  v_mfma_f32_16x16x32_bf16 v[96:99], a[0:3], v[48:51], v[96:99]
  v_pk_add_f32 v[252:253], v[252:253], v[72:73]
  v_mfma_f32_16x16x32_bf16 v[100:103], a[0:3], v[56:59], v[100:103]
  ds_read_b64_tr_b16 a[12:13], v7 offset:0
  v_cvt_pk_bf16_f32 v72, v72, v73
  v_mfma_f32_16x16x32_bf16 v[104:107], a[0:3], v[64:67], v[104:107]
  s_waitcnt lgkmcnt(3)
  ds_read_b64_tr_b16 a[14:15], v7 offset:6144
  ds_read_b64_tr_b16 a[16:17], v4 offset:1024
  v_mfma_f32_16x16x32_bf16 v[116:119], a[4:7], v[64:67], v[116:119]
  v_pk_add_f32 v[252:253], v[252:253], v[74:75]
  v_mfma_f32_16x16x32_bf16 v[112:115], a[4:7], v[56:59], v[112:115]
  ds_read_b64_tr_b16 a[18:19], v4 offset:7168
  v_cvt_pk_bf16_f32 v73, v74, v75
  v_mfma_f32_16x16x32_bf16 v[108:111], a[4:7], v[48:51], v[108:111]
  s_waitcnt lgkmcnt(4)
  v_pk_add_f32 v[252:253], v[252:253], v[76:77]
  v_mfma_f32_16x16x32_bf16 v[120:123], a[8:11], v[48:51], v[120:123]
  ds_read_b64_tr_b16 a[20:21], v5 offset:1024
  v_cvt_pk_bf16_f32 v74, v76, v77
  v_mfma_f32_16x16x32_bf16 v[124:127], a[8:11], v[56:59], v[124:127]
  v_exp_f32 v79, v79
  v_mfma_f32_16x16x32_bf16 v[128:131], a[8:11], v[64:67], v[128:131]
  s_waitcnt lgkmcnt(3)
  ds_read_b64_tr_b16 a[22:23], v5 offset:7168
  ds_read_b64_tr_b16 a[24:25], v6 offset:1024
  v_mfma_f32_16x16x32_bf16 v[140:143], a[12:15], v[64:67], v[140:143]
  v_pk_add_f32 v[252:253], v[252:253], v[78:79]
  v_mfma_f32_16x16x32_bf16 v[136:139], a[12:15], v[56:59], v[136:139]
  ds_read_b64_tr_b16 a[26:27], v6 offset:7168
  v_cvt_pk_bf16_f32 v75, v78, v79
  v_mfma_f32_16x16x32_bf16 v[132:135], a[12:15], v[48:51], v[132:135]
  s_waitcnt lgkmcnt(4)
  v_exp_f32 v80, v80
  v_mfma_f32_16x16x32_bf16 v[144:147], a[16:19], v[48:51], v[144:147]
  v_exp_f32 v81, v81
  v_mfma_f32_16x16x32_bf16 v[148:151], a[16:19], v[56:59], v[148:151]
  v_pk_add_f32 v[254:255], v[254:255], v[80:81]
  v_mfma_f32_16x16x32_bf16 v[152:155], a[16:19], v[64:67], v[152:155]
  s_waitcnt lgkmcnt(2)
  ds_read_b64_tr_b16 a[28:29], v7 offset:1024
  ds_read_b64_tr_b16 a[30:31], v7 offset:7168
  v_mfma_f32_16x16x32_bf16 v[164:167], a[20:23], v[64:67], v[164:167]
  ds_read_b64_tr_b16 a[32:33], v4 offset:2048
  v_cvt_pk_bf16_f32 v80, v80, v81
  v_mfma_f32_16x16x32_bf16 v[160:163], a[20:23], v[56:59], v[160:163]
  v_exp_f32 v82, v82
  v_mfma_f32_16x16x32_bf16 v[156:159], a[20:23], v[48:51], v[156:159]
  s_waitcnt lgkmcnt(3)
  ds_read_b64_tr_b16 a[34:35], v4 offset:8192
  ds_read_b64_tr_b16 a[36:37], v5 offset:2048
  v_mfma_f32_16x16x32_bf16 v[168:171], a[24:27], v[48:51], v[168:171]
  v_exp_f32 v83, v83
  v_mfma_f32_16x16x32_bf16 v[172:175], a[24:27], v[56:59], v[172:175]
  v_pk_add_f32 v[254:255], v[254:255], v[82:83]
  v_mfma_f32_16x16x32_bf16 v[176:179], a[24:27], v[64:67], v[176:179]
  s_waitcnt lgkmcnt(3)
  ds_read_b64_tr_b16 a[38:39], v5 offset:8192
  v_cvt_pk_bf16_f32 v81, v82, v83
  v_mfma_f32_16x16x32_bf16 v[188:191], a[28:31], v[64:67], v[188:191]
  v_exp_f32 v84, v84
  v_mfma_f32_16x16x32_bf16 v[184:187], a[28:31], v[56:59], v[184:187]
  s_waitcnt vmcnt(6)
  s_barrier
  ds_read_b64_tr_b16 a[40:41], v6 offset:2048
  v_mfma_f32_16x16x32_bf16 v[180:183], a[28:31], v[48:51], v[180:183]
  s_waitcnt lgkmcnt(3)
  s_add_u32 s46, s70, 0xa000
  ds_read_b64_tr_b16 a[42:43], v6 offset:8192
  v_mfma_f32_16x16x32_bf16 v[192:195], a[32:35], v[48:51], v[192:195]
  s_add_u32 m0, s37, 0x6000
  v_exp_f32 v85, v85
  v_mfma_f32_16x16x32_bf16 v[196:199], a[32:35], v[56:59], v[196:199]
  buffer_load_dwordx4 v15, s[20:23], s46 offen lds
  v_mfma_f32_16x16x32_bf16 v[200:203], a[32:35], v[64:67], v[200:203]
  s_waitcnt lgkmcnt(2)
  ds_read_b64_tr_b16 a[44:45], v7 offset:2048
  ds_read_b64_tr_b16 a[46:47], v7 offset:8192
  v_mfma_f32_16x16x32_bf16 v[212:215], a[36:39], v[64:67], v[212:215]
  s_add_u32 m0, s37, 0x6380
  v_pk_add_f32 v[254:255], v[254:255], v[84:85]
  v_mfma_f32_16x16x32_bf16 v[208:211], a[36:39], v[56:59], v[208:211]
  buffer_load_dwordx4 v15, s[20:23], s46 offen offset:128 lds
  v_mfma_f32_16x16x32_bf16 v[204:207], a[36:39], v[48:51], v[204:207]
  s_waitcnt lgkmcnt(2)
  ds_read_b64_tr_b16 a[0:1], v4 offset:12288
  ds_read_b64_tr_b16 a[2:3], v4 offset:18432
  v_mfma_f32_16x16x32_bf16 v[216:219], a[40:43], v[48:51], v[216:219]
  s_add_u32 m0, s37, 0x6700
  v_exp_f32 v86, v86
  v_mfma_f32_16x16x32_bf16 v[220:223], a[40:43], v[56:59], v[220:223]
  buffer_load_dwordx4 v16, s[20:23], s46 offen offset:256 lds
  v_mfma_f32_16x16x32_bf16 v[224:227], a[40:43], v[64:67], v[224:227]
  s_waitcnt lgkmcnt(2)
  ds_read_b64_tr_b16 a[4:5], v5 offset:12288
  ds_read_b64_tr_b16 a[6:7], v5 offset:18432
  v_mfma_f32_16x16x32_bf16 v[236:239], a[44:47], v[64:67], v[236:239]
  v_exp_f32 v87, v87
  v_exp_f32 v88, v88
  v_exp_f32 v89, v89
  v_exp_f32 v90, v90
  v_exp_f32 v91, v91
  v_exp_f32 v92, v92
  v_exp_f32 v93, v93
  v_exp_f32 v94, v94
  v_exp_f32 v95, v95
  v_mfma_f32_16x16x32_bf16 v[232:235], a[44:47], v[56:59], v[232:235]
  v_cvt_pk_bf16_f32 v82, v84, v85
  v_pk_add_f32 v[254:255], v[254:255], v[86:87]
  v_cvt_pk_bf16_f32 v83, v86, v87
  v_pk_add_f32 v[2:3], v[2:3], v[88:89]
  v_cvt_pk_bf16_f32 v88, v88, v89
  v_pk_add_f32 v[2:3], v[2:3], v[90:91]
  v_cvt_pk_bf16_f32 v89, v90, v91
  v_pk_add_f32 v[2:3], v[2:3], v[92:93]
  v_cvt_pk_bf16_f32 v90, v92, v93
  v_pk_add_f32 v[2:3], v[2:3], v[94:95]
  v_cvt_pk_bf16_f32 v91, v94, v95
  v_mfma_f32_16x16x32_bf16 v[228:231], a[44:47], v[48:51], v[228:231]
  s_waitcnt lgkmcnt(2)
  ds_read_b64_tr_b16 a[8:9], v6 offset:12288
  ds_read_b64_tr_b16 a[10:11], v6 offset:18432
  v_mfma_f32_16x16x32_bf16 v[96:99], a[0:3], v[72:75], v[96:99]
  s_add_u32 s47, s71, 0
  s_add_u32 m0, s37, 0xc000
  ds_read_b64_tr_b16 a[12:13], v7 offset:12288
  v_mfma_f32_16x16x32_bf16 v[100:103], a[0:3], v[80:83], v[100:103]
  buffer_load_dwordx4 v15, s[20:23], s47 offen lds
  v_mfma_f32_16x16x32_bf16 v[104:107], a[0:3], v[88:91], v[104:107]
  s_waitcnt lgkmcnt(3)
  ds_read_b64_tr_b16 a[14:15], v7 offset:18432
  v_add_f32 v28, v28, v252
  v_mfma_f32_16x16x32_bf16 v[116:119], a[4:7], v[88:91], v[116:119]
  v_add_f32 v28, v28, v253
  v_add_f32 v29, v29, v254
  v_mfma_f32_16x16x32_bf16 v[112:115], a[4:7], v[80:83], v[112:115]
  v_add_f32 v29, v29, v255
  v_add_f32 v30, v30, v2
  v_mfma_f32_16x16x32_bf16 v[108:111], a[4:7], v[72:75], v[108:111]
  s_waitcnt lgkmcnt(2)
  ds_read_b64_tr_b16 a[16:17], v4 offset:13312
  ds_read_b64_tr_b16 a[18:19], v4 offset:19456
  v_mfma_f32_16x16x32_bf16 v[120:123], a[8:11], v[72:75], v[120:123]
  s_add_u32 m0, s37, 0xc380
  v_add_f32 v30, v30, v3
  v_mov_b32 v20, v28
  v_mfma_f32_16x16x32_bf16 v[124:127], a[8:11], v[80:83], v[124:127]
  buffer_load_dwordx4 v15, s[20:23], s47 offen offset:128 lds
  v_mfma_f32_16x16x32_bf16 v[128:131], a[8:11], v[88:91], v[128:131]
  s_waitcnt lgkmcnt(2)
  ds_read_b64_tr_b16 a[20:21], v5 offset:13312
  ds_read_b64_tr_b16 a[22:23], v5 offset:19456
  v_mfma_f32_16x16x32_bf16 v[140:143], a[12:15], v[88:91], v[140:143]
  v_mov_b32 v21, v29
  v_mov_b32 v22, v30
  v_mfma_f32_16x16x32_bf16 v[136:139], a[12:15], v[80:83], v[136:139]
  v_permlane32_swap_b32 v28, v20
  v_mfma_f32_16x16x32_bf16 v[132:135], a[12:15], v[72:75], v[132:135]
  s_waitcnt lgkmcnt(2)
  ds_read_b64_tr_b16 a[24:25], v6 offset:13312
  ds_read_b64_tr_b16 a[26:27], v6 offset:19456
  v_mfma_f32_16x16x32_bf16 v[144:147], a[16:19], v[72:75], v[144:147]
  v_permlane32_swap_b32 v29, v21
  v_mfma_f32_16x16x32_bf16 v[148:151], a[16:19], v[80:83], v[148:151]
  v_permlane32_swap_b32 v30, v22
  v_mfma_f32_16x16x32_bf16 v[152:155], a[16:19], v[88:91], v[152:155]
  s_waitcnt lgkmcnt(2)
  ds_read_b64_tr_b16 a[28:29], v7 offset:13312
  ds_read_b64_tr_b16 a[30:31], v7 offset:19456
  v_mfma_f32_16x16x32_bf16 v[164:167], a[20:23], v[88:91], v[164:167]
  v_add_f32 v28, v28, v20
  v_mov_b32 v20, v28
  v_mfma_f32_16x16x32_bf16 v[160:163], a[20:23], v[80:83], v[160:163]
  v_add_f32 v29, v29, v21
  v_mov_b32 v21, v29
  v_mfma_f32_16x16x32_bf16 v[156:159], a[20:23], v[72:75], v[156:159]
  s_waitcnt lgkmcnt(2)
  ds_read_b64_tr_b16 a[32:33], v4 offset:14336
  ds_read_b64_tr_b16 a[34:35], v4 offset:20480
  v_mfma_f32_16x16x32_bf16 v[168:171], a[24:27], v[72:75], v[168:171]
  s_add_u32 s49, s64, 0
  v_add_f32 v30, v30, v22
  v_mov_b32 v22, v30
  v_mfma_f32_16x16x32_bf16 v[172:175], a[24:27], v[80:83], v[172:175]
  v_permlane16_swap_b32 v28, v20
  v_mfma_f32_16x16x32_bf16 v[176:179], a[24:27], v[88:91], v[176:179]
  s_waitcnt lgkmcnt(2)
  ds_read_b64_tr_b16 a[36:37], v5 offset:14336
  ds_read_b64_tr_b16 a[38:39], v5 offset:20480
  v_mfma_f32_16x16x32_bf16 v[188:191], a[28:31], v[88:91], v[188:191]
  v_permlane16_swap_b32 v29, v21
  v_permlane16_swap_b32 v30, v22
  v_add_f32 v28, v28, v20
  v_add_f32 v29, v29, v21
  v_add_f32 v30, v30, v22
  v_max3_f32 v23, v28, v29, v30
  v_cmp_lt_f32 vcc, 0x53800000, v23
  s_lshl_b32 s53, s36, 2
  v_mov_b32 v24, s53
  s_or_b32 s53, vcc_lo, vcc_hi
  v_add_u32 v24, 0x27000, v24
  v_mov_b32 v23, s53
  ds_write_b32 v24, v23
  v_mfma_f32_16x16x32_bf16 v[184:187], a[28:31], v[80:83], v[184:187]
  s_waitcnt lgkmcnt(0)
  s_barrier
  ds_read_b64_tr_b16 a[40:41], v6 offset:14336
  v_mfma_f32_16x16x32_bf16 v[180:183], a[28:31], v[72:75], v[180:183]
  s_add_u32 m0, s37, 0xc700
  ds_read_b64_tr_b16 a[42:43], v6 offset:20480
  v_mfma_f32_16x16x32_bf16 v[192:195], a[32:35], v[72:75], v[192:195]
  buffer_load_dwordx4 v16, s[20:23], s47 offen offset:256 lds
  v_mfma_f32_16x16x32_bf16 v[196:199], a[32:35], v[80:83], v[196:199]
  v_rcp_f32 v32, v28
  v_mfma_f32_16x16x32_bf16 v[200:203], a[32:35], v[88:91], v[200:203]
  ds_read_b64_tr_b16 a[44:45], v7 offset:14336
  ds_read_b64_tr_b16 a[46:47], v7 offset:20480
  v_mov_b32 v24, 0x27000
  ds_read_b128 v[240:243], v24 offset:0
  v_mfma_f32_16x16x32_bf16 v[212:215], a[36:39], v[88:91], v[212:215]
  v_rcp_f32 v33, v29
  v_mfma_f32_16x16x32_bf16 v[208:211], a[36:39], v[80:83], v[208:211]
  v_add_u32 v4, 0xffff1000, v4
  v_add_u32 v5, 0xffff1000, v5
  v_add_u32 v6, 0xffff1000, v6
  v_add_u32 v7, 0xffff1000, v7
  v_mfma_f32_16x16x32_bf16 v[204:207], a[36:39], v[72:75], v[204:207]
  s_waitcnt lgkmcnt(3)
  ds_read_b64_tr_b16 a[0:1], v4 offset:0
  ds_read_b64_tr_b16 a[2:3], v4 offset:6144
  v_mfma_f32_16x16x32_bf16 v[216:219], a[40:43], v[72:75], v[216:219]
  v_rcp_f32 v34, v30
  s_mul_i32 s48, s36, 0x4800
  v_mfma_f32_16x16x32_bf16 v[220:223], a[40:43], v[80:83], v[220:223]
  v_add_u32 v13, s48, v19
  v_mul_f32 v96, v32, v96
  v_mfma_f32_16x16x32_bf16 v[224:227], a[40:43], v[88:91], v[224:227]
  s_waitcnt lgkmcnt(3)
  ds_read_b64_tr_b16 a[4:5], v5 offset:0
  ds_read_b64_tr_b16 a[6:7], v5 offset:6144
  v_mfma_f32_16x16x32_bf16 v[236:239], a[44:47], v[88:91], v[236:239]
  v_mul_f32 v97, v32, v97
  v_cvt_pk_bf16_f32 v48, v96, v97
  v_mfma_f32_16x16x32_bf16 v[232:235], a[44:47], v[80:83], v[232:235]
  v_mul_f32 v98, v32, v98
  v_mul_f32 v99, v32, v99
  v_cvt_pk_bf16_f32 v49, v98, v99
  v_mul_f32 v108, v32, v108
  v_mul_f32 v109, v32, v109
  v_cvt_pk_bf16_f32 v50, v108, v109
  v_mul_f32 v110, v32, v110
  v_mul_f32 v111, v32, v111
  v_cvt_pk_bf16_f32 v51, v110, v111
  v_mul_f32 v100, v33, v100
  v_mul_f32 v101, v33, v101
  v_cvt_pk_bf16_f32 v52, v100, v101
  v_mul_f32 v102, v33, v102
  v_mul_f32 v103, v33, v103
  v_cvt_pk_bf16_f32 v53, v102, v103
  v_mul_f32 v112, v33, v112
  v_mul_f32 v113, v33, v113
  v_cvt_pk_bf16_f32 v54, v112, v113
  v_mul_f32 v114, v33, v114
  v_mul_f32 v115, v33, v115
  v_cvt_pk_bf16_f32 v55, v114, v115
  v_mul_f32 v104, v34, v104
  v_mul_f32 v105, v34, v105
  v_cvt_pk_bf16_f32 v56, v104, v105
  v_mul_f32 v106, v34, v106
  v_mul_f32 v107, v34, v107
  v_cvt_pk_bf16_f32 v57, v106, v107
  v_mul_f32 v116, v34, v116
  v_mul_f32 v117, v34, v117
  v_cvt_pk_bf16_f32 v58, v116, v117
  v_mul_f32 v118, v34, v118
  v_mul_f32 v119, v34, v119
  v_cvt_pk_bf16_f32 v59, v118, v119
  s_waitcnt lgkmcnt(4)
  v_or3_b32 v23, v240, v241, v242
  v_or_b32 v23, v23, v243
  v_mfma_f32_16x16x32_bf16 v[228:231], a[44:47], v[72:75], v[228:231]
  ds_read_b64_tr_b16 a[8:9], v6 offset:0
  ds_read_b64_tr_b16 a[10:11], v6 offset:6144
  v_cmp_ne_u32 vcc, 0, v23
  s_nop 0
  s_cbranch_vccnz L_redo
L_redo_back:
  s_waitcnt lgkmcnt(4)
  v_mfma_f32_16x16x32_bf16 a[40:43], a[0:3], v[48:51], 0
  buffer_store_dwordx4 v[48:51], v13, s[24:27], s49 offen sc1
  v_mfma_f32_16x16x32_bf16 a[44:47], a[0:3], v[52:55], 0
  buffer_store_dwordx4 v[52:55], v13, s[24:27], s49 offen offset:1024 sc1
  v_mfma_f32_16x16x32_bf16 a[48:51], a[0:3], v[56:59], 0
  s_waitcnt lgkmcnt(2)
  ds_read_b64_tr_b16 a[12:13], v7 offset:0
  ds_read_b64_tr_b16 a[14:15], v7 offset:6144
  v_mfma_f32_16x16x32_bf16 a[60:63], a[4:7], v[56:59], 0
  buffer_store_dwordx4 v[56:59], v13, s[24:27], s49 offen offset:2048 sc1
  v_mfma_f32_16x16x32_bf16 a[56:59], a[4:7], v[52:55], 0
  v_mul_f32 v120, v32, v120
  v_mul_f32 v121, v32, v121
  v_cvt_pk_bf16_f32 v60, v120, v121
  v_mul_f32 v122, v32, v122
  v_mul_f32 v123, v32, v123
  v_cvt_pk_bf16_f32 v61, v122, v123
  v_mul_f32 v132, v32, v132
  v_mul_f32 v133, v32, v133
  v_cvt_pk_bf16_f32 v62, v132, v133
  v_mul_f32 v134, v32, v134
  v_mul_f32 v135, v32, v135
  v_cvt_pk_bf16_f32 v63, v134, v135
  v_mul_f32 v124, v33, v124
  v_mul_f32 v125, v33, v125
  v_cvt_pk_bf16_f32 v64, v124, v125
  v_mul_f32 v126, v33, v126
  v_mul_f32 v127, v33, v127
  v_cvt_pk_bf16_f32 v65, v126, v127
  v_mul_f32 v136, v33, v136
  v_mul_f32 v137, v33, v137
  v_cvt_pk_bf16_f32 v66, v136, v137
  v_mul_f32 v138, v33, v138
  v_mul_f32 v139, v33, v139
  v_cvt_pk_bf16_f32 v67, v138, v139
  v_mul_f32 v128, v34, v128
  v_mul_f32 v129, v34, v129
  v_cvt_pk_bf16_f32 v68, v128, v129
  v_mul_f32 v130, v34, v130
  v_mul_f32 v131, v34, v131
  v_cvt_pk_bf16_f32 v69, v130, v131
  v_mul_f32 v140, v34, v140
  v_mul_f32 v141, v34, v141
  v_cvt_pk_bf16_f32 v70, v140, v141
  v_mul_f32 v142, v34, v142
  v_mul_f32 v143, v34, v143
  v_cvt_pk_bf16_f32 v71, v142, v143
  v_mfma_f32_16x16x32_bf16 a[52:55], a[4:7], v[48:51], 0
  s_waitcnt lgkmcnt(2)
  ds_read_b64_tr_b16 a[16:17], v4 offset:1024
  ds_read_b64_tr_b16 a[18:19], v4 offset:7168
  v_mfma_f32_16x16x32_bf16 a[64:67], a[8:11], v[48:51], 0
  buffer_store_dwordx4 v[60:63], v13, s[24:27], s49 offen offset:3072 sc1
  v_mfma_f32_16x16x32_bf16 a[68:71], a[8:11], v[52:55], 0
  s_add_u32 s49, s64, 0x1000
  v_mul_f32 v144, v32, v144
  v_mul_f32 v145, v32, v145
  v_mfma_f32_16x16x32_bf16 a[72:75], a[8:11], v[56:59], 0
  s_waitcnt lgkmcnt(2)
  ds_read_b64_tr_b16 a[20:21], v5 offset:1024
  ds_read_b64_tr_b16 a[22:23], v5 offset:7168
  v_mfma_f32_16x16x32_bf16 a[84:87], a[12:15], v[56:59], 0
  buffer_store_dwordx4 v[64:67], v13, s[24:27], s49 offen sc1
  v_mfma_f32_16x16x32_bf16 a[80:83], a[12:15], v[52:55], 0
  buffer_store_dwordx4 v[68:71], v13, s[24:27], s49 offen offset:1024 sc1
  v_mfma_f32_16x16x32_bf16 a[76:79], a[12:15], v[48:51], 0
  s_waitcnt lgkmcnt(2)
  ds_read_b64_tr_b16 a[24:25], v6 offset:1024
  ds_read_b64_tr_b16 a[26:27], v6 offset:7168
  v_mfma_f32_16x16x32_bf16 a[88:91], a[16:19], v[48:51], 0
  v_cvt_pk_bf16_f32 v72, v144, v145
  v_mul_f32 v146, v32, v146
  v_mfma_f32_16x16x32_bf16 a[92:95], a[16:19], v[52:55], 0
  v_mul_f32 v147, v32, v147
  v_cvt_pk_bf16_f32 v73, v146, v147
  v_mfma_f32_16x16x32_bf16 a[96:99], a[16:19], v[56:59], 0
  s_waitcnt lgkmcnt(2)
  ds_read_b64_tr_b16 a[28:29], v7 offset:1024
  ds_read_b64_tr_b16 a[30:31], v7 offset:7168
  v_mfma_f32_16x16x32_bf16 a[108:111], a[20:23], v[56:59], 0
  v_mul_f32 v156, v32, v156
  v_mul_f32 v157, v32, v157
  v_mfma_f32_16x16x32_bf16 a[104:107], a[20:23], v[52:55], 0
  s_barrier
  v_cvt_pk_bf16_f32 v74, v156, v157
  v_mfma_f32_16x16x32_bf16 a[100:103], a[20:23], v[48:51], 0
  s_waitcnt lgkmcnt(2)
  ds_read_b64_tr_b16 a[32:33], v4 offset:2048
  ds_read_b64_tr_b16 a[34:35], v4 offset:8192
  v_mfma_f32_16x16x32_bf16 a[112:115], a[24:27], v[48:51], 0
  v_mul_f32 v158, v32, v158
  v_mul_f32 v159, v32, v159
  v_mfma_f32_16x16x32_bf16 a[116:119], a[24:27], v[52:55], 0
  v_cvt_pk_bf16_f32 v75, v158, v159
  v_mul_f32 v148, v33, v148
  v_mfma_f32_16x16x32_bf16 a[120:123], a[24:27], v[56:59], 0
  s_waitcnt lgkmcnt(2)
  ds_read_b64_tr_b16 a[36:37], v5 offset:2048
  ds_read_b64_tr_b16 a[38:39], v5 offset:8192
  v_mfma_f32_16x16x32_bf16 a[132:135], a[28:31], v[56:59], 0
  v_mul_f32 v149, v33, v149
  v_cvt_pk_bf16_f32 v76, v148, v149
  v_mfma_f32_16x16x32_bf16 a[128:131], a[28:31], v[52:55], 0
  v_mul_f32 v150, v33, v150
  v_mul_f32 v151, v33, v151
  v_mfma_f32_16x16x32_bf16 a[124:127], a[28:31], v[48:51], 0
  s_waitcnt lgkmcnt(2)
  ds_read_b64_tr_b16 a[0:1], v4 offset:24576
  ds_read_b64_tr_b16 a[2:3], v4 offset:30720
  v_mfma_f32_16x16x32_bf16 a[136:139], a[32:35], v[48:51], 0
  v_cvt_pk_bf16_f32 v77, v150, v151
  v_mul_f32 v160, v33, v160
  v_mfma_f32_16x16x32_bf16 a[140:143], a[32:35], v[52:55], 0
  v_mul_f32 v161, v33, v161
  v_cvt_pk_bf16_f32 v78, v160, v161
  v_mfma_f32_16x16x32_bf16 a[144:147], a[32:35], v[56:59], 0
  s_waitcnt lgkmcnt(2)
  ds_read_b64_tr_b16 a[4:5], v5 offset:24576
  ds_read_b64_tr_b16 a[6:7], v5 offset:30720
  v_mfma_f32_16x16x32_bf16 a[156:159], a[36:39], v[56:59], 0
  v_mul_f32 v162, v33, v162
  v_mul_f32 v163, v33, v163
  v_mfma_f32_16x16x32_bf16 a[152:155], a[36:39], v[52:55], 0
  v_cvt_pk_bf16_f32 v79, v162, v163
  v_mul_f32 v152, v34, v152
  v_mfma_f32_16x16x32_bf16 a[148:151], a[36:39], v[48:51], 0
  s_waitcnt lgkmcnt(2)
  ds_read_b64_tr_b16 a[8:9], v6 offset:24576
  ds_read_b64_tr_b16 a[10:11], v6 offset:30720
  v_mfma_f32_16x16x32_bf16 a[40:43], a[0:3], v[60:63], a[40:43]
  v_mul_f32 v153, v34, v153
  v_cvt_pk_bf16_f32 v80, v152, v153
  v_mfma_f32_16x16x32_bf16 a[44:47], a[0:3], v[64:67], a[44:47]
  v_mul_f32 v154, v34, v154
  v_mul_f32 v155, v34, v155
  v_mfma_f32_16x16x32_bf16 a[48:51], a[0:3], v[68:71], a[48:51]
  s_waitcnt lgkmcnt(2)
  ds_read_b64_tr_b16 a[12:13], v7 offset:24576
L_hop9:
  s_cbranch_execz L_hop_ret
  ds_read_b64_tr_b16 a[14:15], v7 offset:30720
  v_mfma_f32_16x16x32_bf16 a[60:63], a[4:7], v[68:71], a[60:63]
  v_cvt_pk_bf16_f32 v81, v154, v155
  v_mul_f32 v164, v34, v164
  v_mfma_f32_16x16x32_bf16 a[56:59], a[4:7], v[64:67], a[56:59]
  v_mul_f32 v165, v34, v165
  v_cvt_pk_bf16_f32 v82, v164, v165
  v_mfma_f32_16x16x32_bf16 a[52:55], a[4:7], v[60:63], a[52:55]
  s_waitcnt lgkmcnt(2)
  ds_read_b64_tr_b16 a[16:17], v4 offset:25600
  ds_read_b64_tr_b16 a[18:19], v4 offset:31744
  v_mfma_f32_16x16x32_bf16 a[64:67], a[8:11], v[60:63], a[64:67]
  v_mul_f32 v166, v34, v166
  v_mul_f32 v167, v34, v167
  v_mfma_f32_16x16x32_bf16 a[68:71], a[8:11], v[64:67], a[68:71]
  v_cvt_pk_bf16_f32 v83, v166, v167
  v_mul_f32 v168, v32, v168
  v_mfma_f32_16x16x32_bf16 a[72:75], a[8:11], v[68:71], a[72:75]
  s_waitcnt lgkmcnt(2)
  ds_read_b64_tr_b16 a[20:21], v5 offset:25600
  ds_read_b64_tr_b16 a[22:23], v5 offset:31744
  v_mfma_f32_16x16x32_bf16 a[84:87], a[12:15], v[68:71], a[84:87]
  v_mul_f32 v169, v32, v169
  v_cvt_pk_bf16_f32 v84, v168, v169
  v_mfma_f32_16x16x32_bf16 a[80:83], a[12:15], v[64:67], a[80:83]
  v_mul_f32 v170, v32, v170
  v_mul_f32 v171, v32, v171
  v_mfma_f32_16x16x32_bf16 a[76:79], a[12:15], v[60:63], a[76:79]
  s_waitcnt lgkmcnt(2)
  ds_read_b64_tr_b16 a[24:25], v6 offset:25600
  ds_read_b64_tr_b16 a[26:27], v6 offset:31744
  v_mfma_f32_16x16x32_bf16 a[88:91], a[16:19], v[60:63], a[88:91]
  v_cvt_pk_bf16_f32 v85, v170, v171
  v_mul_f32 v180, v32, v180
  v_mfma_f32_16x16x32_bf16 a[92:95], a[16:19], v[64:67], a[92:95]
  v_mul_f32 v181, v32, v181
  v_cvt_pk_bf16_f32 v86, v180, v181
  v_mfma_f32_16x16x32_bf16 a[96:99], a[16:19], v[68:71], a[96:99]
  s_waitcnt lgkmcnt(2)
  ds_read_b64_tr_b16 a[28:29], v7 offset:25600
  ds_read_b64_tr_b16 a[30:31], v7 offset:31744
  v_mfma_f32_16x16x32_bf16 a[108:111], a[20:23], v[68:71], a[108:111]
  v_mul_f32 v182, v32, v182
  v_mul_f32 v183, v32, v183
  v_mfma_f32_16x16x32_bf16 a[104:107], a[20:23], v[64:67], a[104:107]
  s_barrier
  v_cvt_pk_bf16_f32 v87, v182, v183
  v_mfma_f32_16x16x32_bf16 a[100:103], a[20:23], v[60:63], a[100:103]
  s_waitcnt lgkmcnt(2)
  ds_read_b64_tr_b16 a[32:33], v4 offset:26624
  ds_read_b64_tr_b16 a[34:35], v4 offset:32768
  v_mfma_f32_16x16x32_bf16 a[112:115], a[24:27], v[60:63], a[112:115]
  s_add_u32 s48, s100, 1
  v_mul_f32 v172, v33, v172
  v_mul_f32 v173, v33, v173
  v_mfma_f32_16x16x32_bf16 a[116:119], a[24:27], v[64:67], a[116:119]
  v_cvt_pk_bf16_f32 v88, v172, v173
  v_mul_f32 v174, v33, v174
  v_mfma_f32_16x16x32_bf16 a[120:123], a[24:27], v[68:71], a[120:123]
  s_waitcnt lgkmcnt(2)
  ds_read_b64_tr_b16 a[36:37], v5 offset:26624
  ds_read_b64_tr_b16 a[38:39], v5 offset:32768
  v_mfma_f32_16x16x32_bf16 a[132:135], a[28:31], v[68:71], a[132:135]
  v_mul_f32 v175, v33, v175
  v_cvt_pk_bf16_f32 v89, v174, v175
  v_mfma_f32_16x16x32_bf16 a[128:131], a[28:31], v[64:67], a[128:131]
  v_add_u32 v4, 0xffff7000, v4
  v_add_u32 v5, 0xffff7000, v5
  v_add_u32 v6, 0xffff7000, v6
  v_add_u32 v7, 0xffff7000, v7
  v_mfma_f32_16x16x32_bf16 a[124:127], a[28:31], v[60:63], a[124:127]
  s_waitcnt lgkmcnt(2)
  ds_read_b64_tr_b16 a[0:1], v4 offset:0
  ds_read_b64_tr_b16 a[2:3], v4 offset:6144
  v_mov_b32 v11, s48
  v_mfma_f32_16x16x32_bf16 a[136:139], a[32:35], v[60:63], a[136:139]
  s_waitcnt vmcnt(0)
  v_mul_f32 v184, v33, v184
  v_mul_f32 v185, v33, v185
  v_mfma_f32_16x16x32_bf16 a[140:143], a[32:35], v[64:67], a[140:143]
  buffer_store_dword v11, off, s[60:63], s43 sc1
  v_mfma_f32_16x16x32_bf16 a[144:147], a[32:35], v[68:71], a[144:147]
  s_waitcnt lgkmcnt(2)
  ds_read_b64_tr_b16 a[4:5], v5 offset:0
  ds_read_b64_tr_b16 a[6:7], v5 offset:6144
  v_mfma_f32_16x16x32_bf16 a[156:159], a[36:39], v[68:71], a[156:159]
  v_cvt_pk_bf16_f32 v90, v184, v185
  v_mul_f32 v186, v33, v186
  v_mfma_f32_16x16x32_bf16 a[152:155], a[36:39], v[64:67], a[152:155]
  v_mul_f32 v187, v33, v187
  v_cvt_pk_bf16_f32 v91, v186, v187
  v_mfma_f32_16x16x32_bf16 a[148:151], a[36:39], v[60:63], a[148:151]
  s_waitcnt lgkmcnt(2)
  ds_read_b64_tr_b16 a[8:9], v6 offset:0
  ds_read_b64_tr_b16 a[10:11], v6 offset:6144
  v_mfma_f32_16x16x32_bf16 a[40:43], a[0:3], v[72:75], a[40:43]
  v_mul_f32 v176, v34, v176
  v_mul_f32 v177, v34, v177
  v_mfma_f32_16x16x32_bf16 a[44:47], a[0:3], v[76:79], a[44:47]
  v_cvt_pk_bf16_f32 v92, v176, v177
  v_mul_f32 v178, v34, v178
  v_mfma_f32_16x16x32_bf16 a[48:51], a[0:3], v[80:83], a[48:51]
  s_waitcnt lgkmcnt(2)
  ds_read_b64_tr_b16 a[12:13], v7 offset:0
  ds_read_b64_tr_b16 a[14:15], v7 offset:6144
  v_mfma_f32_16x16x32_bf16 a[60:63], a[4:7], v[80:83], a[60:63]
  buffer_store_dwordx4 v[72:75], v13, s[24:27], s49 offen offset:2048 sc1
  v_mfma_f32_16x16x32_bf16 a[56:59], a[4:7], v[76:79], a[56:59]
  v_mul_f32 v179, v34, v179
  v_cvt_pk_bf16_f32 v93, v178, v179
  v_mfma_f32_16x16x32_bf16 a[52:55], a[4:7], v[72:75], a[52:55]
  s_waitcnt lgkmcnt(2)
  ds_read_b64_tr_b16 a[16:17], v4 offset:1024
  ds_read_b64_tr_b16 a[18:19], v4 offset:7168
  v_mfma_f32_16x16x32_bf16 a[64:67], a[8:11], v[72:75], a[64:67]
  v_mul_f32 v188, v34, v188
  v_mul_f32 v189, v34, v189
  v_mfma_f32_16x16x32_bf16 a[68:71], a[8:11], v[76:79], a[68:71]
  buffer_store_dwordx4 v[76:79], v13, s[24:27], s49 offen offset:3072 sc1
  v_mfma_f32_16x16x32_bf16 a[72:75], a[8:11], v[80:83], a[72:75]
  s_waitcnt lgkmcnt(2)
  ds_read_b64_tr_b16 a[20:21], v5 offset:1024
  ds_read_b64_tr_b16 a[22:23], v5 offset:7168
  v_mfma_f32_16x16x32_bf16 a[84:87], a[12:15], v[80:83], a[84:87]
  v_cvt_pk_bf16_f32 v94, v188, v189
  v_mul_f32 v190, v34, v190
  v_mfma_f32_16x16x32_bf16 a[80:83], a[12:15], v[76:79], a[80:83]
  s_add_u32 s49, s64, 0x2000
  v_mul_f32 v191, v34, v191
  v_cvt_pk_bf16_f32 v95, v190, v191
  v_mfma_f32_16x16x32_bf16 a[76:79], a[12:15], v[72:75], a[76:79]
  s_waitcnt lgkmcnt(2)
  ds_read_b64_tr_b16 a[24:25], v6 offset:1024
  ds_read_b64_tr_b16 a[26:27], v6 offset:7168
  v_mfma_f32_16x16x32_bf16 a[88:91], a[16:19], v[72:75], a[88:91]
  buffer_store_dwordx4 v[80:83], v13, s[24:27], s49 offen sc1
  v_mfma_f32_16x16x32_bf16 a[92:95], a[16:19], v[76:79], a[92:95]
  v_mul_f32 v192, v32, v192
  v_mul_f32 v193, v32, v193
  v_mfma_f32_16x16x32_bf16 a[96:99], a[16:19], v[80:83], a[96:99]
  s_waitcnt lgkmcnt(2)
  ds_read_b64_tr_b16 a[28:29], v7 offset:1024
  ds_read_b64_tr_b16 a[30:31], v7 offset:7168
  v_mfma_f32_16x16x32_bf16 a[108:111], a[20:23], v[80:83], a[108:111]
  v_cvt_pk_bf16_f32 v96, v192, v193
  v_mul_f32 v194, v32, v194
  v_mfma_f32_16x16x32_bf16 a[104:107], a[20:23], v[76:79], a[104:107]
  s_barrier
  v_mul_f32 v195, v32, v195
  v_mfma_f32_16x16x32_bf16 a[100:103], a[20:23], v[72:75], a[100:103]
  s_waitcnt lgkmcnt(2)
  ds_read_b64_tr_b16 a[32:33], v4 offset:2048
  ds_read_b64_tr_b16 a[34:35], v4 offset:8192
  v_mfma_f32_16x16x32_bf16 a[112:115], a[24:27], v[72:75], a[112:115]
  buffer_store_dwordx4 v[84:87], v13, s[24:27], s49 offen offset:1024 sc1
  v_mfma_f32_16x16x32_bf16 a[116:119], a[24:27], v[76:79], a[116:119]
  v_cvt_pk_bf16_f32 v97, v194, v195
  v_mul_f32 v204, v32, v204
  v_mfma_f32_16x16x32_bf16 a[120:123], a[24:27], v[80:83], a[120:123]
  s_waitcnt lgkmcnt(2)
  ds_read_b64_tr_b16 a[36:37], v5 offset:2048
  ds_read_b64_tr_b16 a[38:39], v5 offset:8192
  v_mfma_f32_16x16x32_bf16 a[132:135], a[28:31], v[80:83], a[132:135]
  v_mul_f32 v205, v32, v205
  v_cvt_pk_bf16_f32 v98, v204, v205
  v_mfma_f32_16x16x32_bf16 a[128:131], a[28:31], v[76:79], a[128:131]
  v_add_u32 v4, 0x1e000, v4
  v_add_u32 v5, 0x1e000, v5
  v_add_u32 v6, 0x1e000, v6
  v_add_u32 v7, 0x1e000, v7
  v_mfma_f32_16x16x32_bf16 a[124:127], a[28:31], v[72:75], a[124:127]
  s_waitcnt lgkmcnt(2)
  ds_read_b64_tr_b16 a[0:1], v4 offset:0
  ds_read_b64_tr_b16 a[2:3], v4 offset:6144
  v_mfma_f32_16x16x32_bf16 a[136:139], a[32:35], v[72:75], a[136:139]
  buffer_store_dwordx4 v[88:91], v13, s[24:27], s49 offen offset:2048 sc1
  v_mfma_f32_16x16x32_bf16 a[140:143], a[32:35], v[76:79], a[140:143]
  v_mul_f32 v206, v32, v206
  v_mul_f32 v207, v32, v207
  v_mfma_f32_16x16x32_bf16 a[144:147], a[32:35], v[80:83], a[144:147]
  s_waitcnt lgkmcnt(2)
  ds_read_b64_tr_b16 a[4:5], v5 offset:0
  ds_read_b64_tr_b16 a[6:7], v5 offset:6144
  v_mfma_f32_16x16x32_bf16 a[156:159], a[36:39], v[80:83], a[156:159]
  buffer_store_dwordx4 v[92:95], v13, s[24:27], s49 offen offset:3072 sc1
  v_mfma_f32_16x16x32_bf16 a[152:155], a[36:39], v[76:79], a[152:155]
  v_cvt_pk_bf16_f32 v99, v206, v207
  v_mul_f32 v196, v33, v196
  v_mfma_f32_16x16x32_bf16 a[148:151], a[36:39], v[72:75], a[148:151]
  s_waitcnt lgkmcnt(2)
  ds_read_b64_tr_b16 a[8:9], v6 offset:0
  ds_read_b64_tr_b16 a[10:11], v6 offset:6144
  v_mfma_f32_16x16x32_bf16 a[40:43], a[0:3], v[84:87], a[40:43]
  v_mul_f32 v197, v33, v197
  v_cvt_pk_bf16_f32 v100, v196, v197
  v_mfma_f32_16x16x32_bf16 a[44:47], a[0:3], v[88:91], a[44:47]
  v_mul_f32 v198, v33, v198
  v_mul_f32 v199, v33, v199
  v_mfma_f32_16x16x32_bf16 a[48:51], a[0:3], v[92:95], a[48:51]
  s_waitcnt lgkmcnt(2)
  ds_read_b64_tr_b16 a[12:13], v7 offset:0
  ds_read_b64_tr_b16 a[14:15], v7 offset:6144
  v_mfma_f32_16x16x32_bf16 a[60:63], a[4:7], v[92:95], a[60:63]
  v_cvt_pk_bf16_f32 v101, v198, v199
  v_mul_f32 v208, v33, v208
  v_mfma_f32_16x16x32_bf16 a[56:59], a[4:7], v[88:91], a[56:59]
  v_mul_f32 v209, v33, v209
  v_cvt_pk_bf16_f32 v102, v208, v209
  v_mfma_f32_16x16x32_bf16 a[52:55], a[4:7], v[84:87], a[52:55]
  s_waitcnt lgkmcnt(2)
  ds_read_b64_tr_b16 a[16:17], v4 offset:1024
  ds_read_b64_tr_b16 a[18:19], v4 offset:7168
  v_mfma_f32_16x16x32_bf16 a[64:67], a[8:11], v[84:87], a[64:67]
  v_mul_f32 v210, v33, v210
  v_mul_f32 v211, v33, v211
  v_mfma_f32_16x16x32_bf16 a[68:71], a[8:11], v[88:91], a[68:71]
  v_cvt_pk_bf16_f32 v103, v210, v211
  v_mul_f32 v200, v34, v200
  v_mfma_f32_16x16x32_bf16 a[72:75], a[8:11], v[92:95], a[72:75]
  s_waitcnt lgkmcnt(2)
  ds_read_b64_tr_b16 a[20:21], v5 offset:1024
  ds_read_b64_tr_b16 a[22:23], v5 offset:7168
  v_mfma_f32_16x16x32_bf16 a[84:87], a[12:15], v[92:95], a[84:87]
  v_mul_f32 v201, v34, v201
  v_cvt_pk_bf16_f32 v104, v200, v201
  v_mfma_f32_16x16x32_bf16 a[80:83], a[12:15], v[88:91], a[80:83]
  buffer_load_dword v31, v44, s[60:63], 0 offen sc1
  v_mfma_f32_16x16x32_bf16 a[76:79], a[12:15], v[84:87], a[76:79]
  s_waitcnt lgkmcnt(2)
  ds_read_b64_tr_b16 a[24:25], v6 offset:1024
  ds_read_b64_tr_b16 a[26:27], v6 offset:7168
  v_mfma_f32_16x16x32_bf16 a[88:91], a[16:19], v[84:87], a[88:91]
  s_add_u32 s46, s71, 0xa000
  v_mul_f32 v202, v34, v202
  v_mul_f32 v203, v34, v203
  v_mfma_f32_16x16x32_bf16 a[92:95], a[16:19], v[88:91], a[92:95]
  s_add_u32 m0, s37, 0x18000
  v_cvt_pk_bf16_f32 v105, v202, v203
  v_mul_f32 v212, v34, v212
  v_mfma_f32_16x16x32_bf16 a[96:99], a[16:19], v[92:95], a[96:99]
  s_waitcnt lgkmcnt(2)
  ds_read_b64_tr_b16 a[28:29], v7 offset:1024
  ds_read_b64_tr_b16 a[30:31], v7 offset:7168
  v_mfma_f32_16x16x32_bf16 a[108:111], a[20:23], v[92:95], a[108:111]
  buffer_load_dwordx4 v15, s[20:23], s46 offen lds
  v_mfma_f32_16x16x32_bf16 a[104:107], a[20:23], v[88:91], a[104:107]
  s_barrier
  v_mul_f32 v213, v34, v213
  v_mfma_f32_16x16x32_bf16 a[100:103], a[20:23], v[84:87], a[100:103]
  s_waitcnt lgkmcnt(2)
  ds_read_b64_tr_b16 a[32:33], v4 offset:2048
  ds_read_b64_tr_b16 a[34:35], v4 offset:8192
  v_mfma_f32_16x16x32_bf16 a[112:115], a[24:27], v[84:87], a[112:115]
  s_add_u32 m0, s37, 0x18380
  v_cvt_pk_bf16_f32 v106, v212, v213
  v_mul_f32 v214, v34, v214
  v_mfma_f32_16x16x32_bf16 a[116:119], a[24:27], v[88:91], a[116:119]
  buffer_load_dwordx4 v15, s[20:23], s46 offen offset:128 lds
  v_mfma_f32_16x16x32_bf16 a[120:123], a[24:27], v[92:95], a[120:123]
  s_waitcnt lgkmcnt(2)
  ds_read_b64_tr_b16 a[36:37], v5 offset:2048
  ds_read_b64_tr_b16 a[38:39], v5 offset:8192
  v_mfma_f32_16x16x32_bf16 a[132:135], a[28:31], v[92:95], a[132:135]
  s_add_u32 m0, s37, 0x18700
  v_mul_f32 v215, v34, v215
  v_cvt_pk_bf16_f32 v107, v214, v215
  v_mfma_f32_16x16x32_bf16 a[128:131], a[28:31], v[88:91], a[128:131]
  buffer_load_dwordx4 v16, s[20:23], s46 offen offset:256 lds
  v_mfma_f32_16x16x32_bf16 a[124:127], a[28:31], v[84:87], a[124:127]
  s_waitcnt lgkmcnt(2)
  ds_read_b64_tr_b16 a[0:1], v4 offset:12288
  ds_read_b64_tr_b16 a[2:3], v4 offset:18432
  v_mfma_f32_16x16x32_bf16 a[136:139], a[32:35], v[84:87], a[136:139]
  s_add_u32 s47, s69, 0x14000
  v_mul_f32 v216, v32, v216
  v_mul_f32 v217, v32, v217
  v_mfma_f32_16x16x32_bf16 a[140:143], a[32:35], v[88:91], a[140:143]
  s_add_u32 m0, s37, 0x1b000
  v_cvt_pk_bf16_f32 v108, v216, v217
  v_mul_f32 v218, v32, v218
  v_mfma_f32_16x16x32_bf16 a[144:147], a[32:35], v[92:95], a[144:147]
  s_waitcnt lgkmcnt(2)
  ds_read_b64_tr_b16 a[4:5], v5 offset:12288
  ds_read_b64_tr_b16 a[6:7], v5 offset:18432
  v_mfma_f32_16x16x32_bf16 a[156:159], a[36:39], v[92:95], a[156:159]
  buffer_load_dwordx4 v15, s[20:23], s47 offen lds
  v_mfma_f32_16x16x32_bf16 a[152:155], a[36:39], v[88:91], a[152:155]
  s_add_u32 m0, s37, 0x1b380
  v_mul_f32 v219, v32, v219
  v_cvt_pk_bf16_f32 v109, v218, v219
  v_mfma_f32_16x16x32_bf16 a[148:151], a[36:39], v[84:87], a[148:151]
  s_waitcnt lgkmcnt(2)
  ds_read_b64_tr_b16 a[8:9], v6 offset:12288
  ds_read_b64_tr_b16 a[10:11], v6 offset:18432
  v_mfma_f32_16x16x32_bf16 a[40:43], a[0:3], v[96:99], a[40:43]
  buffer_load_dwordx4 v15, s[20:23], s47 offen offset:128 lds
  v_mfma_f32_16x16x32_bf16 a[44:47], a[0:3], v[100:103], a[44:47]
  s_add_u32 m0, s37, 0x1b700
  v_mul_f32 v228, v32, v228
  v_mul_f32 v229, v32, v229
  v_mfma_f32_16x16x32_bf16 a[48:51], a[0:3], v[104:107], a[48:51]
  s_waitcnt lgkmcnt(2)
  ds_read_b64_tr_b16 a[12:13], v7 offset:12288
  ds_read_b64_tr_b16 a[14:15], v7 offset:18432
  v_mfma_f32_16x16x32_bf16 a[60:63], a[4:7], v[104:107], a[60:63]
  buffer_load_dwordx4 v16, s[20:23], s47 offen offset:256 lds
  v_mfma_f32_16x16x32_bf16 a[56:59], a[4:7], v[100:103], a[56:59]
  v_cvt_pk_bf16_f32 v110, v228, v229
  v_mul_f32 v230, v32, v230
  v_mfma_f32_16x16x32_bf16 a[52:55], a[4:7], v[96:99], a[52:55]
  s_waitcnt lgkmcnt(2)
  ds_read_b64_tr_b16 a[16:17], v4 offset:13312
  ds_read_b64_tr_b16 a[18:19], v4 offset:19456
  v_mfma_f32_16x16x32_bf16 a[64:67], a[8:11], v[96:99], a[64:67]
  s_add_u32 s46, s69, 0x1e000
  v_mul_f32 v231, v32, v231
  v_cvt_pk_bf16_f32 v111, v230, v231
  v_mfma_f32_16x16x32_bf16 a[68:71], a[8:11], v[100:103], a[68:71]
  s_add_u32 m0, s37, 0x9000
  v_mul_f32 v220, v33, v220
  v_mul_f32 v221, v33, v221
  v_mfma_f32_16x16x32_bf16 a[72:75], a[8:11], v[104:107], a[72:75]
  s_waitcnt lgkmcnt(2)
  ds_read_b64_tr_b16 a[20:21], v5 offset:13312
  ds_read_b64_tr_b16 a[22:23], v5 offset:19456
  v_mfma_f32_16x16x32_bf16 a[84:87], a[12:15], v[104:107], a[84:87]
  buffer_load_dwordx4 v15, s[20:23], s46 offen lds
  v_mfma_f32_16x16x32_bf16 a[80:83], a[12:15], v[100:103], a[80:83]
  s_add_u32 m0, s37, 0x9380
  v_cvt_pk_bf16_f32 v112, v220, v221
  v_mul_f32 v222, v33, v222
  v_mfma_f32_16x16x32_bf16 a[76:79], a[12:15], v[96:99], a[76:79]
  s_waitcnt lgkmcnt(2)
  ds_read_b64_tr_b16 a[24:25], v6 offset:13312
  ds_read_b64_tr_b16 a[26:27], v6 offset:19456
  v_mfma_f32_16x16x32_bf16 a[88:91], a[16:19], v[96:99], a[88:91]
  buffer_load_dwordx4 v15, s[20:23], s46 offen offset:128 lds
  v_mfma_f32_16x16x32_bf16 a[92:95], a[16:19], v[100:103], a[92:95]
  s_add_u32 m0, s37, 0x9700
  v_mul_f32 v223, v33, v223
  v_cvt_pk_bf16_f32 v113, v222, v223
  v_mfma_f32_16x16x32_bf16 a[96:99], a[16:19], v[104:107], a[96:99]
  s_waitcnt lgkmcnt(2)
  ds_read_b64_tr_b16 a[28:29], v7 offset:13312
  ds_read_b64_tr_b16 a[30:31], v7 offset:19456
  v_mfma_f32_16x16x32_bf16 a[108:111], a[20:23], v[104:107], a[108:111]
  buffer_load_dwordx4 v16, s[20:23], s46 offen offset:256 lds
  v_mfma_f32_16x16x32_bf16 a[104:107], a[20:23], v[100:103], a[104:107]
  s_barrier
  v_mul_f32 v232, v33, v232
  v_mfma_f32_16x16x32_bf16 a[100:103], a[20:23], v[96:99], a[100:103]
  s_waitcnt lgkmcnt(2)
  ds_read_b64_tr_b16 a[32:33], v4 offset:14336
  ds_read_b64_tr_b16 a[34:35], v4 offset:20480
  v_mfma_f32_16x16x32_bf16 a[112:115], a[24:27], v[96:99], a[112:115]
  s_add_u32 s47, s70, 0x14000
  v_mul_f32 v233, v33, v233
  v_cvt_pk_bf16_f32 v114, v232, v233
  v_mfma_f32_16x16x32_bf16 a[116:119], a[24:27], v[100:103], a[116:119]
  s_add_u32 m0, s37, 0xf000
  v_mul_f32 v234, v33, v234
  v_mul_f32 v235, v33, v235
  v_mfma_f32_16x16x32_bf16 a[120:123], a[24:27], v[104:107], a[120:123]
  s_waitcnt lgkmcnt(2)
  ds_read_b64_tr_b16 a[36:37], v5 offset:14336
  ds_read_b64_tr_b16 a[38:39], v5 offset:20480
  v_mfma_f32_16x16x32_bf16 a[132:135], a[28:31], v[104:107], a[132:135]
  buffer_load_dwordx4 v15, s[20:23], s47 offen lds
  v_mfma_f32_16x16x32_bf16 a[128:131], a[28:31], v[100:103], a[128:131]
  s_add_u32 s48, s100, 2
  v_cvt_pk_bf16_f32 v115, v234, v235
  v_mul_f32 v224, v34, v224
  v_mfma_f32_16x16x32_bf16 a[124:127], a[28:31], v[96:99], a[124:127]
  s_waitcnt lgkmcnt(2)
  ds_read_b64_tr_b16 a[0:1], v4 offset:24576
  ds_read_b64_tr_b16 a[2:3], v4 offset:30720
  v_mfma_f32_16x16x32_bf16 a[136:139], a[32:35], v[96:99], a[136:139]
  v_mul_f32 v225, v34, v225
  v_cvt_pk_bf16_f32 v116, v224, v225
  v_mfma_f32_16x16x32_bf16 a[140:143], a[32:35], v[100:103], a[140:143]
  s_waitcnt vmcnt(10)
  v_sub_u32 v31, v31, v46
  v_cmp_gt_u32 vcc, 1, v31
  s_nop 0
  s_cbranch_vccnz L_poll1_0
L_poll1_0_back:
  v_mfma_f32_16x16x32_bf16 a[144:147], a[32:35], v[104:107], a[144:147]
  s_waitcnt lgkmcnt(2)
  ds_read_b64_tr_b16 a[4:5], v5 offset:24576
  ds_read_b64_tr_b16 a[6:7], v5 offset:30720
  v_mfma_f32_16x16x32_bf16 a[156:159], a[36:39], v[104:107], a[156:159]
  s_add_u32 s50, s65, 0
  v_mul_f32 v226, v34, v226
  v_mul_f32 v227, v34, v227
  v_mfma_f32_16x16x32_bf16 a[152:155], a[36:39], v[100:103], a[152:155]
  v_cvt_pk_bf16_f32 v117, v226, v227
  v_mul_f32 v236, v34, v236
  v_mul_f32 v237, v34, v237
  v_cvt_pk_bf16_f32 v118, v236, v237
  v_mul_f32 v238, v34, v238
  v_mul_f32 v239, v34, v239
  v_cvt_pk_bf16_f32 v119, v238, v239
  v_mov_b32 v11, s48
  v_mfma_f32_16x16x32_bf16 a[148:151], a[36:39], v[96:99], a[148:151]
  s_waitcnt lgkmcnt(2)
  ds_read_b64_tr_b16 a[8:9], v6 offset:24576
  ds_read_b64_tr_b16 a[10:11], v6 offset:30720
  v_mfma_f32_16x16x32_bf16 a[40:43], a[0:3], v[108:111], a[40:43]
  buffer_load_dwordx4 v[120:123], v13, s[24:27], s50 offen sc1
  v_mfma_f32_16x16x32_bf16 a[44:47], a[0:3], v[112:115], a[44:47]
  buffer_store_dword v11, off, s[60:63], s43 sc1
  v_mfma_f32_16x16x32_bf16 a[48:51], a[0:3], v[116:119], a[48:51]
  s_waitcnt lgkmcnt(2)
  ds_read_b64_tr_b16 a[12:13], v7 offset:24576
  ds_read_b64_tr_b16 a[14:15], v7 offset:30720
  v_mfma_f32_16x16x32_bf16 a[60:63], a[4:7], v[116:119], a[60:63]
  buffer_load_dwordx4 v[124:127], v13, s[24:27], s50 offen offset:1024 sc1
  v_mfma_f32_16x16x32_bf16 a[56:59], a[4:7], v[112:115], a[56:59]
  s_nop 0
  ds_read_b64_tr_b16 a[16:17], v4 offset:25600
  ds_read_b64_tr_b16 a[18:19], v4 offset:31744
  v_mfma_f32_16x16x32_bf16 a[52:55], a[4:7], v[108:111], a[52:55]
  s_waitcnt lgkmcnt(4)
  ds_read_b64_tr_b16 a[20:21], v5 offset:25600
  ds_read_b64_tr_b16 a[22:23], v5 offset:31744
  v_mfma_f32_16x16x32_bf16 a[64:67], a[8:11], v[108:111], a[64:67]
  buffer_load_dwordx4 v[128:131], v13, s[24:27], s50 offen offset:2048 sc1
  v_mfma_f32_16x16x32_bf16 a[68:71], a[8:11], v[112:115], a[68:71]
  s_nop 0
  ds_read_b64_tr_b16 a[24:25], v6 offset:25600
  ds_read_b64_tr_b16 a[26:27], v6 offset:31744
  v_mfma_f32_16x16x32_bf16 a[72:75], a[8:11], v[116:119], a[72:75]
  s_waitcnt lgkmcnt(6)
  s_add_u32 s50, s65, 0xc00
  ds_read_b64_tr_b16 a[28:29], v7 offset:25600
  v_mfma_f32_16x16x32_bf16 a[84:87], a[12:15], v[116:119], a[84:87]
  ds_read_b64_tr_b16 a[30:31], v7 offset:31744
  v_mfma_f32_16x16x32_bf16 a[80:83], a[12:15], v[112:115], a[80:83]
  buffer_load_dwordx4 v[132:135], v13, s[24:27], s50 offen sc1
  v_mfma_f32_16x16x32_bf16 a[76:79], a[12:15], v[108:111], a[76:79]
  s_waitcnt lgkmcnt(6)
  ds_read_b64_tr_b16 a[32:33], v4 offset:26624
  ds_read_b64_tr_b16 a[34:35], v4 offset:32768
  v_mfma_f32_16x16x32_bf16 a[88:91], a[16:19], v[108:111], a[88:91]
  v_mfma_f32_16x16x32_bf16 a[92:95], a[16:19], v[112:115], a[92:95]
  v_mfma_f32_16x16x32_bf16 a[96:99], a[16:19], v[116:119], a[96:99]
  s_waitcnt lgkmcnt(6)
  ds_read_b64_tr_b16 a[36:37], v5 offset:26624
  ds_read_b64_tr_b16 a[38:39], v5 offset:32768
  v_mfma_f32_16x16x32_bf16 a[108:111], a[20:23], v[116:119], a[108:111]
  buffer_load_dwordx4 v[136:139], v13, s[24:27], s50 offen offset:1024 sc1
  v_mfma_f32_16x16x32_bf16 a[104:107], a[20:23], v[112:115], a[104:107]
  s_barrier
  v_add_u32 v4, 0xffff7000, v4
  v_mfma_f32_16x16x32_bf16 a[100:103], a[20:23], v[108:111], a[100:103]
  s_waitcnt lgkmcnt(6)
  v_add_u32 v5, 0xffff7000, v5
  v_add_u32 v6, 0xffff7000, v6
  v_mfma_f32_16x16x32_bf16 a[112:115], a[24:27], v[108:111], a[112:115]
  buffer_load_dwordx4 v[140:143], v13, s[24:27], s50 offen offset:2048 sc1
  v_mfma_f32_16x16x32_bf16 a[116:119], a[24:27], v[112:115], a[116:119]
  v_add_u32 v7, 0xffff7000, v7
  v_mfma_f32_16x16x32_bf16 a[120:123], a[24:27], v[116:119], a[120:123]
  s_waitcnt lgkmcnt(4)
  ds_read_b64_tr_b16 a[0:1], v4 offset:0
  ds_read_b64_tr_b16 a[2:3], v4 offset:6144
  v_mfma_f32_16x16x32_bf16 a[132:135], a[28:31], v[116:119], a[132:135]
  s_add_u32 s50, s66, 0
  ds_read_b64_tr_b16 a[4:5], v5 offset:0
  ds_read_b64_tr_b16 a[6:7], v5 offset:6144
  v_mfma_f32_16x16x32_bf16 a[128:131], a[28:31], v[112:115], a[128:131]
  buffer_load_dwordx4 v[144:147], v13, s[24:27], s50 offen sc1
  v_mfma_f32_16x16x32_bf16 a[124:127], a[28:31], v[108:111], a[124:127]
  s_waitcnt lgkmcnt(6)
  ds_read_b64_tr_b16 a[8:9], v6 offset:0
  ds_read_b64_tr_b16 a[10:11], v6 offset:6144
  v_mfma_f32_16x16x32_bf16 a[136:139], a[32:35], v[108:111], a[136:139]
  v_mfma_f32_16x16x32_bf16 a[140:143], a[32:35], v[112:115], a[140:143]
  v_mfma_f32_16x16x32_bf16 a[144:147], a[32:35], v[116:119], a[144:147]
  s_waitcnt lgkmcnt(6)
  ds_read_b64_tr_b16 a[12:13], v7 offset:0
  ds_read_b64_tr_b16 a[14:15], v7 offset:6144
  v_mfma_f32_16x16x32_bf16 a[156:159], a[36:39], v[116:119], a[156:159]
  buffer_load_dwordx4 v[148:151], v13, s[24:27], s50 offen offset:1024 sc1
  v_mfma_f32_16x16x32_bf16 a[152:155], a[36:39], v[112:115], a[152:155]
  v_mfma_f32_16x16x32_bf16 a[148:151], a[36:39], v[108:111], a[148:151]
  s_waitcnt vmcnt(8) lgkmcnt(6)
  ds_read_b64_tr_b16 a[16:17], v4 offset:1024
  ds_read_b64_tr_b16 a[18:19], v4 offset:7168
  v_mfma_f32_16x16x32_bf16 a[40:43], a[0:3], v[120:123], a[40:43]
  s_waitcnt vmcnt(6)
  buffer_load_dwordx4 v[152:155], v13, s[24:27], s50 offen offset:2048 sc1
  v_mfma_f32_16x16x32_bf16 a[44:47], a[0:3], v[124:127], a[44:47]
  s_waitcnt vmcnt(6)
  v_mfma_f32_16x16x32_bf16 a[48:51], a[0:3], v[128:131], a[48:51]
  s_waitcnt lgkmcnt(6)
  s_add_u32 s49, s64, 0x3000
  ds_read_b64_tr_b16 a[20:21], v5 offset:1024
  v_mfma_f32_16x16x32_bf16 a[60:63], a[4:7], v[128:131], a[60:63]
  ds_read_b64_tr_b16 a[22:23], v5 offset:7168
  v_mfma_f32_16x16x32_bf16 a[56:59], a[4:7], v[124:127], a[56:59]
  buffer_store_dwordx4 v[96:99], v13, s[24:27], s49 offen sc1
  v_mfma_f32_16x16x32_bf16 a[52:55], a[4:7], v[120:123], a[52:55]
  s_waitcnt lgkmcnt(6)
  ds_read_b64_tr_b16 a[24:25], v6 offset:1024
  ds_read_b64_tr_b16 a[26:27], v6 offset:7168
  v_mfma_f32_16x16x32_bf16 a[64:67], a[8:11], v[120:123], a[64:67]
  v_mfma_f32_16x16x32_bf16 a[68:71], a[8:11], v[124:127], a[68:71]
  v_mfma_f32_16x16x32_bf16 a[72:75], a[8:11], v[128:131], a[72:75]
  s_waitcnt lgkmcnt(6)
  ds_read_b64_tr_b16 a[28:29], v7 offset:1024
  ds_read_b64_tr_b16 a[30:31], v7 offset:7168
  v_mfma_f32_16x16x32_bf16 a[84:87], a[12:15], v[128:131], a[84:87]
  buffer_store_dwordx4 v[100:103], v13, s[24:27], s49 offen offset:1024 sc1
  v_mfma_f32_16x16x32_bf16 a[80:83], a[12:15], v[124:127], a[80:83]
  v_mfma_f32_16x16x32_bf16 a[76:79], a[12:15], v[120:123], a[76:79]
  s_waitcnt lgkmcnt(6)
  ds_read_b64_tr_b16 a[32:33], v4 offset:2048
  ds_read_b64_tr_b16 a[34:35], v4 offset:8192
  v_mfma_f32_16x16x32_bf16 a[88:91], a[16:19], v[120:123], a[88:91]
  v_mfma_f32_16x16x32_bf16 a[92:95], a[16:19], v[124:127], a[92:95]
  v_mfma_f32_16x16x32_bf16 a[96:99], a[16:19], v[128:131], a[96:99]
  s_waitcnt lgkmcnt(6)
  s_add_u32 m0, s37, 0xf380
  ds_read_b64_tr_b16 a[36:37], v5 offset:2048
  v_mfma_f32_16x16x32_bf16 a[108:111], a[20:23], v[128:131], a[108:111]
  buffer_store_dwordx4 v[104:107], v13, s[24:27], s49 offen offset:2048 sc1
  v_mfma_f32_16x16x32_bf16 a[104:107], a[20:23], v[124:127], a[104:107]
  s_barrier
  ds_read_b64_tr_b16 a[38:39], v5 offset:8192
  v_mfma_f32_16x16x32_bf16 a[100:103], a[20:23], v[120:123], a[100:103]
  s_waitcnt lgkmcnt(6)
  v_add_u32 v4, 0xfffee000, v4
  v_add_u32 v5, 0xfffee000, v5
  v_mfma_f32_16x16x32_bf16 a[112:115], a[24:27], v[120:123], a[112:115]
  buffer_load_dwordx4 v15, s[20:23], s47 offen offset:128 lds
  v_mfma_f32_16x16x32_bf16 a[116:119], a[24:27], v[124:127], a[116:119]
  buffer_store_dwordx4 v[108:111], v13, s[24:27], s49 offen offset:3072 sc1
  v_mfma_f32_16x16x32_bf16 a[120:123], a[24:27], v[128:131], a[120:123]
  s_waitcnt lgkmcnt(4)
  v_add_u32 v6, 0xfffee000, v6
  v_add_u32 v7, 0xfffee000, v7
  v_mfma_f32_16x16x32_bf16 a[132:135], a[28:31], v[128:131], a[132:135]
  s_nop 0
  ds_read_b64_tr_b16 a[0:1], v4 offset:0
  ds_read_b64_tr_b16 a[2:3], v4 offset:6144
  v_mfma_f32_16x16x32_bf16 a[128:131], a[28:31], v[124:127], a[128:131]
  s_add_u32 s49, s64, 0x4000
  ds_read_b64_tr_b16 a[4:5], v5 offset:0
  ds_read_b64_tr_b16 a[6:7], v5 offset:6144
  v_mfma_f32_16x16x32_bf16 a[124:127], a[28:31], v[120:123], a[124:127]
  s_waitcnt lgkmcnt(6)
  ds_read_b64_tr_b16 a[8:9], v6 offset:0
  ds_read_b64_tr_b16 a[10:11], v6 offset:6144
  v_mfma_f32_16x16x32_bf16 a[136:139], a[32:35], v[120:123], a[136:139]
  buffer_store_dwordx4 v[112:115], v13, s[24:27], s49 offen sc1
  v_mfma_f32_16x16x32_bf16 a[140:143], a[32:35], v[124:127], a[140:143]
  v_mfma_f32_16x16x32_bf16 a[144:147], a[32:35], v[128:131], a[144:147]
  s_waitcnt lgkmcnt(6)
  ds_read_b64_tr_b16 a[12:13], v7 offset:0
  ds_read_b64_tr_b16 a[14:15], v7 offset:6144
  v_mfma_f32_16x16x32_bf16 a[156:159], a[36:39], v[128:131], a[156:159]
  v_mfma_f32_16x16x32_bf16 a[152:155], a[36:39], v[124:127], a[152:155]
  v_mfma_f32_16x16x32_bf16 a[148:151], a[36:39], v[120:123], a[148:151]
  s_waitcnt vmcnt(11) lgkmcnt(6)
  ds_read_b64_tr_b16 a[16:17], v4 offset:1024
  ds_read_b64_tr_b16 a[18:19], v4 offset:7168
  v_mfma_f32_16x16x32_bf16 a[40:43], a[0:3], v[132:135], a[40:43]
  s_waitcnt vmcnt(10)
  buffer_store_dwordx4 v[116:119], v13, s[24:27], s49 offen offset:1024 sc1
  v_mfma_f32_16x16x32_bf16 a[44:47], a[0:3], v[136:139], a[44:47]
  s_waitcnt vmcnt(10)
  v_mfma_f32_16x16x32_bf16 a[48:51], a[0:3], v[140:143], a[48:51]
  s_waitcnt lgkmcnt(6)
  ds_read_b64_tr_b16 a[20:21], v5 offset:1024
  ds_read_b64_tr_b16 a[22:23], v5 offset:7168
  v_mfma_f32_16x16x32_bf16 a[60:63], a[4:7], v[140:143], a[60:63]
  v_mfma_f32_16x16x32_bf16 a[56:59], a[4:7], v[136:139], a[56:59]
  buffer_load_dword v31, v44, s[60:63], 0 offen sc1
  v_mfma_f32_16x16x32_bf16 a[52:55], a[4:7], v[132:135], a[52:55]
  s_waitcnt lgkmcnt(6)
  s_add_u32 s50, s66, 0xc00
  ds_read_b64_tr_b16 a[24:25], v6 offset:1024
  v_mfma_f32_16x16x32_bf16 a[64:67], a[8:11], v[132:135], a[64:67]
  buffer_load_dwordx4 v[156:159], v13, s[24:27], s50 offen sc1
  v_mfma_f32_16x16x32_bf16 a[68:71], a[8:11], v[136:139], a[68:71]
  ds_read_b64_tr_b16 a[26:27], v6 offset:7168
  v_mfma_f32_16x16x32_bf16 a[72:75], a[8:11], v[140:143], a[72:75]
  s_waitcnt lgkmcnt(6)
  ds_read_b64_tr_b16 a[28:29], v7 offset:1024
  ds_read_b64_tr_b16 a[30:31], v7 offset:7168
  v_mfma_f32_16x16x32_bf16 a[84:87], a[12:15], v[140:143], a[84:87]
  v_mfma_f32_16x16x32_bf16 a[80:83], a[12:15], v[136:139], a[80:83]
  buffer_load_dwordx4 v[160:163], v13, s[24:27], s50 offen offset:1024 sc1
L_hop10:
  s_cbranch_execz L_hop_ret
  v_mfma_f32_16x16x32_bf16 a[76:79], a[12:15], v[132:135], a[76:79]
  s_waitcnt lgkmcnt(6)
  ds_read_b64_tr_b16 a[32:33], v4 offset:2048
  ds_read_b64_tr_b16 a[34:35], v4 offset:8192
  v_mfma_f32_16x16x32_bf16 a[88:91], a[16:19], v[132:135], a[88:91]
  v_mfma_f32_16x16x32_bf16 a[92:95], a[16:19], v[136:139], a[92:95]
  v_mfma_f32_16x16x32_bf16 a[96:99], a[16:19], v[140:143], a[96:99]
  s_waitcnt lgkmcnt(6)
  ds_read_b64_tr_b16 a[36:37], v5 offset:2048
  ds_read_b64_tr_b16 a[38:39], v5 offset:8192
  v_mfma_f32_16x16x32_bf16 a[108:111], a[20:23], v[140:143], a[108:111]
  buffer_load_dwordx4 v[164:167], v13, s[24:27], s50 offen offset:2048 sc1
  v_mfma_f32_16x16x32_bf16 a[104:107], a[20:23], v[136:139], a[104:107]
  s_barrier
  s_add_u32 s50, s67, 0
  v_mfma_f32_16x16x32_bf16 a[100:103], a[20:23], v[132:135], a[100:103]
  s_waitcnt lgkmcnt(6)
  v_add_u32 v4, 0xf000, v4
  v_add_u32 v5, 0xf000, v5
  v_mfma_f32_16x16x32_bf16 a[112:115], a[24:27], v[132:135], a[112:115]
  buffer_load_dwordx4 v[168:171], v13, s[24:27], s50 offen sc1
  v_mfma_f32_16x16x32_bf16 a[116:119], a[24:27], v[136:139], a[116:119]
  v_add_u32 v6, 0xf000, v6
  v_add_u32 v7, 0xf000, v7
  v_mfma_f32_16x16x32_bf16 a[120:123], a[24:27], v[140:143], a[120:123]
  s_waitcnt lgkmcnt(4)
  ds_read_b64_tr_b16 a[0:1], v4 offset:0
  ds_read_b64_tr_b16 a[2:3], v4 offset:6144
  v_mfma_f32_16x16x32_bf16 a[132:135], a[28:31], v[140:143], a[132:135]
  s_nop 0
  ds_read_b64_tr_b16 a[4:5], v5 offset:0
  ds_read_b64_tr_b16 a[6:7], v5 offset:6144
  v_mfma_f32_16x16x32_bf16 a[128:131], a[28:31], v[136:139], a[128:131]
  buffer_load_dwordx4 v[172:175], v13, s[24:27], s50 offen offset:1024 sc1
  v_mfma_f32_16x16x32_bf16 a[124:127], a[28:31], v[132:135], a[124:127]
  s_waitcnt lgkmcnt(6)
  ds_read_b64_tr_b16 a[8:9], v6 offset:0
  ds_read_b64_tr_b16 a[10:11], v6 offset:6144
  v_mfma_f32_16x16x32_bf16 a[136:139], a[32:35], v[132:135], a[136:139]
  v_mfma_f32_16x16x32_bf16 a[140:143], a[32:35], v[136:139], a[140:143]
  v_mfma_f32_16x16x32_bf16 a[144:147], a[32:35], v[140:143], a[144:147]
  s_waitcnt lgkmcnt(6)
  ds_read_b64_tr_b16 a[12:13], v7 offset:0
  ds_read_b64_tr_b16 a[14:15], v7 offset:6144
  v_mfma_f32_16x16x32_bf16 a[156:159], a[36:39], v[140:143], a[156:159]
  buffer_load_dwordx4 v[176:179], v13, s[24:27], s50 offen offset:2048 sc1
  v_mfma_f32_16x16x32_bf16 a[152:155], a[36:39], v[136:139], a[152:155]
  s_add_u32 s50, s67, 0xc00
  v_mfma_f32_16x16x32_bf16 a[148:151], a[36:39], v[132:135], a[148:151]
  s_waitcnt vmcnt(16) lgkmcnt(6)
  ds_read_b64_tr_b16 a[16:17], v4 offset:1024
  ds_read_b64_tr_b16 a[18:19], v4 offset:7168
  v_mfma_f32_16x16x32_bf16 a[40:43], a[0:3], v[144:147], a[40:43]
  s_waitcnt vmcnt(15)
  buffer_load_dwordx4 v[180:183], v13, s[24:27], s50 offen sc1
  v_mfma_f32_16x16x32_bf16 a[44:47], a[0:3], v[148:151], a[44:47]
  s_waitcnt vmcnt(15)
  v_mfma_f32_16x16x32_bf16 a[48:51], a[0:3], v[152:155], a[48:51]
  s_waitcnt lgkmcnt(6)
  ds_read_b64_tr_b16 a[20:21], v5 offset:1024
  ds_read_b64_tr_b16 a[22:23], v5 offset:7168
  v_mfma_f32_16x16x32_bf16 a[60:63], a[4:7], v[152:155], a[60:63]
  v_mfma_f32_16x16x32_bf16 a[56:59], a[4:7], v[148:151], a[56:59]
  buffer_load_dwordx4 v[184:187], v13, s[24:27], s50 offen offset:1024 sc1
  v_mfma_f32_16x16x32_bf16 a[52:55], a[4:7], v[144:147], a[52:55]
  s_waitcnt lgkmcnt(6)
  ds_read_b64_tr_b16 a[24:25], v6 offset:1024
  ds_read_b64_tr_b16 a[26:27], v6 offset:7168
  v_mfma_f32_16x16x32_bf16 a[64:67], a[8:11], v[144:147], a[64:67]
  v_mfma_f32_16x16x32_bf16 a[68:71], a[8:11], v[148:151], a[68:71]
  v_mfma_f32_16x16x32_bf16 a[72:75], a[8:11], v[152:155], a[72:75]
  s_waitcnt lgkmcnt(6)
  ds_read_b64_tr_b16 a[28:29], v7 offset:1024
  ds_read_b64_tr_b16 a[30:31], v7 offset:7168
  v_mfma_f32_16x16x32_bf16 a[84:87], a[12:15], v[152:155], a[84:87]
  buffer_load_dwordx4 v[188:191], v13, s[24:27], s50 offen offset:2048 sc1
  v_mfma_f32_16x16x32_bf16 a[80:83], a[12:15], v[148:151], a[80:83]
  v_mfma_f32_16x16x32_bf16 a[76:79], a[12:15], v[144:147], a[76:79]
  s_waitcnt lgkmcnt(6)
  s_add_u32 m0, s37, 0xf700
  ds_read_b64_tr_b16 a[32:33], v4 offset:2048
  v_mfma_f32_16x16x32_bf16 a[88:91], a[16:19], v[144:147], a[88:91]
  buffer_load_dwordx4 v16, s[20:23], s47 offen offset:256 lds
  v_mfma_f32_16x16x32_bf16 a[92:95], a[16:19], v[148:151], a[92:95]
  ds_read_b64_tr_b16 a[34:35], v4 offset:8192
  v_mfma_f32_16x16x32_bf16 a[96:99], a[16:19], v[152:155], a[96:99]
  s_waitcnt lgkmcnt(6)
  ds_read_b64_tr_b16 a[36:37], v5 offset:2048
  ds_read_b64_tr_b16 a[38:39], v5 offset:8192
  v_mfma_f32_16x16x32_bf16 a[108:111], a[20:23], v[152:155], a[108:111]
  s_add_u32 s46, s70, 0x1e000
  s_add_u32 m0, s37, 0
  v_add_u32 v4, 0xffff4000, v4
  v_mfma_f32_16x16x32_bf16 a[104:107], a[20:23], v[148:151], a[104:107]
  s_barrier
  v_add_u32 v5, 0xffff4000, v5
  v_mfma_f32_16x16x32_bf16 a[100:103], a[20:23], v[144:147], a[100:103]
  s_waitcnt lgkmcnt(6)
  v_add_u32 v6, 0xffff4000, v6
  v_add_u32 v7, 0xffff4000, v7
  v_mfma_f32_16x16x32_bf16 a[112:115], a[24:27], v[144:147], a[112:115]
  buffer_load_dwordx4 v15, s[20:23], s46 offen lds
  v_mfma_f32_16x16x32_bf16 a[116:119], a[24:27], v[148:151], a[116:119]
  s_add_u32 m0, s37, 0x380
  ds_read_b64_tr_b16 a[0:1], v4 offset:0
  ds_read_b64_tr_b16 a[2:3], v4 offset:6144
  v_mfma_f32_16x16x32_bf16 a[120:123], a[24:27], v[152:155], a[120:123]
  s_waitcnt lgkmcnt(6)
  ds_read_b64_tr_b16 a[4:5], v5 offset:0
  ds_read_b64_tr_b16 a[6:7], v5 offset:6144
  v_mfma_f32_16x16x32_bf16 a[132:135], a[28:31], v[152:155], a[132:135]
  buffer_load_dwordx4 v15, s[20:23], s46 offen offset:128 lds
  v_mfma_f32_16x16x32_bf16 a[128:131], a[28:31], v[148:151], a[128:131]
  v_mfma_f32_16x16x32_bf16 a[124:127], a[28:31], v[144:147], a[124:127]
  s_waitcnt lgkmcnt(6)
  s_add_u32 m0, s37, 0x700
  ds_read_b64_tr_b16 a[8:9], v6 offset:0
  v_mfma_f32_16x16x32_bf16 a[136:139], a[32:35], v[144:147], a[136:139]
  buffer_load_dwordx4 v16, s[20:23], s46 offen offset:256 lds
  v_mfma_f32_16x16x32_bf16 a[140:143], a[32:35], v[148:151], a[140:143]
  ds_read_b64_tr_b16 a[10:11], v6 offset:6144
  v_mfma_f32_16x16x32_bf16 a[144:147], a[32:35], v[152:155], a[144:147]
  s_waitcnt lgkmcnt(6)
  ds_read_b64_tr_b16 a[12:13], v7 offset:0
  ds_read_b64_tr_b16 a[14:15], v7 offset:6144
  v_mfma_f32_16x16x32_bf16 a[156:159], a[36:39], v[152:155], a[156:159]
  s_add_u32 s47, s71, 0x14000
  s_add_u32 m0, s37, 0x1e000
  v_mfma_f32_16x16x32_bf16 a[152:155], a[36:39], v[148:151], a[152:155]
  buffer_load_dwordx4 v15, s[20:23], s47 offen lds
  v_mfma_f32_16x16x32_bf16 a[148:151], a[36:39], v[144:147], a[148:151]
  s_waitcnt vmcnt(13) lgkmcnt(6)
  ds_read_b64_tr_b16 a[16:17], v4 offset:1024
  ds_read_b64_tr_b16 a[18:19], v4 offset:7168
  v_mfma_f32_16x16x32_bf16 a[40:43], a[0:3], v[156:159], a[40:43]
  s_waitcnt vmcnt(12)
  v_mfma_f32_16x16x32_bf16 a[44:47], a[0:3], v[160:163], a[44:47]
  s_waitcnt vmcnt(11)
  s_add_u32 m0, s37, 0x1e380
  v_mfma_f32_16x16x32_bf16 a[48:51], a[0:3], v[164:167], a[48:51]
  s_waitcnt lgkmcnt(6)
  ds_read_b64_tr_b16 a[20:21], v5 offset:1024
  ds_read_b64_tr_b16 a[22:23], v5 offset:7168
  v_mfma_f32_16x16x32_bf16 a[60:63], a[4:7], v[164:167], a[60:63]
  buffer_load_dwordx4 v15, s[20:23], s47 offen offset:128 lds
  v_mfma_f32_16x16x32_bf16 a[56:59], a[4:7], v[160:163], a[56:59]
  v_mfma_f32_16x16x32_bf16 a[52:55], a[4:7], v[156:159], a[52:55]
  s_waitcnt lgkmcnt(6)
  s_add_u32 m0, s37, 0x1e700
  ds_read_b64_tr_b16 a[24:25], v6 offset:1024
  v_mfma_f32_16x16x32_bf16 a[64:67], a[8:11], v[156:159], a[64:67]
  buffer_load_dwordx4 v16, s[20:23], s47 offen offset:256 lds
  v_mfma_f32_16x16x32_bf16 a[68:71], a[8:11], v[160:163], a[68:71]
  ds_read_b64_tr_b16 a[26:27], v6 offset:7168
  v_mfma_f32_16x16x32_bf16 a[72:75], a[8:11], v[164:167], a[72:75]
  s_waitcnt lgkmcnt(6)
  ds_read_b64_tr_b16 a[28:29], v7 offset:1024
  ds_read_b64_tr_b16 a[30:31], v7 offset:7168
  v_mfma_f32_16x16x32_bf16 a[84:87], a[12:15], v[164:167], a[84:87]
  s_add_u32 s46, s71, 0x1e000
  s_add_u32 m0, s37, 0x21000
  v_mfma_f32_16x16x32_bf16 a[80:83], a[12:15], v[160:163], a[80:83]
  buffer_load_dwordx4 v15, s[20:23], s46 offen lds
  v_mfma_f32_16x16x32_bf16 a[76:79], a[12:15], v[156:159], a[76:79]
  s_waitcnt lgkmcnt(6)
  ds_read_b64_tr_b16 a[32:33], v4 offset:2048
  ds_read_b64_tr_b16 a[34:35], v4 offset:8192
  v_mfma_f32_16x16x32_bf16 a[88:91], a[16:19], v[156:159], a[88:91]
  v_mfma_f32_16x16x32_bf16 a[92:95], a[16:19], v[160:163], a[92:95]
  s_add_u32 m0, s37, 0x21380
  v_mfma_f32_16x16x32_bf16 a[96:99], a[16:19], v[164:167], a[96:99]
  s_waitcnt lgkmcnt(6)
  ds_read_b64_tr_b16 a[36:37], v5 offset:2048
  ds_read_b64_tr_b16 a[38:39], v5 offset:8192
  v_mfma_f32_16x16x32_bf16 a[108:111], a[20:23], v[164:167], a[108:111]
  buffer_load_dwordx4 v15, s[20:23], s46 offen offset:128 lds
  v_mfma_f32_16x16x32_bf16 a[104:107], a[20:23], v[160:163], a[104:107]
  s_barrier
  s_add_u32 s48, s100, 4
  v_mfma_f32_16x16x32_bf16 a[100:103], a[20:23], v[156:159], a[100:103]
  s_waitcnt lgkmcnt(6)
  s_add_u32 m0, s37, 0x21700
  ds_read_b64_tr_b16 a[0:1], v4 offset:24576
  v_mfma_f32_16x16x32_bf16 a[112:115], a[24:27], v[156:159], a[112:115]
  buffer_load_dwordx4 v16, s[20:23], s46 offen offset:256 lds
  v_mfma_f32_16x16x32_bf16 a[116:119], a[24:27], v[160:163], a[116:119]
  ds_read_b64_tr_b16 a[2:3], v4 offset:30720
  v_mov_b32 v11, s48
  v_mfma_f32_16x16x32_bf16 a[120:123], a[24:27], v[164:167], a[120:123]
  s_waitcnt lgkmcnt(6)
  ds_read_b64_tr_b16 a[4:5], v5 offset:24576
  ds_read_b64_tr_b16 a[6:7], v5 offset:30720
  v_mfma_f32_16x16x32_bf16 a[132:135], a[28:31], v[164:167], a[132:135]
  v_mfma_f32_16x16x32_bf16 a[128:131], a[28:31], v[160:163], a[128:131]
  buffer_store_dword v11, off, s[60:63], s43 sc1
  v_mfma_f32_16x16x32_bf16 a[124:127], a[28:31], v[156:159], a[124:127]
  s_waitcnt lgkmcnt(6)
  s_add_u32 s47, s69, 0x28000
  s_add_u32 m0, s37, 0x24000
  v_mfma_f32_16x16x32_bf16 a[136:139], a[32:35], v[156:159], a[136:139]
  buffer_load_dwordx4 v15, s[20:23], s47 offen lds
  v_mfma_f32_16x16x32_bf16 a[140:143], a[32:35], v[160:163], a[140:143]
  s_nop 0
  ds_read_b64_tr_b16 a[8:9], v6 offset:24576
  ds_read_b64_tr_b16 a[10:11], v6 offset:30720
  v_mfma_f32_16x16x32_bf16 a[144:147], a[32:35], v[164:167], a[144:147]
  s_waitcnt lgkmcnt(6)
  ds_read_b64_tr_b16 a[12:13], v7 offset:24576
  ds_read_b64_tr_b16 a[14:15], v7 offset:30720
  v_mfma_f32_16x16x32_bf16 a[156:159], a[36:39], v[164:167], a[156:159]
  s_add_u32 m0, s37, 0x24380
  v_mfma_f32_16x16x32_bf16 a[152:155], a[36:39], v[160:163], a[152:155]
  buffer_load_dwordx4 v15, s[20:23], s47 offen offset:128 lds
  v_mfma_f32_16x16x32_bf16 a[148:151], a[36:39], v[156:159], a[148:151]
  s_waitcnt vmcnt(18) lgkmcnt(6)
  ds_read_b64_tr_b16 a[16:17], v4 offset:25600
  ds_read_b64_tr_b16 a[18:19], v4 offset:31744
  v_mfma_f32_16x16x32_bf16 a[40:43], a[0:3], v[168:171], a[40:43]
  s_waitcnt vmcnt(17)
  v_mfma_f32_16x16x32_bf16 a[44:47], a[0:3], v[172:175], a[44:47]
  s_waitcnt vmcnt(16)
  s_add_u32 m0, s37, 0x24700
  v_mfma_f32_16x16x32_bf16 a[48:51], a[0:3], v[176:179], a[48:51]
  s_waitcnt lgkmcnt(6)
  ds_read_b64_tr_b16 a[20:21], v5 offset:25600
  ds_read_b64_tr_b16 a[22:23], v5 offset:31744
  v_mfma_f32_16x16x32_bf16 a[60:63], a[4:7], v[176:179], a[60:63]
  buffer_load_dwordx4 v16, s[20:23], s47 offen offset:256 lds
  v_mfma_f32_16x16x32_bf16 a[56:59], a[4:7], v[172:175], a[56:59]
  v_mfma_f32_16x16x32_bf16 a[52:55], a[4:7], v[168:171], a[52:55]
  s_waitcnt lgkmcnt(6)
  s_add_u32 s46, s69, 0x32000
  s_add_u32 m0, s37, 0x15000
  v_mfma_f32_16x16x32_bf16 a[64:67], a[8:11], v[168:171], a[64:67]
  buffer_load_dwordx4 v15, s[20:23], s46 offen lds
  v_mfma_f32_16x16x32_bf16 a[68:71], a[8:11], v[172:175], a[68:71]
  s_nop 0
  ds_read_b64_tr_b16 a[24:25], v6 offset:25600
  ds_read_b64_tr_b16 a[26:27], v6 offset:31744
  v_mfma_f32_16x16x32_bf16 a[72:75], a[8:11], v[176:179], a[72:75]
  s_waitcnt lgkmcnt(6)
  ds_read_b64_tr_b16 a[28:29], v7 offset:25600
  ds_read_b64_tr_b16 a[30:31], v7 offset:31744
  v_mfma_f32_16x16x32_bf16 a[84:87], a[12:15], v[176:179], a[84:87]
  s_add_u32 m0, s37, 0x15380
  v_mfma_f32_16x16x32_bf16 a[80:83], a[12:15], v[172:175], a[80:83]
  buffer_load_dwordx4 v15, s[20:23], s46 offen offset:128 lds
  v_mfma_f32_16x16x32_bf16 a[76:79], a[12:15], v[168:171], a[76:79]
  s_waitcnt lgkmcnt(6)
  ds_read_b64_tr_b16 a[32:33], v4 offset:26624
  ds_read_b64_tr_b16 a[34:35], v4 offset:32768
  v_mfma_f32_16x16x32_bf16 a[88:91], a[16:19], v[168:171], a[88:91]
  v_mfma_f32_16x16x32_bf16 a[92:95], a[16:19], v[172:175], a[92:95]
  s_add_u32 m0, s37, 0x15700
  v_mfma_f32_16x16x32_bf16 a[96:99], a[16:19], v[176:179], a[96:99]
  v_sub_u32 v31, v31, v46
  v_cmp_gt_u32 vcc, 2, v31
  s_nop 0
  s_cbranch_vccnz L_poll1_1
L_poll1_1_back:
  s_waitcnt lgkmcnt(6)
  v_mfma_f32_16x16x32_bf16 a[108:111], a[20:23], v[176:179], a[108:111]
  buffer_load_dwordx4 v16, s[20:23], s46 offen offset:256 lds
  v_mfma_f32_16x16x32_bf16 a[104:107], a[20:23], v[172:175], a[104:107]
  s_barrier
  ds_read_b64_tr_b16 a[36:37], v5 offset:26624
  v_mfma_f32_16x16x32_bf16 a[100:103], a[20:23], v[168:171], a[100:103]
  s_waitcnt lgkmcnt(5)
  s_add_u32 s50, s65, 0x1800
  ds_read_b64_tr_b16 a[38:39], v5 offset:32768
  v_mfma_f32_16x16x32_bf16 a[112:115], a[24:27], v[168:171], a[112:115]
  buffer_load_dwordx4 a[160:163], v13, s[24:27], s50 offen sc1
  v_mfma_f32_16x16x32_bf16 a[116:119], a[24:27], v[172:175], a[116:119]
  v_add_u32 v4, 0x12000, v4
  v_add_u32 v5, 0x12000, v5
  v_mfma_f32_16x16x32_bf16 a[120:123], a[24:27], v[176:179], a[120:123]
  s_waitcnt lgkmcnt(4)
  v_add_u32 v6, 0x12000, v6
  v_add_u32 v7, 0x12000, v7
  v_mfma_f32_16x16x32_bf16 a[132:135], a[28:31], v[176:179], a[132:135]
  s_nop 0
  ds_read_b64_tr_b16 a[0:1], v4 offset:0
  ds_read_b64_tr_b16 a[2:3], v4 offset:6144
  v_mfma_f32_16x16x32_bf16 a[128:131], a[28:31], v[172:175], a[128:131]
  buffer_load_dwordx4 a[164:167], v13, s[24:27], s50 offen offset:1024 sc1
  v_mfma_f32_16x16x32_bf16 a[124:127], a[28:31], v[168:171], a[124:127]
  s_waitcnt lgkmcnt(4)
  ds_read_b64_tr_b16 a[4:5], v5 offset:0
  ds_read_b64_tr_b16 a[6:7], v5 offset:6144
  v_mfma_f32_16x16x32_bf16 a[136:139], a[32:35], v[168:171], a[136:139]
  s_nop 0
  ds_read_b64_tr_b16 a[8:9], v6 offset:0
  ds_read_b64_tr_b16 a[10:11], v6 offset:6144
  v_mfma_f32_16x16x32_bf16 a[140:143], a[32:35], v[172:175], a[140:143]
  v_mfma_f32_16x16x32_bf16 a[144:147], a[32:35], v[176:179], a[144:147]
  s_waitcnt lgkmcnt(6)
  ds_read_b64_tr_b16 a[12:13], v7 offset:0
  ds_read_b64_tr_b16 a[14:15], v7 offset:6144
  v_mfma_f32_16x16x32_bf16 a[156:159], a[36:39], v[176:179], a[156:159]
  buffer_load_dwordx4 a[168:171], v13, s[24:27], s50 offen offset:2048 sc1
  v_mfma_f32_16x16x32_bf16 a[152:155], a[36:39], v[172:175], a[152:155]
  s_add_u32 s50, s65, 0x2400
  v_mfma_f32_16x16x32_bf16 a[148:151], a[36:39], v[168:171], a[148:151]
  s_waitcnt vmcnt(22) lgkmcnt(6)
  ds_read_b64_tr_b16 a[16:17], v4 offset:1024
  ds_read_b64_tr_b16 a[18:19], v4 offset:7168
  v_mfma_f32_16x16x32_bf16 a[40:43], a[0:3], v[180:183], a[40:43]
  s_waitcnt vmcnt(21)
  buffer_load_dwordx4 a[172:175], v13, s[24:27], s50 offen sc1
  v_mfma_f32_16x16x32_bf16 a[44:47], a[0:3], v[184:187], a[44:47]
  s_waitcnt vmcnt(21)
  v_bfe_u32 v23, v0, 2, 2
  v_bfe_u32 v24, v0, 4, 1
  v_mfma_f32_16x16x32_bf16 a[48:51], a[0:3], v[188:191], a[48:51]
  s_waitcnt lgkmcnt(6)
  ds_read_b64_tr_b16 a[20:21], v5 offset:1024
  v_lshl_add_u32 v23, v23, 1, v24
  v_mfma_f32_16x16x32_bf16 a[60:63], a[4:7], v[188:191], a[60:63]
  ds_read_b64_tr_b16 a[22:23], v5 offset:7168
  v_mul_u32_u24 v23, 0x3c00, v23
  v_mfma_f32_16x16x32_bf16 a[56:59], a[4:7], v[184:187], a[56:59]
  buffer_load_dwordx4 a[176:179], v13, s[24:27], s50 offen offset:1024 sc1
  v_mfma_f32_16x16x32_bf16 a[52:55], a[4:7], v[180:183], a[52:55]
  s_waitcnt lgkmcnt(6)
  ds_read_b64_tr_b16 a[24:25], v6 offset:1024
  v_lshrrev_b32 v24, 5, v0
  v_mfma_f32_16x16x32_bf16 a[64:67], a[8:11], v[180:183], a[64:67]
  ds_read_b64_tr_b16 a[26:27], v6 offset:7168
  v_and_b32 v25, 3, v0
  v_mfma_f32_16x16x32_bf16 a[68:71], a[8:11], v[184:187], a[68:71]
  v_lshl_add_u32 v24, v24, 2, v25
  v_lshl_add_u32 v12, v24, 4, v23
  v_mfma_f32_16x16x32_bf16 a[72:75], a[8:11], v[188:191], a[72:75]
  s_waitcnt lgkmcnt(6)
  ds_read_b64_tr_b16 a[28:29], v7 offset:1024
  ds_read_b64_tr_b16 a[30:31], v7 offset:7168
  v_mfma_f32_16x16x32_bf16 a[84:87], a[12:15], v[188:191], a[84:87]
  buffer_load_dwordx4 a[180:183], v13, s[24:27], s50 offen offset:2048 sc1
  v_mfma_f32_16x16x32_bf16 a[80:83], a[12:15], v[184:187], a[80:83]
  s_add_u32 s50, s66, 0x1800
  v_add_u32 v23, 0, v0
  v_lshrrev_b32 v24, 3, v23
  v_mfma_f32_16x16x32_bf16 a[76:79], a[12:15], v[180:183], a[76:79]
  s_waitcnt lgkmcnt(6)
  ds_read_b64_tr_b16 a[32:33], v4 offset:2048
  ds_read_b64_tr_b16 a[34:35], v4 offset:8192
  v_mfma_f32_16x16x32_bf16 a[88:91], a[16:19], v[180:183], a[88:91]
  buffer_load_dwordx4 a[184:187], v13, s[24:27], s50 offen sc1
  v_mfma_f32_16x16x32_bf16 a[92:95], a[16:19], v[184:187], a[92:95]
  v_mul_u32_u24 v25, 0x56, v24
  v_lshrrev_b32 v25, 8, v25
  v_mfma_f32_16x16x32_bf16 a[96:99], a[16:19], v[188:191], a[96:99]
  s_waitcnt lgkmcnt(6)
  ds_read_b64_tr_b16 a[36:37], v5 offset:2048
  ds_read_b64_tr_b16 a[38:39], v5 offset:8192
  v_mfma_f32_16x16x32_bf16 a[108:111], a[20:23], v[188:191], a[108:111]
  v_mul_u32_u24 v26, 3, v25
  v_sub_u32 v26, v24, v26
  v_mfma_f32_16x16x32_bf16 a[104:107], a[20:23], v[184:187], a[104:107]
  s_barrier
  v_and_b32 v27, 3, v0
  v_mfma_f32_16x16x32_bf16 a[100:103], a[20:23], v[180:183], a[100:103]
  s_waitcnt lgkmcnt(6)
  ds_read_b64_tr_b16 a[0:1], v4 offset:12288
  ds_read_b64_tr_b16 a[2:3], v4 offset:18432
  v_mfma_f32_16x16x32_bf16 a[112:115], a[24:27], v[180:183], a[112:115]
  buffer_load_dwordx4 a[188:191], v13, s[24:27], s50 offen offset:1024 sc1
  v_mfma_f32_16x16x32_bf16 a[116:119], a[24:27], v[184:187], a[116:119]
  v_lshl_add_u32 v26, v26, 4, v27
  v_mul_u32_u24 v26, 0x500, v26
  v_mfma_f32_16x16x32_bf16 a[120:123], a[24:27], v[188:191], a[120:123]
  s_waitcnt lgkmcnt(6)
  ds_read_b64_tr_b16 a[4:5], v5 offset:12288
  ds_read_b64_tr_b16 a[6:7], v5 offset:18432
  v_mfma_f32_16x16x32_bf16 a[132:135], a[28:31], v[188:191], a[132:135]
  buffer_load_dwordx4 a[192:195], v13, s[24:27], s50 offen offset:2048 sc1
  v_mfma_f32_16x16x32_bf16 a[128:131], a[28:31], v[184:187], a[128:131]
  v_lshl_add_u32 v26, v25, 6, v26
  v_bfe_u32 v27, v0, 2, 1
  v_mfma_f32_16x16x32_bf16 a[124:127], a[28:31], v[180:183], a[124:127]
  s_waitcnt lgkmcnt(6)
  ds_read_b64_tr_b16 a[8:9], v6 offset:12288
  ds_read_b64_tr_b16 a[10:11], v6 offset:18432
  v_mfma_f32_16x16x32_bf16 a[136:139], a[32:35], v[180:183], a[136:139]
  buffer_load_dword v31, v44, s[60:63], 0 offen sc1
  v_mfma_f32_16x16x32_bf16 a[140:143], a[32:35], v[184:187], a[140:143]
  s_add_u32 s50, s66, 0x2400
  v_lshl_add_u32 v14, v27, 4, v26
  v_add_u32 v23, 64, v0
  v_mfma_f32_16x16x32_bf16 a[144:147], a[32:35], v[188:191], a[144:147]
  s_waitcnt lgkmcnt(6)
  ds_read_b64_tr_b16 a[12:13], v7 offset:12288
  ds_read_b64_tr_b16 a[14:15], v7 offset:18432
  v_mfma_f32_16x16x32_bf16 a[156:159], a[36:39], v[188:191], a[156:159]
  buffer_load_dwordx4 a[196:199], v13, s[24:27], s50 offen sc1
  v_mfma_f32_16x16x32_bf16 a[152:155], a[36:39], v[184:187], a[152:155]
  v_lshrrev_b32 v24, 3, v23
  v_mul_u32_u24 v25, 0x56, v24
  v_mfma_f32_16x16x32_bf16 a[148:151], a[36:39], v[180:183], a[148:151]
  s_waitcnt vmcnt(10) lgkmcnt(6)
  ds_read_b64_tr_b16 a[16:17], v4 offset:13312
  ds_read_b64_tr_b16 a[18:19], v4 offset:19456
  v_mfma_f32_16x16x32_bf16 a[40:43], a[0:3], a[160:163], a[40:43]
  s_waitcnt vmcnt(9)
  buffer_load_dwordx4 a[200:203], v13, s[24:27], s50 offen offset:1024 sc1
  v_mfma_f32_16x16x32_bf16 a[44:47], a[0:3], a[164:167], a[44:47]
  s_waitcnt vmcnt(9)
  v_lshrrev_b32 v25, 8, v25
  v_mul_u32_u24 v26, 3, v25
  v_mfma_f32_16x16x32_bf16 a[48:51], a[0:3], a[168:171], a[48:51]
  s_waitcnt lgkmcnt(6)
  ds_read_b64_tr_b16 a[20:21], v5 offset:13312
  ds_read_b64_tr_b16 a[22:23], v5 offset:19456
  v_mfma_f32_16x16x32_bf16 a[60:63], a[4:7], a[168:171], a[60:63]
  v_sub_u32 v26, v24, v26
  v_and_b32 v27, 3, v0
  v_mfma_f32_16x16x32_bf16 a[56:59], a[4:7], a[164:167], a[56:59]
  buffer_load_dwordx4 a[204:207], v13, s[24:27], s50 offen offset:2048 sc1
  v_mfma_f32_16x16x32_bf16 a[52:55], a[4:7], a[160:163], a[52:55]
  s_waitcnt lgkmcnt(6)
  ds_read_b64_tr_b16 a[24:25], v6 offset:13312
  ds_read_b64_tr_b16 a[26:27], v6 offset:19456
  v_mfma_f32_16x16x32_bf16 a[64:67], a[8:11], a[160:163], a[64:67]
  s_add_u32 s50, s67, 0x1800
  v_lshl_add_u32 v26, v26, 4, v27
  v_mul_u32_u24 v26, 0x500, v26
  v_mfma_f32_16x16x32_bf16 a[68:71], a[8:11], a[164:167], a[68:71]
  v_lshl_add_u32 v26, v25, 6, v26
  v_bfe_u32 v27, v0, 2, 1
  v_mfma_f32_16x16x32_bf16 a[72:75], a[8:11], a[168:171], a[72:75]
  s_waitcnt lgkmcnt(6)
  ds_read_b64_tr_b16 a[28:29], v7 offset:13312
  ds_read_b64_tr_b16 a[30:31], v7 offset:19456
  v_mfma_f32_16x16x32_bf16 a[84:87], a[12:15], a[168:171], a[84:87]
  buffer_load_dwordx4 a[208:211], v13, s[24:27], s50 offen sc1
  v_mfma_f32_16x16x32_bf16 a[80:83], a[12:15], a[164:167], a[80:83]
  v_lshl_add_u32 v17, v27, 4, v26
  v_add_u32 v23, 8, v0
  v_mfma_f32_16x16x32_bf16 a[76:79], a[12:15], a[160:163], a[76:79]
  s_waitcnt lgkmcnt(6)
  ds_read_b64_tr_b16 a[32:33], v4 offset:14336
  ds_read_b64_tr_b16 a[34:35], v4 offset:20480
  v_mfma_f32_16x16x32_bf16 a[88:91], a[16:19], a[160:163], a[88:91]
  buffer_load_dwordx4 a[212:215], v13, s[24:27], s50 offen offset:1024 sc1
  v_mfma_f32_16x16x32_bf16 a[92:95], a[16:19], a[164:167], a[92:95]
  v_lshrrev_b32 v23, 6, v23
  v_lshlrev_b32 v23, 30, v23
  v_mfma_f32_16x16x32_bf16 a[96:99], a[16:19], a[168:171], a[96:99]
  s_waitcnt lgkmcnt(6)
  ds_read_b64_tr_b16 a[36:37], v5 offset:14336
  ds_read_b64_tr_b16 a[38:39], v5 offset:20480
  v_mfma_f32_16x16x32_bf16 a[108:111], a[20:23], a[168:171], a[108:111]
  v_add_u32 v4, 0xffff1000, v4
  v_add_u32 v5, 0xffff1000, v5
  v_mfma_f32_16x16x32_bf16 a[104:107], a[20:23], a[164:167], a[104:107]
  s_barrier
  v_add_u32 v6, 0xffff1000, v6
  v_mfma_f32_16x16x32_bf16 a[100:103], a[20:23], a[160:163], a[100:103]
  s_waitcnt lgkmcnt(6)
  v_add_u32 v7, 0xffff1000, v7
  v_add_u32 v17, v17, v23
  v_mfma_f32_16x16x32_bf16 a[112:115], a[24:27], a[160:163], a[112:115]
  buffer_load_dwordx4 a[216:219], v13, s[24:27], s50 offen offset:2048 sc1
  v_mfma_f32_16x16x32_bf16 a[116:119], a[24:27], a[164:167], a[116:119]
  s_add_u32 s50, s67, 0x2400
  ds_read_b64_tr_b16 a[0:1], v4 offset:0
  ds_read_b64_tr_b16 a[2:3], v4 offset:6144
  v_mfma_f32_16x16x32_bf16 a[120:123], a[24:27], a[168:171], a[120:123]
  s_waitcnt lgkmcnt(6)
  ds_read_b64_tr_b16 a[4:5], v5 offset:0
  ds_read_b64_tr_b16 a[6:7], v5 offset:6144
  v_mfma_f32_16x16x32_bf16 a[132:135], a[28:31], a[168:171], a[132:135]
  buffer_load_dwordx4 a[220:223], v13, s[24:27], s50 offen sc1
  v_mfma_f32_16x16x32_bf16 a[128:131], a[28:31], a[164:167], a[128:131]
  v_add_u32 v18, v19, v23
  s_mul_i32 s56, s40, 0x780
  s_mul_i32 s51, s36, 48
  v_mfma_f32_16x16x32_bf16 a[124:127], a[28:31], a[160:163], a[124:127]
  s_waitcnt lgkmcnt(6)
  ds_read_b64_tr_b16 a[8:9], v6 offset:0
  ds_read_b64_tr_b16 a[10:11], v6 offset:6144
  v_mfma_f32_16x16x32_bf16 a[136:139], a[32:35], a[160:163], a[136:139]
  buffer_load_dwordx4 a[224:227], v13, s[24:27], s50 offen offset:1024 sc1
  v_mfma_f32_16x16x32_bf16 a[140:143], a[32:35], a[164:167], a[140:143]
  s_lshr_b32 s52, s40, 1
  s_lshl_b32 s52, s52, 2
  s_add_u32 s51, s51, s52
  v_mfma_f32_16x16x32_bf16 a[144:147], a[32:35], a[168:171], a[144:147]
  s_waitcnt lgkmcnt(6)
  ds_read_b64_tr_b16 a[12:13], v7 offset:0
  ds_read_b64_tr_b16 a[14:15], v7 offset:6144
  v_mfma_f32_16x16x32_bf16 a[156:159], a[36:39], a[168:171], a[156:159]
  s_mul_i32 s51, s51, 0x500
  s_and_b32 s52, s40, 1
  s_lshl_b32 s52, s52, 5
  v_mfma_f32_16x16x32_bf16 a[152:155], a[36:39], a[164:167], a[152:155]
  buffer_load_dwordx4 a[228:231], v13, s[24:27], s50 offen offset:2048 sc1
  v_mfma_f32_16x16x32_bf16 a[148:151], a[36:39], a[160:163], a[148:151]
  s_waitcnt vmcnt(15) lgkmcnt(6)
  ds_read_b64_tr_b16 a[16:17], v4 offset:1024
  ds_read_b64_tr_b16 a[18:19], v4 offset:7168
  v_mfma_f32_16x16x32_bf16 a[40:43], a[0:3], a[172:175], a[40:43]
  s_waitcnt vmcnt(14)
  s_add_u32 s57, s51, s52
  s_mul_i32 s58, s40, 0x3c00
  s_mov_b32 s59, 0xffff0000
  v_mfma_f32_16x16x32_bf16 a[44:47], a[0:3], a[176:179], a[44:47]
  s_waitcnt vmcnt(13)
  s_add_u32 s47, s70, 0x28000
  s_add_u32 m0, s37, 0x3000
  v_mfma_f32_16x16x32_bf16 a[48:51], a[0:3], a[180:183], a[48:51]
  s_waitcnt lgkmcnt(6)
  ds_read_b64_tr_b16 a[20:21], v5 offset:1024
  ds_read_b64_tr_b16 a[22:23], v5 offset:7168
  v_mfma_f32_16x16x32_bf16 a[60:63], a[4:7], a[180:183], a[60:63]
  buffer_load_dwordx4 v15, s[20:23], s47 offen lds
  v_mfma_f32_16x16x32_bf16 a[56:59], a[4:7], a[176:179], a[56:59]
  v_mfma_f32_16x16x32_bf16 a[52:55], a[4:7], a[172:175], a[52:55]
  s_waitcnt lgkmcnt(6)
  s_add_u32 m0, s37, 0x3380
  ds_read_b64_tr_b16 a[24:25], v6 offset:1024
  v_mfma_f32_16x16x32_bf16 a[64:67], a[8:11], a[172:175], a[64:67]
  buffer_load_dwordx4 v15, s[20:23], s47 offen offset:128 lds
  v_mfma_f32_16x16x32_bf16 a[68:71], a[8:11], a[176:179], a[68:71]
  ds_read_b64_tr_b16 a[26:27], v6 offset:7168
  v_mfma_f32_16x16x32_bf16 a[72:75], a[8:11], a[180:183], a[72:75]
  s_waitcnt lgkmcnt(6)
  ds_read_b64_tr_b16 a[28:29], v7 offset:1024
  ds_read_b64_tr_b16 a[30:31], v7 offset:7168
  v_mfma_f32_16x16x32_bf16 a[84:87], a[12:15], a[180:183], a[84:87]
  s_add_u32 m0, s37, 0x3700
  v_mfma_f32_16x16x32_bf16 a[80:83], a[12:15], a[176:179], a[80:83]
  buffer_load_dwordx4 v16, s[20:23], s47 offen offset:256 lds
  v_mfma_f32_16x16x32_bf16 a[76:79], a[12:15], a[172:175], a[76:79]
  s_waitcnt lgkmcnt(6)
  ds_read_b64_tr_b16 a[32:33], v4 offset:2048
  ds_read_b64_tr_b16 a[34:35], v4 offset:8192
  v_mfma_f32_16x16x32_bf16 a[88:91], a[16:19], a[172:175], a[88:91]
  v_mfma_f32_16x16x32_bf16 a[92:95], a[16:19], a[176:179], a[92:95]
  s_add_u32 s46, s70, 0x32000
  s_add_u32 m0, s37, 0x12000
  v_mfma_f32_16x16x32_bf16 a[96:99], a[16:19], a[180:183], a[96:99]
  s_waitcnt lgkmcnt(6)
  ds_read_b64_tr_b16 a[36:37], v5 offset:2048
  ds_read_b64_tr_b16 a[38:39], v5 offset:8192
  v_mfma_f32_16x16x32_bf16 a[108:111], a[20:23], a[180:183], a[108:111]
  buffer_load_dwordx4 v15, s[20:23], s46 offen lds
  v_mfma_f32_16x16x32_bf16 a[104:107], a[20:23], a[176:179], a[104:107]
  s_barrier
  v_mfma_f32_16x16x32_bf16 a[100:103], a[20:23], a[172:175], a[100:103]
  s_waitcnt lgkmcnt(6)
  s_add_u32 m0, s37, 0x12380
  ds_read_b64_tr_b16 a[0:1], v4 offset:24576
  v_mfma_f32_16x16x32_bf16 a[112:115], a[24:27], a[172:175], a[112:115]
  buffer_load_dwordx4 v15, s[20:23], s46 offen offset:128 lds
  v_mfma_f32_16x16x32_bf16 a[116:119], a[24:27], a[176:179], a[116:119]
  ds_read_b64_tr_b16 a[2:3], v4 offset:30720
  v_mfma_f32_16x16x32_bf16 a[120:123], a[24:27], a[180:183], a[120:123]
  s_waitcnt lgkmcnt(6)
  ds_read_b64_tr_b16 a[4:5], v5 offset:24576
  ds_read_b64_tr_b16 a[6:7], v5 offset:30720
  v_mfma_f32_16x16x32_bf16 a[132:135], a[28:31], a[180:183], a[132:135]
  s_add_u32 m0, s37, 0x12700
  v_mfma_f32_16x16x32_bf16 a[128:131], a[28:31], a[176:179], a[128:131]
  buffer_load_dwordx4 v16, s[20:23], s46 offen offset:256 lds
  v_mfma_f32_16x16x32_bf16 a[124:127], a[28:31], a[172:175], a[124:127]
  s_waitcnt lgkmcnt(6)
  ds_read_b64_tr_b16 a[8:9], v6 offset:24576
  ds_read_b64_tr_b16 a[10:11], v6 offset:30720
  v_mfma_f32_16x16x32_bf16 a[136:139], a[32:35], a[172:175], a[136:139]
  v_mfma_f32_16x16x32_bf16 a[140:143], a[32:35], a[176:179], a[140:143]
  s_add_u32 s47, s71, 0x28000
  s_add_u32 m0, s37, 0x6000
  v_mfma_f32_16x16x32_bf16 a[144:147], a[32:35], a[180:183], a[144:147]
L_hop11:
  s_cbranch_execz L_hop_ret
  s_waitcnt lgkmcnt(6)
  ds_read_b64_tr_b16 a[12:13], v7 offset:24576
  ds_read_b64_tr_b16 a[14:15], v7 offset:30720
  v_mfma_f32_16x16x32_bf16 a[156:159], a[36:39], a[180:183], a[156:159]
  buffer_load_dwordx4 v15, s[20:23], s47 offen lds
  v_mfma_f32_16x16x32_bf16 a[152:155], a[36:39], a[176:179], a[152:155]
  v_mfma_f32_16x16x32_bf16 a[148:151], a[36:39], a[172:175], a[148:151]
  s_waitcnt vmcnt(19) lgkmcnt(6)
  s_add_u32 m0, s37, 0x6380
  ds_read_b64_tr_b16 a[16:17], v4 offset:25600
  v_mfma_f32_16x16x32_bf16 a[40:43], a[0:3], a[184:187], a[40:43]
  s_waitcnt vmcnt(18)
  buffer_load_dwordx4 v15, s[20:23], s47 offen offset:128 lds
  v_mfma_f32_16x16x32_bf16 a[44:47], a[0:3], a[188:191], a[44:47]
  s_waitcnt vmcnt(18)
  ds_read_b64_tr_b16 a[18:19], v4 offset:31744
  v_mfma_f32_16x16x32_bf16 a[48:51], a[0:3], a[192:195], a[48:51]
  s_waitcnt lgkmcnt(6)
  ds_read_b64_tr_b16 a[20:21], v5 offset:25600
  ds_read_b64_tr_b16 a[22:23], v5 offset:31744
  v_mfma_f32_16x16x32_bf16 a[60:63], a[4:7], a[192:195], a[60:63]
  s_add_u32 m0, s37, 0x6700
  v_mfma_f32_16x16x32_bf16 a[56:59], a[4:7], a[188:191], a[56:59]
  buffer_load_dwordx4 v16, s[20:23], s47 offen offset:256 lds
  v_mfma_f32_16x16x32_bf16 a[52:55], a[4:7], a[184:187], a[52:55]
  s_waitcnt lgkmcnt(6)
  ds_read_b64_tr_b16 a[24:25], v6 offset:25600
  ds_read_b64_tr_b16 a[26:27], v6 offset:31744
  v_mfma_f32_16x16x32_bf16 a[64:67], a[8:11], a[184:187], a[64:67]
  v_mfma_f32_16x16x32_bf16 a[68:71], a[8:11], a[188:191], a[68:71]
  s_add_u32 s46, s71, 0x32000
  s_add_u32 m0, s37, 0xc000
  v_mfma_f32_16x16x32_bf16 a[72:75], a[8:11], a[192:195], a[72:75]
  s_waitcnt lgkmcnt(6)
  ds_read_b64_tr_b16 a[28:29], v7 offset:25600
  ds_read_b64_tr_b16 a[30:31], v7 offset:31744
  v_mfma_f32_16x16x32_bf16 a[84:87], a[12:15], a[192:195], a[84:87]
  buffer_load_dwordx4 v15, s[20:23], s46 offen lds
  v_mfma_f32_16x16x32_bf16 a[80:83], a[12:15], a[188:191], a[80:83]
  v_mfma_f32_16x16x32_bf16 a[76:79], a[12:15], a[184:187], a[76:79]
  s_waitcnt lgkmcnt(6)
  s_add_u32 m0, s37, 0xc380
  ds_read_b64_tr_b16 a[32:33], v4 offset:26624
  v_mfma_f32_16x16x32_bf16 a[88:91], a[16:19], a[184:187], a[88:91]
  buffer_load_dwordx4 v15, s[20:23], s46 offen offset:128 lds
  v_mfma_f32_16x16x32_bf16 a[92:95], a[16:19], a[188:191], a[92:95]
  ds_read_b64_tr_b16 a[34:35], v4 offset:32768
  v_mfma_f32_16x16x32_bf16 a[96:99], a[16:19], a[192:195], a[96:99]
  s_waitcnt lgkmcnt(6)
  ds_read_b64_tr_b16 a[36:37], v5 offset:26624
  ds_read_b64_tr_b16 a[38:39], v5 offset:32768
  v_mfma_f32_16x16x32_bf16 a[108:111], a[20:23], a[192:195], a[108:111]
  s_add_u32 m0, s37, 0xc700
  v_add_u32 v4, 0xffff7000, v4
  v_add_u32 v5, 0xffff7000, v5
  v_mfma_f32_16x16x32_bf16 a[104:107], a[20:23], a[188:191], a[104:107]
  s_barrier
  v_add_u32 v6, 0xffff7000, v6
  v_mfma_f32_16x16x32_bf16 a[100:103], a[20:23], a[184:187], a[100:103]
  s_waitcnt lgkmcnt(6)
  v_add_u32 v7, 0xffff7000, v7
  v_mfma_f32_16x16x32_bf16 a[112:115], a[24:27], a[184:187], a[112:115]
  buffer_load_dwordx4 v16, s[20:23], s46 offen offset:256 lds
  v_mfma_f32_16x16x32_bf16 a[116:119], a[24:27], a[188:191], a[116:119]
  s_nop 0
  ds_read_b64_tr_b16 a[0:1], v4 offset:0
  ds_read_b64_tr_b16 a[2:3], v4 offset:6144
  v_mfma_f32_16x16x32_bf16 a[120:123], a[24:27], a[192:195], a[120:123]
  s_waitcnt lgkmcnt(6)
  ds_read_b64_tr_b16 a[4:5], v5 offset:0
  ds_read_b64_tr_b16 a[6:7], v5 offset:6144
  v_mfma_f32_16x16x32_bf16 a[132:135], a[28:31], a[192:195], a[132:135]
  v_mfma_f32_16x16x32_bf16 a[128:131], a[28:31], a[188:191], a[128:131]
  v_mfma_f32_16x16x32_bf16 a[124:127], a[28:31], a[184:187], a[124:127]
  s_waitcnt lgkmcnt(6)
  ds_read_b64_tr_b16 a[8:9], v6 offset:0
  ds_read_b64_tr_b16 a[10:11], v6 offset:6144
  v_mfma_f32_16x16x32_bf16 a[136:139], a[32:35], a[184:187], a[136:139]
  v_mfma_f32_16x16x32_bf16 a[140:143], a[32:35], a[188:191], a[140:143]
  v_mfma_f32_16x16x32_bf16 a[144:147], a[32:35], a[192:195], a[144:147]
  s_waitcnt lgkmcnt(6)
  ds_read_b64_tr_b16 a[12:13], v7 offset:0
  ds_read_b64_tr_b16 a[14:15], v7 offset:6144
  v_mfma_f32_16x16x32_bf16 a[156:159], a[36:39], a[192:195], a[156:159]
  v_mfma_f32_16x16x32_bf16 a[152:155], a[36:39], a[188:191], a[152:155]
  v_mfma_f32_16x16x32_bf16 a[148:151], a[36:39], a[184:187], a[148:151]
  s_waitcnt vmcnt(20) lgkmcnt(6)
  ds_read_b64_tr_b16 a[16:17], v4 offset:1024
  ds_read_b64_tr_b16 a[18:19], v4 offset:7168
  v_mfma_f32_16x16x32_bf16 a[40:43], a[0:3], a[196:199], a[40:43]
  s_waitcnt vmcnt(19)
  v_mfma_f32_16x16x32_bf16 a[44:47], a[0:3], a[200:203], a[44:47]
  s_waitcnt vmcnt(18)
  v_mfma_f32_16x16x32_bf16 a[48:51], a[0:3], a[204:207], a[48:51]
  s_waitcnt lgkmcnt(6)
  ds_read_b64_tr_b16 a[20:21], v5 offset:1024
  ds_read_b64_tr_b16 a[22:23], v5 offset:7168
  v_mfma_f32_16x16x32_bf16 a[60:63], a[4:7], a[204:207], a[60:63]
  v_mfma_f32_16x16x32_bf16 a[56:59], a[4:7], a[200:203], a[56:59]
  v_sub_u32 v31, v31, v46
  v_cmp_gt_u32 vcc, 3, v31
  s_nop 0
  s_cbranch_vccnz L_poll1_2
L_poll1_2_back:
  v_mfma_f32_16x16x32_bf16 a[52:55], a[4:7], a[196:199], a[52:55]
  s_waitcnt lgkmcnt(6)
  s_add_u32 s50, s65, 0x3000
  ds_read_b64_tr_b16 a[24:25], v6 offset:1024
  v_mfma_f32_16x16x32_bf16 a[64:67], a[8:11], a[196:199], a[64:67]
  buffer_load_dwordx4 v[192:195], v13, s[24:27], s50 offen sc1
  v_mfma_f32_16x16x32_bf16 a[68:71], a[8:11], a[200:203], a[68:71]
  ds_read_b64_tr_b16 a[26:27], v6 offset:7168
  v_mfma_f32_16x16x32_bf16 a[72:75], a[8:11], a[204:207], a[72:75]
  s_waitcnt lgkmcnt(6)
  ds_read_b64_tr_b16 a[28:29], v7 offset:1024
  ds_read_b64_tr_b16 a[30:31], v7 offset:7168
  v_mfma_f32_16x16x32_bf16 a[84:87], a[12:15], a[204:207], a[84:87]
  buffer_load_dwordx4 v[196:199], v13, s[24:27], s50 offen offset:1024 sc1
  v_mfma_f32_16x16x32_bf16 a[80:83], a[12:15], a[200:203], a[80:83]
  v_mfma_f32_16x16x32_bf16 a[76:79], a[12:15], a[196:199], a[76:79]
  s_waitcnt lgkmcnt(6)
  ds_read_b64_tr_b16 a[32:33], v4 offset:2048
  ds_read_b64_tr_b16 a[34:35], v4 offset:8192
  v_mfma_f32_16x16x32_bf16 a[88:91], a[16:19], a[196:199], a[88:91]
  v_mfma_f32_16x16x32_bf16 a[92:95], a[16:19], a[200:203], a[92:95]
  buffer_load_dwordx4 v[200:203], v13, s[24:27], s50 offen offset:2048 sc1
  v_mfma_f32_16x16x32_bf16 a[96:99], a[16:19], a[204:207], a[96:99]
  s_waitcnt lgkmcnt(6)
  ds_read_b64_tr_b16 a[36:37], v5 offset:2048
  ds_read_b64_tr_b16 a[38:39], v5 offset:8192
  v_mfma_f32_16x16x32_bf16 a[108:111], a[20:23], a[204:207], a[108:111]
  s_add_u32 s50, s65, 0x3c00
  v_add_u32 v4, 0x1e000, v4
  v_add_u32 v5, 0x1e000, v5
  v_mfma_f32_16x16x32_bf16 a[104:107], a[20:23], a[200:203], a[104:107]
  s_barrier
  v_add_u32 v6, 0x1e000, v6
  v_mfma_f32_16x16x32_bf16 a[100:103], a[20:23], a[196:199], a[100:103]
  s_waitcnt lgkmcnt(6)
  v_add_u32 v7, 0x1e000, v7
  v_mfma_f32_16x16x32_bf16 a[112:115], a[24:27], a[196:199], a[112:115]
  buffer_load_dwordx4 v[204:207], v13, s[24:27], s50 offen sc1
  v_mfma_f32_16x16x32_bf16 a[116:119], a[24:27], a[200:203], a[116:119]
  s_nop 0
  ds_read_b64_tr_b16 a[0:1], v4 offset:0
  ds_read_b64_tr_b16 a[2:3], v4 offset:6144
  v_mfma_f32_16x16x32_bf16 a[120:123], a[24:27], a[204:207], a[120:123]
  s_waitcnt lgkmcnt(6)
  ds_read_b64_tr_b16 a[4:5], v5 offset:0
  ds_read_b64_tr_b16 a[6:7], v5 offset:6144
  v_mfma_f32_16x16x32_bf16 a[132:135], a[28:31], a[204:207], a[132:135]
  buffer_load_dwordx4 v[208:211], v13, s[24:27], s50 offen offset:1024 sc1
  v_mfma_f32_16x16x32_bf16 a[128:131], a[28:31], a[200:203], a[128:131]
  v_mfma_f32_16x16x32_bf16 a[124:127], a[28:31], a[196:199], a[124:127]
  s_waitcnt lgkmcnt(6)
  ds_read_b64_tr_b16 a[8:9], v6 offset:0
  ds_read_b64_tr_b16 a[10:11], v6 offset:6144
  v_mfma_f32_16x16x32_bf16 a[136:139], a[32:35], a[196:199], a[136:139]
  v_mfma_f32_16x16x32_bf16 a[140:143], a[32:35], a[200:203], a[140:143]
  buffer_load_dwordx4 v[212:215], v13, s[24:27], s50 offen offset:2048 sc1
  v_mfma_f32_16x16x32_bf16 a[144:147], a[32:35], a[204:207], a[144:147]
  s_waitcnt lgkmcnt(6)
  ds_read_b64_tr_b16 a[12:13], v7 offset:0
  ds_read_b64_tr_b16 a[14:15], v7 offset:6144
  v_mfma_f32_16x16x32_bf16 a[156:159], a[36:39], a[204:207], a[156:159]
  s_add_u32 s50, s66, 0x3000
  v_mfma_f32_16x16x32_bf16 a[152:155], a[36:39], a[200:203], a[152:155]
  v_mfma_f32_16x16x32_bf16 a[148:151], a[36:39], a[196:199], a[148:151]
  s_waitcnt vmcnt(23) lgkmcnt(6)
  ds_read_b64_tr_b16 a[16:17], v4 offset:1024
  ds_read_b64_tr_b16 a[18:19], v4 offset:7168
  v_mfma_f32_16x16x32_bf16 a[40:43], a[0:3], a[208:211], a[40:43]
  s_waitcnt vmcnt(22)
  buffer_load_dwordx4 v[216:219], v13, s[24:27], s50 offen sc1
  v_mfma_f32_16x16x32_bf16 a[44:47], a[0:3], a[212:215], a[44:47]
  s_waitcnt vmcnt(22)
  v_mfma_f32_16x16x32_bf16 a[48:51], a[0:3], a[216:219], a[48:51]
  s_waitcnt lgkmcnt(6)
  ds_read_b64_tr_b16 a[20:21], v5 offset:1024
  ds_read_b64_tr_b16 a[22:23], v5 offset:7168
  v_mfma_f32_16x16x32_bf16 a[60:63], a[4:7], a[216:219], a[60:63]
  buffer_load_dwordx4 v[220:223], v13, s[24:27], s50 offen offset:1024 sc1
  v_mfma_f32_16x16x32_bf16 a[56:59], a[4:7], a[212:215], a[56:59]
  v_mfma_f32_16x16x32_bf16 a[52:55], a[4:7], a[208:211], a[52:55]
  s_waitcnt lgkmcnt(6)
  ds_read_b64_tr_b16 a[24:25], v6 offset:1024
  ds_read_b64_tr_b16 a[26:27], v6 offset:7168
  v_mfma_f32_16x16x32_bf16 a[64:67], a[8:11], a[208:211], a[64:67]
  v_mfma_f32_16x16x32_bf16 a[68:71], a[8:11], a[212:215], a[68:71]
  buffer_load_dwordx4 v[224:227], v13, s[24:27], s50 offen offset:2048 sc1
  v_mfma_f32_16x16x32_bf16 a[72:75], a[8:11], a[216:219], a[72:75]
  s_waitcnt lgkmcnt(6)
  ds_read_b64_tr_b16 a[28:29], v7 offset:1024
  ds_read_b64_tr_b16 a[30:31], v7 offset:7168
  v_mfma_f32_16x16x32_bf16 a[84:87], a[12:15], a[216:219], a[84:87]
  s_add_u32 s50, s66, 0x3c00
  v_mfma_f32_16x16x32_bf16 a[80:83], a[12:15], a[212:215], a[80:83]
  v_mfma_f32_16x16x32_bf16 a[76:79], a[12:15], a[208:211], a[76:79]
  s_waitcnt lgkmcnt(6)
  ds_read_b64_tr_b16 a[32:33], v4 offset:2048
  ds_read_b64_tr_b16 a[34:35], v4 offset:8192
  v_mfma_f32_16x16x32_bf16 a[88:91], a[16:19], a[208:211], a[88:91]
  buffer_load_dwordx4 v[228:231], v13, s[24:27], s50 offen sc1
  v_mfma_f32_16x16x32_bf16 a[92:95], a[16:19], a[212:215], a[92:95]
  v_mfma_f32_16x16x32_bf16 a[96:99], a[16:19], a[216:219], a[96:99]
  s_waitcnt lgkmcnt(6)
  ds_read_b64_tr_b16 a[36:37], v5 offset:2048
  ds_read_b64_tr_b16 a[38:39], v5 offset:8192
  v_mfma_f32_16x16x32_bf16 a[108:111], a[20:23], a[216:219], a[108:111]
  buffer_load_dwordx4 v[232:235], v13, s[24:27], s50 offen offset:1024 sc1
  v_mfma_f32_16x16x32_bf16 a[104:107], a[20:23], a[212:215], a[104:107]
  s_barrier
  v_mfma_f32_16x16x32_bf16 a[100:103], a[20:23], a[208:211], a[100:103]
  s_waitcnt lgkmcnt(6)
  ds_read_b64_tr_b16 a[0:1], v4 offset:12288
  ds_read_b64_tr_b16 a[2:3], v4 offset:18432
  v_mfma_f32_16x16x32_bf16 a[112:115], a[24:27], a[208:211], a[112:115]
  v_mfma_f32_16x16x32_bf16 a[116:119], a[24:27], a[212:215], a[116:119]
  buffer_load_dwordx4 v[236:239], v13, s[24:27], s50 offen offset:2048 sc1
  v_mfma_f32_16x16x32_bf16 a[120:123], a[24:27], a[216:219], a[120:123]
  s_waitcnt lgkmcnt(6)
  ds_read_b64_tr_b16 a[4:5], v5 offset:12288
  ds_read_b64_tr_b16 a[6:7], v5 offset:18432
  v_mfma_f32_16x16x32_bf16 a[132:135], a[28:31], a[216:219], a[132:135]
  s_add_u32 s50, s67, 0x3000
  v_mfma_f32_16x16x32_bf16 a[128:131], a[28:31], a[212:215], a[128:131]
  v_mfma_f32_16x16x32_bf16 a[124:127], a[28:31], a[208:211], a[124:127]
  s_waitcnt lgkmcnt(6)
  ds_read_b64_tr_b16 a[8:9], v6 offset:12288
  ds_read_b64_tr_b16 a[10:11], v6 offset:18432
  v_mfma_f32_16x16x32_bf16 a[136:139], a[32:35], a[208:211], a[136:139]
  buffer_load_dwordx4 v[48:51], v13, s[24:27], s50 offen sc1
  v_mfma_f32_16x16x32_bf16 a[140:143], a[32:35], a[212:215], a[140:143]
  v_mfma_f32_16x16x32_bf16 a[144:147], a[32:35], a[216:219], a[144:147]
  s_waitcnt lgkmcnt(6)
  ds_read_b64_tr_b16 a[12:13], v7 offset:12288
  ds_read_b64_tr_b16 a[14:15], v7 offset:18432
  v_mfma_f32_16x16x32_bf16 a[156:159], a[36:39], a[216:219], a[156:159]
  buffer_load_dwordx4 v[52:55], v13, s[24:27], s50 offen offset:1024 sc1
  v_mfma_f32_16x16x32_bf16 a[152:155], a[36:39], a[212:215], a[152:155]
  v_mfma_f32_16x16x32_bf16 a[148:151], a[36:39], a[208:211], a[148:151]
  s_waitcnt vmcnt(28) lgkmcnt(6)
  ds_read_b64_tr_b16 a[16:17], v4 offset:13312
  ds_read_b64_tr_b16 a[18:19], v4 offset:19456
  v_mfma_f32_16x16x32_bf16 a[40:43], a[0:3], a[220:223], a[40:43]
  s_waitcnt vmcnt(27)
  v_mfma_f32_16x16x32_bf16 a[44:47], a[0:3], a[224:227], a[44:47]
  s_waitcnt vmcnt(26)
  buffer_load_dwordx4 v[56:59], v13, s[24:27], s50 offen offset:2048 sc1
  v_mfma_f32_16x16x32_bf16 a[48:51], a[0:3], a[228:231], a[48:51]
  s_waitcnt lgkmcnt(6)
  ds_read_b64_tr_b16 a[20:21], v5 offset:13312
  ds_read_b64_tr_b16 a[22:23], v5 offset:19456
  v_mfma_f32_16x16x32_bf16 a[60:63], a[4:7], a[228:231], a[60:63]
  s_add_u32 s50, s67, 0x3c00
  v_mfma_f32_16x16x32_bf16 a[56:59], a[4:7], a[224:227], a[56:59]
  v_mfma_f32_16x16x32_bf16 a[52:55], a[4:7], a[220:223], a[52:55]
  s_waitcnt lgkmcnt(6)
  ds_read_b64_tr_b16 a[24:25], v6 offset:13312
  ds_read_b64_tr_b16 a[26:27], v6 offset:19456
  v_mfma_f32_16x16x32_bf16 a[64:67], a[8:11], a[220:223], a[64:67]
  buffer_load_dwordx4 v[60:63], v13, s[24:27], s50 offen sc1
  v_mfma_f32_16x16x32_bf16 a[68:71], a[8:11], a[224:227], a[68:71]
  v_mfma_f32_16x16x32_bf16 a[72:75], a[8:11], a[228:231], a[72:75]
  s_waitcnt lgkmcnt(6)
  ds_read_b64_tr_b16 a[28:29], v7 offset:13312
  ds_read_b64_tr_b16 a[30:31], v7 offset:19456
  v_mfma_f32_16x16x32_bf16 a[84:87], a[12:15], a[228:231], a[84:87]
  buffer_load_dwordx4 v[64:67], v13, s[24:27], s50 offen offset:1024 sc1
  v_mfma_f32_16x16x32_bf16 a[80:83], a[12:15], a[224:227], a[80:83]
  v_mfma_f32_16x16x32_bf16 a[76:79], a[12:15], a[220:223], a[76:79]
  s_waitcnt lgkmcnt(6)
  ds_read_b64_tr_b16 a[32:33], v4 offset:14336
  ds_read_b64_tr_b16 a[34:35], v4 offset:20480
  v_mfma_f32_16x16x32_bf16 a[88:91], a[16:19], a[220:223], a[88:91]
  v_mfma_f32_16x16x32_bf16 a[92:95], a[16:19], a[224:227], a[92:95]
  buffer_load_dwordx4 v[68:71], v13, s[24:27], s50 offen offset:2048 sc1
  v_mfma_f32_16x16x32_bf16 a[96:99], a[16:19], a[228:231], a[96:99]
  s_waitcnt lgkmcnt(6)
  ds_read_b64_tr_b16 a[36:37], v5 offset:14336
  ds_read_b64_tr_b16 a[38:39], v5 offset:20480
  v_mfma_f32_16x16x32_bf16 a[108:111], a[20:23], a[228:231], a[108:111]
  v_mfma_f32_16x16x32_bf16 a[104:107], a[20:23], a[224:227], a[104:107]
  s_waitcnt vmcnt(18)
  s_barrier
  v_mfma_f32_16x16x32_bf16 a[100:103], a[20:23], a[220:223], a[100:103]
  s_waitcnt lgkmcnt(6)
  v_add_u32 v240, 0xfffe2000, v4
  v_add_u32 v241, 0xfffe2000, v5
  v_mfma_f32_16x16x32_bf16 a[112:115], a[24:27], a[220:223], a[112:115]
  v_add_u32 v242, 0xfffe2000, v6
  v_add_u32 v243, 0xfffe2000, v7
  v_mfma_f32_16x16x32_bf16 a[116:119], a[24:27], a[224:227], a[116:119]
  v_add_u32 v244, 0xffff1000, v4
  v_add_u32 v245, 0xffff1000, v5
  v_mfma_f32_16x16x32_bf16 a[120:123], a[24:27], a[228:231], a[120:123]
  s_waitcnt lgkmcnt(4)
  v_add_u32 v246, 0xffff1000, v6
  v_add_u32 v247, 0xffff1000, v7
  v_mfma_f32_16x16x32_bf16 a[132:135], a[28:31], a[228:231], a[132:135]
  v_add_u32 v248, 0, v4
  v_add_u32 v249, 0, v5
  v_mfma_f32_16x16x32_bf16 a[128:131], a[28:31], a[224:227], a[128:131]
  v_add_u32 v250, 0, v6
  v_add_u32 v251, 0, v7
  v_mfma_f32_16x16x32_bf16 a[124:127], a[28:31], a[220:223], a[124:127]
  s_waitcnt lgkmcnt(2)
  ds_read_b64_tr_b16 a[0:1], v248 offset:24576
  ds_read_b64_tr_b16 a[2:3], v248 offset:30720
  v_mfma_f32_16x16x32_bf16 a[136:139], a[32:35], a[220:223], a[136:139]
  s_nop 0
  ds_read_b64_tr_b16 a[4:5], v249 offset:24576
  ds_read_b64_tr_b16 a[6:7], v249 offset:30720
  v_mfma_f32_16x16x32_bf16 a[140:143], a[32:35], a[224:227], a[140:143]
  s_nop 0
  ds_read_b64_tr_b16 a[8:9], v244 offset:24576
  ds_read_b64_tr_b16 a[10:11], v244 offset:30720
  v_mfma_f32_16x16x32_bf16 a[144:147], a[32:35], a[228:231], a[144:147]
  s_waitcnt lgkmcnt(6)
  ds_read_b64_tr_b16 a[12:13], v245 offset:24576
  ds_read_b64_tr_b16 a[14:15], v245 offset:30720
  v_mfma_f32_16x16x32_bf16 a[156:159], a[36:39], a[228:231], a[156:159]
  v_mfma_f32_16x16x32_bf16 a[152:155], a[36:39], a[224:227], a[152:155]
  v_mfma_f32_16x16x32_bf16 a[148:151], a[36:39], a[220:223], a[148:151]
  s_waitcnt vmcnt(17) lgkmcnt(6)
  ds_read_b64_tr_b16 a[16:17], v240 offset:12288
  ds_read_b64_tr_b16 a[18:19], v240 offset:18432
  v_mfma_f32_16x16x32_bf16 a[40:43], a[0:3], v[192:195], a[40:43]
  s_waitcnt vmcnt(16)
  v_mfma_f32_16x16x32_bf16 a[44:47], a[0:3], v[196:199], a[44:47]
  s_waitcnt vmcnt(15)
  v_mfma_f32_16x16x32_bf16 a[48:51], a[0:3], v[200:203], a[48:51]
  s_waitcnt lgkmcnt(6)
  ds_read_b64_tr_b16 a[20:21], v241 offset:12288
  ds_read_b64_tr_b16 a[22:23], v241 offset:18432
  v_mfma_f32_16x16x32_bf16 a[60:63], a[4:7], v[200:203], a[60:63]
  v_mfma_f32_16x16x32_bf16 a[56:59], a[4:7], v[196:199], a[56:59]
  v_mfma_f32_16x16x32_bf16 a[52:55], a[4:7], v[192:195], a[52:55]
  s_waitcnt vmcnt(14) lgkmcnt(6)
  ds_read_b64_tr_b16 a[24:25], v244 offset:12288
  ds_read_b64_tr_b16 a[26:27], v244 offset:18432
  v_mfma_f32_16x16x32_bf16 a[40:43], a[8:11], v[204:207], a[40:43]
  s_waitcnt vmcnt(13)
  v_mfma_f32_16x16x32_bf16 a[44:47], a[8:11], v[208:211], a[44:47]
  s_waitcnt vmcnt(12)
  v_mfma_f32_16x16x32_bf16 a[48:51], a[8:11], v[212:215], a[48:51]
  s_waitcnt lgkmcnt(6)
  ds_read_b64_tr_b16 a[28:29], v245 offset:12288
  ds_read_b64_tr_b16 a[30:31], v245 offset:18432
  v_mfma_f32_16x16x32_bf16 a[60:63], a[12:15], v[212:215], a[60:63]
  v_mfma_f32_16x16x32_bf16 a[56:59], a[12:15], v[208:211], a[56:59]
  v_mfma_f32_16x16x32_bf16 a[52:55], a[12:15], v[204:207], a[52:55]
  s_waitcnt vmcnt(11) lgkmcnt(6)
  ds_read_b64_tr_b16 a[32:33], v240 offset:24576
  ds_read_b64_tr_b16 a[34:35], v240 offset:30720
  v_mfma_f32_16x16x32_bf16 a[40:43], a[16:19], v[216:219], a[40:43]
  s_waitcnt vmcnt(10)
  v_mfma_f32_16x16x32_bf16 a[44:47], a[16:19], v[220:223], a[44:47]
  s_waitcnt vmcnt(9)
  v_mfma_f32_16x16x32_bf16 a[48:51], a[16:19], v[224:227], a[48:51]
  s_waitcnt lgkmcnt(6)
  ds_read_b64_tr_b16 a[36:37], v241 offset:24576
  ds_read_b64_tr_b16 a[38:39], v241 offset:30720
  v_mfma_f32_16x16x32_bf16 a[60:63], a[20:23], v[224:227], a[60:63]
  v_mfma_f32_16x16x32_bf16 a[56:59], a[20:23], v[220:223], a[56:59]
  v_mfma_f32_16x16x32_bf16 a[52:55], a[20:23], v[216:219], a[52:55]
  s_waitcnt vmcnt(8) lgkmcnt(6)
  ds_read_b64_tr_b16 a[0:1], v240 offset:49152
  ds_read_b64_tr_b16 a[2:3], v240 offset:55296
  v_mfma_f32_16x16x32_bf16 a[40:43], a[24:27], v[228:231], a[40:43]
  s_waitcnt vmcnt(7)
  v_mfma_f32_16x16x32_bf16 a[44:47], a[24:27], v[232:235], a[44:47]
  s_waitcnt vmcnt(6)
  v_mfma_f32_16x16x32_bf16 a[48:51], a[24:27], v[236:239], a[48:51]
  s_waitcnt lgkmcnt(6)
  ds_read_b64_tr_b16 a[4:5], v241 offset:49152
  ds_read_b64_tr_b16 a[6:7], v241 offset:55296
  v_mfma_f32_16x16x32_bf16 a[60:63], a[28:31], v[236:239], a[60:63]
  v_mfma_f32_16x16x32_bf16 a[56:59], a[28:31], v[232:235], a[56:59]
  v_mfma_f32_16x16x32_bf16 a[52:55], a[28:31], v[228:231], a[52:55]
  s_waitcnt vmcnt(5) lgkmcnt(6)
  ds_read_b64_tr_b16 a[8:9], v250 offset:24576
  ds_read_b64_tr_b16 a[10:11], v250 offset:30720
  v_mfma_f32_16x16x32_bf16 a[40:43], a[32:35], v[48:51], a[40:43]
  s_waitcnt vmcnt(4)
  v_mfma_f32_16x16x32_bf16 a[44:47], a[32:35], v[52:55], a[44:47]
  s_waitcnt vmcnt(3)
  v_mfma_f32_16x16x32_bf16 a[48:51], a[32:35], v[56:59], a[48:51]
  s_waitcnt lgkmcnt(6)
  ds_read_b64_tr_b16 a[12:13], v251 offset:24576
  ds_read_b64_tr_b16 a[14:15], v251 offset:30720
  v_mfma_f32_16x16x32_bf16 a[60:63], a[36:39], v[56:59], a[60:63]
  v_mfma_f32_16x16x32_bf16 a[56:59], a[36:39], v[52:55], a[56:59]
  v_mfma_f32_16x16x32_bf16 a[52:55], a[36:39], v[48:51], a[52:55]
  s_waitcnt vmcnt(2) lgkmcnt(6)
  ds_read_b64_tr_b16 a[16:17], v246 offset:24576
  ds_read_b64_tr_b16 a[18:19], v246 offset:30720
  v_mfma_f32_16x16x32_bf16 a[40:43], a[0:3], v[60:63], a[40:43]
  s_waitcnt vmcnt(1)
  v_mfma_f32_16x16x32_bf16 a[44:47], a[0:3], v[64:67], a[44:47]
  s_waitcnt vmcnt(0)
  v_mfma_f32_16x16x32_bf16 a[48:51], a[0:3], v[68:71], a[48:51]
  s_waitcnt lgkmcnt(6)
  ds_read_b64_tr_b16 a[20:21], v247 offset:24576
  ds_read_b64_tr_b16 a[22:23], v247 offset:30720
  v_mfma_f32_16x16x32_bf16 a[60:63], a[4:7], v[68:71], a[60:63]
  v_mfma_f32_16x16x32_bf16 a[56:59], a[4:7], v[64:67], a[56:59]
  v_mfma_f32_16x16x32_bf16 a[52:55], a[4:7], v[60:63], a[52:55]
  s_waitcnt lgkmcnt(6)
  ds_read_b64_tr_b16 a[24:25], v242 offset:12288
  ds_read_b64_tr_b16 a[26:27], v242 offset:18432
  v_mfma_f32_16x16x32_bf16 a[64:67], a[8:11], v[192:195], a[64:67]
  v_mfma_f32_16x16x32_bf16 a[68:71], a[8:11], v[196:199], a[68:71]
  v_accvgpr_read_b32 v72, a40
  v_accvgpr_read_b32 v73, a41
  v_mfma_f32_16x16x32_bf16 a[72:75], a[8:11], v[200:203], a[72:75]
  s_waitcnt lgkmcnt(6)
  v_accvgpr_read_b32 v74, a42
  v_accvgpr_read_b32 v75, a43
  v_mfma_f32_16x16x32_bf16 a[84:87], a[12:15], v[200:203], a[84:87]
  v_accvgpr_read_b32 v76, a52
  v_accvgpr_read_b32 v77, a53
  v_mfma_f32_16x16x32_bf16 a[80:83], a[12:15], v[196:199], a[80:83]
  v_accvgpr_read_b32 v78, a54
  v_accvgpr_read_b32 v79, a55
  v_mfma_f32_16x16x32_bf16 a[76:79], a[12:15], v[192:195], a[76:79]
  s_waitcnt lgkmcnt(4)
  v_cvt_pk_bf16_f32 v80, v72, v73
  v_cvt_pk_bf16_f32 v81, v74, v75
  v_mfma_f32_16x16x32_bf16 a[64:67], a[16:19], v[204:207], a[64:67]
  v_cvt_pk_bf16_f32 v82, v76, v77
  v_cvt_pk_bf16_f32 v83, v78, v79
  v_mfma_f32_16x16x32_bf16 a[68:71], a[16:19], v[208:211], a[68:71]
  v_permlane16_swap_b32 v80, v82
  v_mfma_f32_16x16x32_bf16 a[72:75], a[16:19], v[212:215], a[72:75]
  s_waitcnt lgkmcnt(2)
  ds_read_b64_tr_b16 a[28:29], v243 offset:12288
  ds_read_b64_tr_b16 a[30:31], v243 offset:18432
  v_mfma_f32_16x16x32_bf16 a[84:87], a[20:23], v[212:215], a[84:87]
  v_permlane16_swap_b32 v81, v83
  v_mfma_f32_16x16x32_bf16 a[80:83], a[20:23], v[208:211], a[80:83]
  buffer_store_dwordx4 v[80:83], v12, s[28:31], s56 offen sc1
  v_mfma_f32_16x16x32_bf16 a[76:79], a[20:23], v[204:207], a[76:79]
  s_waitcnt lgkmcnt(2)
  ds_read_b64_tr_b16 a[32:33], v246 offset:12288
  ds_read_b64_tr_b16 a[34:35], v246 offset:18432
  v_mfma_f32_16x16x32_bf16 a[64:67], a[24:27], v[216:219], a[64:67]
  v_accvgpr_read_b32 v84, a44
  v_accvgpr_read_b32 v85, a45
  v_mfma_f32_16x16x32_bf16 a[68:71], a[24:27], v[220:223], a[68:71]
  v_accvgpr_read_b32 v86, a46
  v_accvgpr_read_b32 v87, a47
  v_mfma_f32_16x16x32_bf16 a[72:75], a[24:27], v[224:227], a[72:75]
  s_waitcnt lgkmcnt(2)
  ds_read_b64_tr_b16 a[36:37], v247 offset:12288
  ds_read_b64_tr_b16 a[38:39], v247 offset:18432
  v_mfma_f32_16x16x32_bf16 a[84:87], a[28:31], v[224:227], a[84:87]
  v_accvgpr_read_b32 v88, a56
  v_accvgpr_read_b32 v89, a57
  v_mfma_f32_16x16x32_bf16 a[80:83], a[28:31], v[220:223], a[80:83]
  v_accvgpr_read_b32 v90, a58
  v_accvgpr_read_b32 v91, a59
  v_mfma_f32_16x16x32_bf16 a[76:79], a[28:31], v[216:219], a[76:79]
  s_waitcnt lgkmcnt(2)
  ds_read_b64_tr_b16 a[0:1], v242 offset:24576
  ds_read_b64_tr_b16 a[2:3], v242 offset:30720
  v_mfma_f32_16x16x32_bf16 a[64:67], a[32:35], v[228:231], a[64:67]
  v_cvt_pk_bf16_f32 v92, v84, v85
  v_cvt_pk_bf16_f32 v93, v86, v87
  v_mfma_f32_16x16x32_bf16 a[68:71], a[32:35], v[232:235], a[68:71]
  v_cvt_pk_bf16_f32 v94, v88, v89
  v_cvt_pk_bf16_f32 v95, v90, v91
  v_mfma_f32_16x16x32_bf16 a[72:75], a[32:35], v[236:239], a[72:75]
  s_waitcnt lgkmcnt(2)
  ds_read_b64_tr_b16 a[4:5], v243 offset:24576
  ds_read_b64_tr_b16 a[6:7], v243 offset:30720
  v_mfma_f32_16x16x32_bf16 a[84:87], a[36:39], v[236:239], a[84:87]
  v_permlane16_swap_b32 v92, v94
  v_mfma_f32_16x16x32_bf16 a[80:83], a[36:39], v[232:235], a[80:83]
  v_permlane16_swap_b32 v93, v95
  v_mfma_f32_16x16x32_bf16 a[76:79], a[36:39], v[228:231], a[76:79]
  s_waitcnt lgkmcnt(2)
  ds_read_b64_tr_b16 a[8:9], v242 offset:49152
  ds_read_b64_tr_b16 a[10:11], v242 offset:55296
  v_mfma_f32_16x16x32_bf16 a[64:67], a[0:3], v[48:51], a[64:67]
  buffer_store_dwordx4 v[92:95], v12, s[28:31], s56 offen offset:128 sc1
  v_mfma_f32_16x16x32_bf16 a[68:71], a[0:3], v[52:55], a[68:71]
  v_accvgpr_read_b32 v96, a48
  v_accvgpr_read_b32 v97, a49
  v_mfma_f32_16x16x32_bf16 a[72:75], a[0:3], v[56:59], a[72:75]
  s_waitcnt lgkmcnt(2)
  ds_read_b64_tr_b16 a[12:13], v243 offset:49152
  ds_read_b64_tr_b16 a[14:15], v243 offset:55296
  v_mfma_f32_16x16x32_bf16 a[84:87], a[4:7], v[56:59], a[84:87]
  v_accvgpr_read_b32 v98, a50
  v_accvgpr_read_b32 v99, a51
  v_mfma_f32_16x16x32_bf16 a[80:83], a[4:7], v[52:55], a[80:83]
  v_accvgpr_read_b32 v100, a60
  v_accvgpr_read_b32 v101, a61
  v_mfma_f32_16x16x32_bf16 a[76:79], a[4:7], v[48:51], a[76:79]
  s_waitcnt lgkmcnt(2)
  ds_read_b64_tr_b16 a[16:17], v248 offset:25600
  ds_read_b64_tr_b16 a[18:19], v248 offset:31744
  v_mfma_f32_16x16x32_bf16 a[64:67], a[8:11], v[60:63], a[64:67]
  v_accvgpr_read_b32 v102, a62
  v_accvgpr_read_b32 v103, a63
  v_mfma_f32_16x16x32_bf16 a[68:71], a[8:11], v[64:67], a[68:71]
  v_cvt_pk_bf16_f32 v104, v96, v97
  v_cvt_pk_bf16_f32 v105, v98, v99
  v_mfma_f32_16x16x32_bf16 a[72:75], a[8:11], v[68:71], a[72:75]
  s_waitcnt lgkmcnt(2)
  ds_read_b64_tr_b16 a[20:21], v249 offset:25600
  ds_read_b64_tr_b16 a[22:23], v249 offset:31744
  v_mfma_f32_16x16x32_bf16 a[84:87], a[12:15], v[68:71], a[84:87]
  v_cvt_pk_bf16_f32 v106, v100, v101
  v_cvt_pk_bf16_f32 v107, v102, v103
  v_mfma_f32_16x16x32_bf16 a[80:83], a[12:15], v[64:67], a[80:83]
  v_permlane16_swap_b32 v104, v106
  v_mfma_f32_16x16x32_bf16 a[76:79], a[12:15], v[60:63], a[76:79]
  s_waitcnt lgkmcnt(2)
  ds_read_b64_tr_b16 a[24:25], v244 offset:25600
  ds_read_b64_tr_b16 a[26:27], v244 offset:31744
  v_permlane16_swap_b32 v105, v107
  buffer_store_dwordx4 v[104:107], v12, s[28:31], s56 offen offset:256 sc1
  v_mfma_f32_16x16x32_bf16 a[88:91], a[16:19], v[192:195], a[88:91]
  s_nop 0
  ds_read_b64_tr_b16 a[28:29], v245 offset:25600
  ds_read_b64_tr_b16 a[30:31], v245 offset:31744
  v_mfma_f32_16x16x32_bf16 a[92:95], a[16:19], v[196:199], a[92:95]
  v_accvgpr_read_b32 v108, a64
  v_accvgpr_read_b32 v109, a65
  v_mfma_f32_16x16x32_bf16 a[96:99], a[16:19], v[200:203], a[96:99]
  s_waitcnt lgkmcnt(4)
  v_accvgpr_read_b32 v110, a66
  v_accvgpr_read_b32 v111, a67
  v_mfma_f32_16x16x32_bf16 a[108:111], a[20:23], v[200:203], a[108:111]
  v_accvgpr_read_b32 v112, a76
  v_accvgpr_read_b32 v113, a77
  v_mfma_f32_16x16x32_bf16 a[104:107], a[20:23], v[196:199], a[104:107]
  v_accvgpr_read_b32 v114, a78
  v_accvgpr_read_b32 v115, a79
  v_mfma_f32_16x16x32_bf16 a[100:103], a[20:23], v[192:195], a[100:103]
  s_waitcnt lgkmcnt(2)
  ds_read_b64_tr_b16 a[32:33], v240 offset:13312
  ds_read_b64_tr_b16 a[34:35], v240 offset:19456
  v_mfma_f32_16x16x32_bf16 a[88:91], a[24:27], v[204:207], a[88:91]
  v_cvt_pk_bf16_f32 v116, v108, v109
  v_cvt_pk_bf16_f32 v117, v110, v111
  v_mfma_f32_16x16x32_bf16 a[92:95], a[24:27], v[208:211], a[92:95]
  v_cvt_pk_bf16_f32 v118, v112, v113
  v_cvt_pk_bf16_f32 v119, v114, v115
  v_mfma_f32_16x16x32_bf16 a[96:99], a[24:27], v[212:215], a[96:99]
  s_waitcnt lgkmcnt(2)
  ds_read_b64_tr_b16 a[36:37], v241 offset:13312
  ds_read_b64_tr_b16 a[38:39], v241 offset:19456
  v_mfma_f32_16x16x32_bf16 a[108:111], a[28:31], v[212:215], a[108:111]
  v_permlane16_swap_b32 v116, v118
  v_mfma_f32_16x16x32_bf16 a[104:107], a[28:31], v[208:211], a[104:107]
  v_permlane16_swap_b32 v117, v119
  v_mfma_f32_16x16x32_bf16 a[100:103], a[28:31], v[204:207], a[100:103]
  s_waitcnt lgkmcnt(2)
  ds_read_b64_tr_b16 a[0:1], v244 offset:13312
  ds_read_b64_tr_b16 a[2:3], v244 offset:19456
  v_mfma_f32_16x16x32_bf16 a[88:91], a[32:35], v[216:219], a[88:91]
  buffer_store_dwordx4 v[116:119], v12, s[28:31], s56 offen offset:384 sc1
  v_mfma_f32_16x16x32_bf16 a[92:95], a[32:35], v[220:223], a[92:95]
  v_accvgpr_read_b32 v72, a68
  v_accvgpr_read_b32 v73, a69
  v_mfma_f32_16x16x32_bf16 a[96:99], a[32:35], v[224:227], a[96:99]
  s_waitcnt lgkmcnt(2)
  ds_read_b64_tr_b16 a[4:5], v245 offset:13312
L_hop12:
  s_cbranch_execz L_hop_ret
  ds_read_b64_tr_b16 a[6:7], v245 offset:19456
  v_mfma_f32_16x16x32_bf16 a[108:111], a[36:39], v[224:227], a[108:111]
  v_accvgpr_read_b32 v74, a70
  v_accvgpr_read_b32 v75, a71
  v_mfma_f32_16x16x32_bf16 a[104:107], a[36:39], v[220:223], a[104:107]
  v_accvgpr_read_b32 v76, a80
  v_accvgpr_read_b32 v77, a81
  v_mfma_f32_16x16x32_bf16 a[100:103], a[36:39], v[216:219], a[100:103]
  s_waitcnt lgkmcnt(2)
  ds_read_b64_tr_b16 a[8:9], v240 offset:25600
  ds_read_b64_tr_b16 a[10:11], v240 offset:31744
  v_mfma_f32_16x16x32_bf16 a[88:91], a[0:3], v[228:231], a[88:91]
  v_accvgpr_read_b32 v78, a82
  v_accvgpr_read_b32 v79, a83
  v_mfma_f32_16x16x32_bf16 a[92:95], a[0:3], v[232:235], a[92:95]
  v_cvt_pk_bf16_f32 v80, v72, v73
  v_cvt_pk_bf16_f32 v81, v74, v75
  v_mfma_f32_16x16x32_bf16 a[96:99], a[0:3], v[236:239], a[96:99]
  s_waitcnt lgkmcnt(2)
  ds_read_b64_tr_b16 a[12:13], v241 offset:25600
  ds_read_b64_tr_b16 a[14:15], v241 offset:31744
  v_mfma_f32_16x16x32_bf16 a[108:111], a[4:7], v[236:239], a[108:111]
  v_cvt_pk_bf16_f32 v82, v76, v77
  v_cvt_pk_bf16_f32 v83, v78, v79
  v_mfma_f32_16x16x32_bf16 a[104:107], a[4:7], v[232:235], a[104:107]
  v_permlane16_swap_b32 v80, v82
  v_mfma_f32_16x16x32_bf16 a[100:103], a[4:7], v[228:231], a[100:103]
  s_waitcnt lgkmcnt(2)
  ds_read_b64_tr_b16 a[16:17], v240 offset:50176
  ds_read_b64_tr_b16 a[18:19], v240 offset:56320
  v_mfma_f32_16x16x32_bf16 a[88:91], a[8:11], v[48:51], a[88:91]
  v_permlane16_swap_b32 v81, v83
  v_mfma_f32_16x16x32_bf16 a[92:95], a[8:11], v[52:55], a[92:95]
  buffer_store_dwordx4 v[80:83], v12, s[28:31], s56 offen offset:512 sc1
  v_mfma_f32_16x16x32_bf16 a[96:99], a[8:11], v[56:59], a[96:99]
  s_waitcnt lgkmcnt(2)
  ds_read_b64_tr_b16 a[20:21], v241 offset:50176
  ds_read_b64_tr_b16 a[22:23], v241 offset:56320
  v_mfma_f32_16x16x32_bf16 a[108:111], a[12:15], v[56:59], a[108:111]
  v_accvgpr_read_b32 v84, a72
  v_accvgpr_read_b32 v85, a73
  v_mfma_f32_16x16x32_bf16 a[104:107], a[12:15], v[52:55], a[104:107]
  v_accvgpr_read_b32 v86, a74
  v_accvgpr_read_b32 v87, a75
  v_mfma_f32_16x16x32_bf16 a[100:103], a[12:15], v[48:51], a[100:103]
  s_waitcnt lgkmcnt(2)
  ds_read_b64_tr_b16 a[24:25], v250 offset:25600
  ds_read_b64_tr_b16 a[26:27], v250 offset:31744
  v_mfma_f32_16x16x32_bf16 a[88:91], a[16:19], v[60:63], a[88:91]
  v_accvgpr_read_b32 v88, a84
  v_accvgpr_read_b32 v89, a85
  v_mfma_f32_16x16x32_bf16 a[92:95], a[16:19], v[64:67], a[92:95]
  v_accvgpr_read_b32 v90, a86
  v_accvgpr_read_b32 v91, a87
  v_mfma_f32_16x16x32_bf16 a[96:99], a[16:19], v[68:71], a[96:99]
  s_waitcnt lgkmcnt(2)
  ds_read_b64_tr_b16 a[28:29], v251 offset:25600
  ds_read_b64_tr_b16 a[30:31], v251 offset:31744
  v_mfma_f32_16x16x32_bf16 a[108:111], a[20:23], v[68:71], a[108:111]
  v_cvt_pk_bf16_f32 v92, v84, v85
  v_cvt_pk_bf16_f32 v93, v86, v87
  v_mfma_f32_16x16x32_bf16 a[104:107], a[20:23], v[64:67], a[104:107]
  v_cvt_pk_bf16_f32 v94, v88, v89
  v_cvt_pk_bf16_f32 v95, v90, v91
  v_mfma_f32_16x16x32_bf16 a[100:103], a[20:23], v[60:63], a[100:103]
  s_waitcnt lgkmcnt(2)
  ds_read_b64_tr_b16 a[32:33], v246 offset:25600
  ds_read_b64_tr_b16 a[34:35], v246 offset:31744
  v_permlane16_swap_b32 v92, v94
  v_permlane16_swap_b32 v93, v95
  buffer_store_dwordx4 v[92:95], v12, s[28:31], s56 offen offset:640 sc1
  v_mfma_f32_16x16x32_bf16 a[112:115], a[24:27], v[192:195], a[112:115]
  s_nop 0
  ds_read_b64_tr_b16 a[36:37], v247 offset:25600
  ds_read_b64_tr_b16 a[38:39], v247 offset:31744
  v_mfma_f32_16x16x32_bf16 a[116:119], a[24:27], v[196:199], a[116:119]
  v_accvgpr_read_b32 v96, a88
  v_accvgpr_read_b32 v97, a89
  v_mfma_f32_16x16x32_bf16 a[120:123], a[24:27], v[200:203], a[120:123]
  s_waitcnt lgkmcnt(4)
  v_accvgpr_read_b32 v98, a90
  v_accvgpr_read_b32 v99, a91
  v_mfma_f32_16x16x32_bf16 a[132:135], a[28:31], v[200:203], a[132:135]
  v_accvgpr_read_b32 v100, a100
  v_accvgpr_read_b32 v101, a101
  v_mfma_f32_16x16x32_bf16 a[128:131], a[28:31], v[196:199], a[128:131]
  v_accvgpr_read_b32 v102, a102
  v_accvgpr_read_b32 v103, a103
  v_mfma_f32_16x16x32_bf16 a[124:127], a[28:31], v[192:195], a[124:127]
  s_waitcnt lgkmcnt(2)
  ds_read_b64_tr_b16 a[0:1], v242 offset:13312
  ds_read_b64_tr_b16 a[2:3], v242 offset:19456
  v_mfma_f32_16x16x32_bf16 a[112:115], a[32:35], v[204:207], a[112:115]
  v_cvt_pk_bf16_f32 v104, v96, v97
  v_cvt_pk_bf16_f32 v105, v98, v99
  v_mfma_f32_16x16x32_bf16 a[116:119], a[32:35], v[208:211], a[116:119]
  v_cvt_pk_bf16_f32 v106, v100, v101
  v_cvt_pk_bf16_f32 v107, v102, v103
  v_mfma_f32_16x16x32_bf16 a[120:123], a[32:35], v[212:215], a[120:123]
  s_waitcnt lgkmcnt(2)
  ds_read_b64_tr_b16 a[4:5], v243 offset:13312
  ds_read_b64_tr_b16 a[6:7], v243 offset:19456
  v_mfma_f32_16x16x32_bf16 a[132:135], a[36:39], v[212:215], a[132:135]
  v_permlane16_swap_b32 v104, v106
  v_mfma_f32_16x16x32_bf16 a[128:131], a[36:39], v[208:211], a[128:131]
  v_permlane16_swap_b32 v105, v107
  v_mfma_f32_16x16x32_bf16 a[124:127], a[36:39], v[204:207], a[124:127]
  s_waitcnt lgkmcnt(2)
  ds_read_b64_tr_b16 a[8:9], v246 offset:13312
  ds_read_b64_tr_b16 a[10:11], v246 offset:19456
  v_mfma_f32_16x16x32_bf16 a[112:115], a[0:3], v[216:219], a[112:115]
  buffer_store_dwordx4 v[104:107], v12, s[28:31], s56 offen offset:768 sc1
  v_mfma_f32_16x16x32_bf16 a[116:119], a[0:3], v[220:223], a[116:119]
  v_accvgpr_read_b32 v108, a92
  v_accvgpr_read_b32 v109, a93
  v_mfma_f32_16x16x32_bf16 a[120:123], a[0:3], v[224:227], a[120:123]
  s_waitcnt lgkmcnt(2)
  ds_read_b64_tr_b16 a[12:13], v247 offset:13312
  ds_read_b64_tr_b16 a[14:15], v247 offset:19456
  v_mfma_f32_16x16x32_bf16 a[132:135], a[4:7], v[224:227], a[132:135]
  v_accvgpr_read_b32 v110, a94
  v_accvgpr_read_b32 v111, a95
  v_mfma_f32_16x16x32_bf16 a[128:131], a[4:7], v[220:223], a[128:131]
  v_accvgpr_read_b32 v112, a104
  v_accvgpr_read_b32 v113, a105
  v_mfma_f32_16x16x32_bf16 a[124:127], a[4:7], v[216:219], a[124:127]
  s_waitcnt lgkmcnt(2)
  ds_read_b64_tr_b16 a[16:17], v242 offset:25600
  ds_read_b64_tr_b16 a[18:19], v242 offset:31744
  v_mfma_f32_16x16x32_bf16 a[112:115], a[8:11], v[228:231], a[112:115]
  v_accvgpr_read_b32 v114, a106
  v_accvgpr_read_b32 v115, a107
  v_mfma_f32_16x16x32_bf16 a[116:119], a[8:11], v[232:235], a[116:119]
  v_cvt_pk_bf16_f32 v116, v108, v109
  v_cvt_pk_bf16_f32 v117, v110, v111
  v_mfma_f32_16x16x32_bf16 a[120:123], a[8:11], v[236:239], a[120:123]
  s_waitcnt lgkmcnt(2)
  ds_read_b64_tr_b16 a[20:21], v243 offset:25600
  ds_read_b64_tr_b16 a[22:23], v243 offset:31744
  v_mfma_f32_16x16x32_bf16 a[132:135], a[12:15], v[236:239], a[132:135]
  v_cvt_pk_bf16_f32 v118, v112, v113
  v_cvt_pk_bf16_f32 v119, v114, v115
  v_mfma_f32_16x16x32_bf16 a[128:131], a[12:15], v[232:235], a[128:131]
  v_permlane16_swap_b32 v116, v118
  v_mfma_f32_16x16x32_bf16 a[124:127], a[12:15], v[228:231], a[124:127]
  s_waitcnt lgkmcnt(2)
  ds_read_b64_tr_b16 a[24:25], v242 offset:50176
  ds_read_b64_tr_b16 a[26:27], v242 offset:56320
  v_mfma_f32_16x16x32_bf16 a[112:115], a[16:19], v[48:51], a[112:115]
  v_permlane16_swap_b32 v117, v119
  v_mfma_f32_16x16x32_bf16 a[116:119], a[16:19], v[52:55], a[116:119]
  buffer_store_dwordx4 v[116:119], v12, s[28:31], s56 offen offset:896 sc1
  v_mfma_f32_16x16x32_bf16 a[120:123], a[16:19], v[56:59], a[120:123]
  s_waitcnt lgkmcnt(2)
  ds_read_b64_tr_b16 a[28:29], v243 offset:50176
  ds_read_b64_tr_b16 a[30:31], v243 offset:56320
  v_mfma_f32_16x16x32_bf16 a[132:135], a[20:23], v[56:59], a[132:135]
  v_accvgpr_read_b32 v72, a96
  v_accvgpr_read_b32 v73, a97
  v_mfma_f32_16x16x32_bf16 a[128:131], a[20:23], v[52:55], a[128:131]
  v_accvgpr_read_b32 v74, a98
  v_accvgpr_read_b32 v75, a99
  v_mfma_f32_16x16x32_bf16 a[124:127], a[20:23], v[48:51], a[124:127]
  s_waitcnt lgkmcnt(2)
  ds_read_b64_tr_b16 a[32:33], v248 offset:26624
  ds_read_b64_tr_b16 a[34:35], v248 offset:32768
  v_mfma_f32_16x16x32_bf16 a[112:115], a[24:27], v[60:63], a[112:115]
  v_accvgpr_read_b32 v76, a108
  v_accvgpr_read_b32 v77, a109
  v_mfma_f32_16x16x32_bf16 a[116:119], a[24:27], v[64:67], a[116:119]
  v_accvgpr_read_b32 v78, a110
  v_accvgpr_read_b32 v79, a111
  v_mfma_f32_16x16x32_bf16 a[120:123], a[24:27], v[68:71], a[120:123]
  s_waitcnt lgkmcnt(2)
  ds_read_b64_tr_b16 a[36:37], v249 offset:26624
  ds_read_b64_tr_b16 a[38:39], v249 offset:32768
  v_mfma_f32_16x16x32_bf16 a[132:135], a[28:31], v[68:71], a[132:135]
  v_cvt_pk_bf16_f32 v80, v72, v73
  v_cvt_pk_bf16_f32 v81, v74, v75
  v_mfma_f32_16x16x32_bf16 a[128:131], a[28:31], v[64:67], a[128:131]
  v_cvt_pk_bf16_f32 v82, v76, v77
  v_cvt_pk_bf16_f32 v83, v78, v79
  v_mfma_f32_16x16x32_bf16 a[124:127], a[28:31], v[60:63], a[124:127]
  s_waitcnt lgkmcnt(2)
  ds_read_b64_tr_b16 a[0:1], v244 offset:26624
  ds_read_b64_tr_b16 a[2:3], v244 offset:32768
  v_permlane16_swap_b32 v80, v82
  v_permlane16_swap_b32 v81, v83
  buffer_store_dwordx4 v[80:83], v12, s[28:31], s56 offen offset:1024 sc1
  v_mfma_f32_16x16x32_bf16 a[136:139], a[32:35], v[192:195], a[136:139]
  s_nop 0
  ds_read_b64_tr_b16 a[4:5], v245 offset:26624
  ds_read_b64_tr_b16 a[6:7], v245 offset:32768
  v_mfma_f32_16x16x32_bf16 a[140:143], a[32:35], v[196:199], a[140:143]
  v_accvgpr_read_b32 v84, a112
  v_accvgpr_read_b32 v85, a113
  v_mfma_f32_16x16x32_bf16 a[144:147], a[32:35], v[200:203], a[144:147]
  s_waitcnt lgkmcnt(4)
  v_accvgpr_read_b32 v86, a114
  v_accvgpr_read_b32 v87, a115
  v_mfma_f32_16x16x32_bf16 a[156:159], a[36:39], v[200:203], a[156:159]
  v_accvgpr_read_b32 v88, a124
  v_accvgpr_read_b32 v89, a125
  v_mfma_f32_16x16x32_bf16 a[152:155], a[36:39], v[196:199], a[152:155]
  v_accvgpr_read_b32 v90, a126
  v_accvgpr_read_b32 v91, a127
  v_mfma_f32_16x16x32_bf16 a[148:151], a[36:39], v[192:195], a[148:151]
  s_waitcnt lgkmcnt(2)
  ds_read_b64_tr_b16 a[8:9], v240 offset:14336
  ds_read_b64_tr_b16 a[10:11], v240 offset:20480
  v_mfma_f32_16x16x32_bf16 a[136:139], a[0:3], v[204:207], a[136:139]
  buffer_load_dword v31, v45, s[60:63], 0 offen sc1
  v_mfma_f32_16x16x32_bf16 a[140:143], a[0:3], v[208:211], a[140:143]
  v_cvt_pk_bf16_f32 v92, v84, v85
  v_cvt_pk_bf16_f32 v93, v86, v87
  v_mfma_f32_16x16x32_bf16 a[144:147], a[0:3], v[212:215], a[144:147]
  s_waitcnt lgkmcnt(2)
  ds_read_b64_tr_b16 a[12:13], v241 offset:14336
  ds_read_b64_tr_b16 a[14:15], v241 offset:20480
  v_mfma_f32_16x16x32_bf16 a[156:159], a[4:7], v[212:215], a[156:159]
  v_cvt_pk_bf16_f32 v94, v88, v89
  v_cvt_pk_bf16_f32 v95, v90, v91
  v_mfma_f32_16x16x32_bf16 a[152:155], a[4:7], v[208:211], a[152:155]
  v_permlane16_swap_b32 v92, v94
  v_mfma_f32_16x16x32_bf16 a[148:151], a[4:7], v[204:207], a[148:151]
  s_waitcnt lgkmcnt(2)
  ds_read_b64_tr_b16 a[16:17], v244 offset:14336
  ds_read_b64_tr_b16 a[18:19], v244 offset:20480
  v_mfma_f32_16x16x32_bf16 a[136:139], a[8:11], v[216:219], a[136:139]
  v_permlane16_swap_b32 v93, v95
  v_mfma_f32_16x16x32_bf16 a[140:143], a[8:11], v[220:223], a[140:143]
  buffer_store_dwordx4 v[92:95], v12, s[28:31], s56 offen offset:1152 sc1
  v_mfma_f32_16x16x32_bf16 a[144:147], a[8:11], v[224:227], a[144:147]
  s_waitcnt lgkmcnt(2)
  ds_read_b64_tr_b16 a[20:21], v245 offset:14336
  ds_read_b64_tr_b16 a[22:23], v245 offset:20480
  v_mfma_f32_16x16x32_bf16 a[156:159], a[12:15], v[224:227], a[156:159]
  v_accvgpr_read_b32 v96, a116
  v_accvgpr_read_b32 v97, a117
  v_mfma_f32_16x16x32_bf16 a[152:155], a[12:15], v[220:223], a[152:155]
  v_accvgpr_read_b32 v98, a118
  v_accvgpr_read_b32 v99, a119
  v_mfma_f32_16x16x32_bf16 a[148:151], a[12:15], v[216:219], a[148:151]
  s_waitcnt lgkmcnt(2)
  ds_read_b64_tr_b16 a[24:25], v240 offset:26624
  ds_read_b64_tr_b16 a[26:27], v240 offset:32768
  v_mfma_f32_16x16x32_bf16 a[136:139], a[16:19], v[228:231], a[136:139]
  v_accvgpr_read_b32 v100, a128
  v_accvgpr_read_b32 v101, a129
  v_mfma_f32_16x16x32_bf16 a[140:143], a[16:19], v[232:235], a[140:143]
  v_accvgpr_read_b32 v102, a130
  v_accvgpr_read_b32 v103, a131
  v_mfma_f32_16x16x32_bf16 a[144:147], a[16:19], v[236:239], a[144:147]
  s_waitcnt lgkmcnt(2)
  ds_read_b64_tr_b16 a[28:29], v241 offset:26624
  ds_read_b64_tr_b16 a[30:31], v241 offset:32768
  v_mfma_f32_16x16x32_bf16 a[156:159], a[20:23], v[236:239], a[156:159]
  v_cvt_pk_bf16_f32 v104, v96, v97
  v_cvt_pk_bf16_f32 v105, v98, v99
  v_mfma_f32_16x16x32_bf16 a[152:155], a[20:23], v[232:235], a[152:155]
  v_cvt_pk_bf16_f32 v106, v100, v101
  v_cvt_pk_bf16_f32 v107, v102, v103
  v_mfma_f32_16x16x32_bf16 a[148:151], a[20:23], v[228:231], a[148:151]
  s_waitcnt lgkmcnt(2)
  ds_read_b64_tr_b16 a[32:33], v240 offset:51200
  ds_read_b64_tr_b16 a[34:35], v240 offset:57344
  v_mfma_f32_16x16x32_bf16 a[136:139], a[24:27], v[48:51], a[136:139]
  s_add_u32 s48, s101, 1
  v_permlane16_swap_b32 v104, v106
  v_mfma_f32_16x16x32_bf16 a[140:143], a[24:27], v[52:55], a[140:143]
  v_permlane16_swap_b32 v105, v107
  v_mfma_f32_16x16x32_bf16 a[144:147], a[24:27], v[56:59], a[144:147]
  s_waitcnt lgkmcnt(2)
  ds_read_b64_tr_b16 a[36:37], v241 offset:51200
  ds_read_b64_tr_b16 a[38:39], v241 offset:57344
  v_mfma_f32_16x16x32_bf16 a[156:159], a[28:31], v[56:59], a[156:159]
  buffer_store_dwordx4 v[104:107], v12, s[28:31], s56 offen offset:1280 sc1
  v_mfma_f32_16x16x32_bf16 a[152:155], a[28:31], v[52:55], a[152:155]
  v_accvgpr_read_b32 v108, a120
  v_accvgpr_read_b32 v109, a121
  v_mfma_f32_16x16x32_bf16 a[148:151], a[28:31], v[48:51], a[148:151]
  s_waitcnt lgkmcnt(2)
  v_mov_b32 v11, s48
  v_accvgpr_read_b32 v110, a122
  v_mfma_f32_16x16x32_bf16 a[136:139], a[32:35], v[60:63], a[136:139]
  s_waitcnt vmcnt(4)
  v_accvgpr_read_b32 v111, a123
  v_accvgpr_read_b32 v112, a132
  v_mfma_f32_16x16x32_bf16 a[140:143], a[32:35], v[64:67], a[140:143]
  buffer_store_dword v11, off, s[60:63], s3 sc1
  v_mfma_f32_16x16x32_bf16 a[144:147], a[32:35], v[68:71], a[144:147]
  s_waitcnt lgkmcnt(0)
  v_accvgpr_read_b32 v113, a133
  v_accvgpr_read_b32 v114, a134
  v_mfma_f32_16x16x32_bf16 a[156:159], a[36:39], v[68:71], a[156:159]
  v_accvgpr_read_b32 v115, a135
  v_cvt_pk_bf16_f32 v116, v108, v109
  v_mfma_f32_16x16x32_bf16 a[152:155], a[36:39], v[64:67], a[152:155]
  v_cvt_pk_bf16_f32 v117, v110, v111
  v_cvt_pk_bf16_f32 v118, v112, v113
  v_mfma_f32_16x16x32_bf16 a[148:151], a[36:39], v[60:63], a[148:151]
  v_cvt_pk_bf16_f32 v119, v114, v115
  v_permlane16_swap_b32 v116, v118
  s_nop 0
  v_permlane16_swap_b32 v117, v119
  buffer_store_dwordx4 v[116:119], v12, s[28:31], s56 offen offset:1408 sc1
  v_accvgpr_read_b32 v72, a136
  v_accvgpr_read_b32 v73, a137
  v_accvgpr_read_b32 v74, a138
  v_accvgpr_read_b32 v75, a139
  v_accvgpr_read_b32 v76, a148
  v_accvgpr_read_b32 v77, a149
  v_accvgpr_read_b32 v78, a150
  v_accvgpr_read_b32 v79, a151
  v_cvt_pk_bf16_f32 v80, v72, v73
  v_cvt_pk_bf16_f32 v81, v74, v75
  v_cvt_pk_bf16_f32 v82, v76, v77
  v_cvt_pk_bf16_f32 v83, v78, v79
  s_nop 0
  v_permlane16_swap_b32 v80, v82
  v_permlane16_swap_b32 v81, v83
  buffer_store_dwordx4 v[80:83], v12, s[28:31], s56 offen offset:1536 sc1
  v_accvgpr_read_b32 v84, a140
  v_accvgpr_read_b32 v85, a141
  v_accvgpr_read_b32 v86, a142
  v_accvgpr_read_b32 v87, a143
  v_accvgpr_read_b32 v88, a152
  v_accvgpr_read_b32 v89, a153
  v_accvgpr_read_b32 v90, a154
  v_accvgpr_read_b32 v91, a155
  v_cvt_pk_bf16_f32 v92, v84, v85
  v_cvt_pk_bf16_f32 v93, v86, v87
  v_cvt_pk_bf16_f32 v94, v88, v89
  v_cvt_pk_bf16_f32 v95, v90, v91
  s_nop 0
  v_permlane16_swap_b32 v92, v94
  v_permlane16_swap_b32 v93, v95
  buffer_store_dwordx4 v[92:95], v12, s[28:31], s56 offen offset:1664 sc1
  v_accvgpr_read_b32 v96, a144
  v_accvgpr_read_b32 v97, a145
  v_accvgpr_read_b32 v98, a146
  v_accvgpr_read_b32 v99, a147
  v_accvgpr_read_b32 v100, a156
  v_accvgpr_read_b32 v101, a157
  v_accvgpr_read_b32 v102, a158
  v_accvgpr_read_b32 v103, a159
  v_cvt_pk_bf16_f32 v104, v96, v97
  v_cvt_pk_bf16_f32 v105, v98, v99
  v_cvt_pk_bf16_f32 v106, v100, v101
  v_cvt_pk_bf16_f32 v107, v102, v103
  s_nop 0
  v_permlane16_swap_b32 v104, v106
  v_permlane16_swap_b32 v105, v107
  buffer_store_dwordx4 v[104:107], v12, s[28:31], s56 offen offset:1792 sc1
  s_add_u32 s48, s101, 2
  v_mov_b32 v11, s48
  s_mov_b32 s59, 0x3f80
  s_mov_b32 s56, 0x3f800000
  s_waitcnt vmcnt(0)
  buffer_store_dword v11, off, s[60:63], s3 sc1
  v_sub_u32 v31, v31, v47
  v_cmp_gt_u32 vcc, 1, v31
  s_nop 0
  s_cbranch_vccnz L_poll2a
L_poll2a_back:
  s_add_u32 s44, s58, 0
  buffer_load_dwordx4 v[120:123], v19, s[28:31], s44 offen sc1
  s_add_u32 s45, s58, 0x780
  buffer_load_dwordx4 v[124:127], v19, s[28:31], s45 offen sc1
  s_add_u32 s46, s58, 0xf00
  buffer_load_dwordx4 v[128:131], v19, s[28:31], s46 offen sc1
  s_add_u32 s47, s58, 0x1680
  buffer_load_dwordx4 v[132:135], v19, s[28:31], s47 offen sc1
  s_add_u32 s44, s58, 0x1e00
  buffer_load_dwordx4 v[136:139], v19, s[28:31], s44 offen sc1
  s_add_u32 s45, s58, 0x2580
  buffer_load_dwordx4 v[140:143], v19, s[28:31], s45 offen sc1
  s_add_u32 s46, s58, 0x2d00
  buffer_load_dwordx4 v[144:147], v19, s[28:31], s46 offen sc1
  s_add_u32 s47, s58, 0x3480
  buffer_load_dwordx4 v[148:151], v19, s[28:31], s47 offen sc1
  buffer_load_dword v31, v45, s[60:63], 0 offen sc1
  v_mov_b32 v48, 0
  v_mov_b32 v49, 0
  v_mov_b32 v50, 0
  v_mov_b32 v51, 0
  v_mov_b32 v52, 0
  v_mov_b32 v53, 0
  v_mov_b32 v54, 0
  v_mov_b32 v55, 0
  s_waitcnt vmcnt(8)
  v_dot2c_f32_bf16 v48, s59, v120
  v_dot2c_f32_bf16 v49, s56, v120
  v_dot2c_f32_bf16 v50, s59, v121
  v_dot2c_f32_bf16 v51, s56, v121
  v_dot2c_f32_bf16 v52, s59, v122
  v_dot2c_f32_bf16 v53, s56, v122
  v_dot2c_f32_bf16 v54, s59, v123
  v_dot2c_f32_bf16 v55, s56, v123
  s_waitcnt vmcnt(7)
  v_dot2c_f32_bf16 v48, s59, v124
  v_dot2c_f32_bf16 v49, s56, v124
  v_dot2c_f32_bf16 v50, s59, v125
  v_dot2c_f32_bf16 v51, s56, v125
  v_dot2c_f32_bf16 v52, s59, v126
  v_dot2c_f32_bf16 v53, s56, v126
  v_dot2c_f32_bf16 v54, s59, v127
  v_dot2c_f32_bf16 v55, s56, v127
  s_waitcnt vmcnt(6)
  v_dot2c_f32_bf16 v48, s59, v128
  v_dot2c_f32_bf16 v49, s56, v128
  v_dot2c_f32_bf16 v50, s59, v129
  v_dot2c_f32_bf16 v51, s56, v129
  v_dot2c_f32_bf16 v52, s59, v130
  v_dot2c_f32_bf16 v53, s56, v130
  v_dot2c_f32_bf16 v54, s59, v131
  v_dot2c_f32_bf16 v55, s56, v131
  s_waitcnt vmcnt(5)
  v_dot2c_f32_bf16 v48, s59, v132
  v_dot2c_f32_bf16 v49, s56, v132
  v_dot2c_f32_bf16 v50, s59, v133
  v_dot2c_f32_bf16 v51, s56, v133
  v_dot2c_f32_bf16 v52, s59, v134
  v_dot2c_f32_bf16 v53, s56, v134
  v_dot2c_f32_bf16 v54, s59, v135
  v_dot2c_f32_bf16 v55, s56, v135
  s_waitcnt vmcnt(4)
  v_dot2c_f32_bf16 v48, s59, v136
  v_dot2c_f32_bf16 v49, s56, v136
  v_dot2c_f32_bf16 v50, s59, v137
  v_dot2c_f32_bf16 v51, s56, v137
  v_dot2c_f32_bf16 v52, s59, v138
  v_dot2c_f32_bf16 v53, s56, v138
  v_dot2c_f32_bf16 v54, s59, v139
  v_dot2c_f32_bf16 v55, s56, v139
  s_waitcnt vmcnt(3)
  v_dot2c_f32_bf16 v48, s59, v140
  v_dot2c_f32_bf16 v49, s56, v140
  v_dot2c_f32_bf16 v50, s59, v141
  v_dot2c_f32_bf16 v51, s56, v141
  v_dot2c_f32_bf16 v52, s59, v142
  v_dot2c_f32_bf16 v53, s56, v142
  v_dot2c_f32_bf16 v54, s59, v143
  v_dot2c_f32_bf16 v55, s56, v143
  s_waitcnt vmcnt(2)
  v_dot2c_f32_bf16 v48, s59, v144
  v_dot2c_f32_bf16 v49, s56, v144
  v_dot2c_f32_bf16 v50, s59, v145
  v_dot2c_f32_bf16 v51, s56, v145
  v_dot2c_f32_bf16 v52, s59, v146
  v_dot2c_f32_bf16 v53, s56, v146
  v_dot2c_f32_bf16 v54, s59, v147
  v_dot2c_f32_bf16 v55, s56, v147
  s_waitcnt vmcnt(1)
  v_dot2c_f32_bf16 v48, s59, v148
  v_dot2c_f32_bf16 v49, s56, v148
  v_dot2c_f32_bf16 v50, s59, v149
  v_dot2c_f32_bf16 v51, s56, v149
  v_dot2c_f32_bf16 v52, s59, v150
  v_dot2c_f32_bf16 v53, s56, v150
  v_dot2c_f32_bf16 v54, s59, v151
  v_dot2c_f32_bf16 v55, s56, v151
  s_nop 2
  v_cvt_pk_bf16_f32 v56, v48, v49
  v_cvt_pk_bf16_f32 v57, v50, v51
  v_cvt_pk_bf16_f32 v58, v52, v53
  v_cvt_pk_bf16_f32 v59, v54, v55
  s_waitcnt vmcnt(0)
  v_sub_u32 v31, v31, v47
  v_cmp_gt_u32 vcc, 2, v31
  s_nop 0
  s_cbranch_vccnz L_poll2b
L_poll2b_back:
  s_add_u32 s44, s58, 0
  buffer_load_dwordx4 v[152:155], v18, s[28:31], s44 offen offset:1024 sc1
  s_add_u32 s45, s58, 0x780
  buffer_load_dwordx4 v[156:159], v18, s[28:31], s45 offen offset:1024 sc1
  s_add_u32 s46, s58, 0xf00
  buffer_load_dwordx4 v[160:163], v18, s[28:31], s46 offen offset:1024 sc1
  s_add_u32 s47, s58, 0x1680
  buffer_load_dwordx4 v[164:167], v18, s[28:31], s47 offen offset:1024 sc1
  s_add_u32 s44, s58, 0x1e00
  buffer_load_dwordx4 v[168:171], v18, s[28:31], s44 offen offset:1024 sc1
  s_add_u32 s45, s58, 0x2580
  buffer_load_dwordx4 v[172:175], v18, s[28:31], s45 offen offset:1024 sc1
  s_add_u32 s46, s58, 0x2d00
  buffer_load_dwordx4 v[176:179], v18, s[28:31], s46 offen offset:1024 sc1
  s_add_u32 s47, s58, 0x3480
  buffer_load_dwordx4 v[180:183], v18, s[28:31], s47 offen offset:1024 sc1
  buffer_store_dwordx4 v[56:59], v14, s[32:35], s57 offen
  v_mov_b32 v60, 0
  v_mov_b32 v61, 0
  v_mov_b32 v62, 0
  v_mov_b32 v63, 0
  v_mov_b32 v64, 0
  v_mov_b32 v65, 0
  v_mov_b32 v66, 0
  v_mov_b32 v67, 0
  s_waitcnt vmcnt(8)
  v_dot2c_f32_bf16 v60, s59, v152
  v_dot2c_f32_bf16 v61, s56, v152
  v_dot2c_f32_bf16 v62, s59, v153
  v_dot2c_f32_bf16 v63, s56, v153
  v_dot2c_f32_bf16 v64, s59, v154
  v_dot2c_f32_bf16 v65, s56, v154
  v_dot2c_f32_bf16 v66, s59, v155
  v_dot2c_f32_bf16 v67, s56, v155
  s_waitcnt vmcnt(7)
  v_dot2c_f32_bf16 v60, s59, v156
  v_dot2c_f32_bf16 v61, s56, v156
  v_dot2c_f32_bf16 v62, s59, v157
  v_dot2c_f32_bf16 v63, s56, v157
  v_dot2c_f32_bf16 v64, s59, v158
  v_dot2c_f32_bf16 v65, s56, v158
  v_dot2c_f32_bf16 v66, s59, v159
  v_dot2c_f32_bf16 v67, s56, v159
  s_waitcnt vmcnt(6)
  v_dot2c_f32_bf16 v60, s59, v160
  v_dot2c_f32_bf16 v61, s56, v160
  v_dot2c_f32_bf16 v62, s59, v161
  v_dot2c_f32_bf16 v63, s56, v161
  v_dot2c_f32_bf16 v64, s59, v162
  v_dot2c_f32_bf16 v65, s56, v162
  v_dot2c_f32_bf16 v66, s59, v163
  v_dot2c_f32_bf16 v67, s56, v163
  s_waitcnt vmcnt(5)
  v_dot2c_f32_bf16 v60, s59, v164
  v_dot2c_f32_bf16 v61, s56, v164
  v_dot2c_f32_bf16 v62, s59, v165
  v_dot2c_f32_bf16 v63, s56, v165
  v_dot2c_f32_bf16 v64, s59, v166
  v_dot2c_f32_bf16 v65, s56, v166
  v_dot2c_f32_bf16 v66, s59, v167
  v_dot2c_f32_bf16 v67, s56, v167
  s_waitcnt vmcnt(4)
  v_dot2c_f32_bf16 v60, s59, v168
  v_dot2c_f32_bf16 v61, s56, v168
  v_dot2c_f32_bf16 v62, s59, v169
  v_dot2c_f32_bf16 v63, s56, v169
  v_dot2c_f32_bf16 v64, s59, v170
  v_dot2c_f32_bf16 v65, s56, v170
  v_dot2c_f32_bf16 v66, s59, v171
  v_dot2c_f32_bf16 v67, s56, v171
  s_waitcnt vmcnt(3)
  v_dot2c_f32_bf16 v60, s59, v172
  v_dot2c_f32_bf16 v61, s56, v172
  v_dot2c_f32_bf16 v62, s59, v173
  v_dot2c_f32_bf16 v63, s56, v173
  v_dot2c_f32_bf16 v64, s59, v174
  v_dot2c_f32_bf16 v65, s56, v174
  v_dot2c_f32_bf16 v66, s59, v175
  v_dot2c_f32_bf16 v67, s56, v175
  s_waitcnt vmcnt(2)
  v_dot2c_f32_bf16 v60, s59, v176
  v_dot2c_f32_bf16 v61, s56, v176
  v_dot2c_f32_bf16 v62, s59, v177
  v_dot2c_f32_bf16 v63, s56, v177
  v_dot2c_f32_bf16 v64, s59, v178
  v_dot2c_f32_bf16 v65, s56, v178
  v_dot2c_f32_bf16 v66, s59, v179
  v_dot2c_f32_bf16 v67, s56, v179
  s_waitcnt vmcnt(1)
  v_dot2c_f32_bf16 v60, s59, v180
  v_dot2c_f32_bf16 v61, s56, v180
  v_dot2c_f32_bf16 v62, s59, v181
  v_dot2c_f32_bf16 v63, s56, v181
  v_dot2c_f32_bf16 v64, s59, v182
  v_dot2c_f32_bf16 v65, s56, v182
  v_dot2c_f32_bf16 v66, s59, v183
  v_dot2c_f32_bf16 v67, s56, v183
  s_nop 2
  v_cvt_pk_bf16_f32 v68, v60, v61
  v_cvt_pk_bf16_f32 v69, v62, v63
  v_cvt_pk_bf16_f32 v70, v64, v65
  v_cvt_pk_bf16_f32 v71, v66, v67
  buffer_store_dwordx4 v[68:71], v17, s[32:35], s57 offen
  s_add_u32 s48, s101, 4
  v_mov_b32 v11, s48
  buffer_store_dword v11, off, s[60:63], s3 sc1
L_end_k:
  s_endpgm
.section .rodata,"a"
.p2align 6
.amdhsa_kernel standalone__gqa_block_cached__near_ridge_kernel
  .amdhsa_next_free_vgpr 512
  .amdhsa_next_free_sgpr 102
  .amdhsa_accum_offset 256
  .amdhsa_group_segment_fixed_size 0
  .amdhsa_kernarg_size 64
  .amdhsa_user_sgpr_count 2
  .amdhsa_user_sgpr_kernarg_segment_ptr 1
  .amdhsa_system_sgpr_workgroup_id_x 1
  .amdhsa_float_denorm_mode_32 3
.end_amdhsa_kernel
```
